```python
import torch

def _softmax(x, axis=-1):
    return torch.softmax(x, dim=axis)
def _gelu(x):
    return torch.nn.functional.gelu(x, approximate="tanh")
def _silu(x):
    return torch.nn.functional.silu(x)
def _sigmoid(x):
    return torch.sigmoid(x)
def _layernorm(x, axis=-1, eps=1e-5):
    m = x.mean(dim=axis, keepdim=True)
    v = x.var(dim=axis, keepdim=True, unbiased=False)
    return (x - m) / torch.sqrt(v + eps)
def _scatter_add(tgt, idx, src, axis=0):
    return tgt.clone().index_add_(axis, idx, src)
def _segment_sum(src, seg, n):
    out = torch.zeros((n,) + src.shape[1:], dtype=src.dtype)
    return out.index_add_(0, seg, src)
def _pad(x, pw):
    flat = tuple(v for pair in reversed(pw) for v in pair)
    return torch.nn.functional.pad(x, flat)

kernel_name = 'gated_mix__softmax_full_mha__geglu_ffn__prompt'

def setup_inputs():

    _w = (lambda a: (lambda t: t.to(torch.bfloat16) if t.is_floating_point() else t)(torch.as_tensor(a)))
    def _A_setup():
        B, S, D = 1, 2048, 640
        return {
            "x": _w((lambda *s: torch.randn(*s, dtype=torch.bfloat16) * 0.05)(B, S, D)),
            "wqkv": _w((lambda *s: torch.randn(*s, dtype=torch.bfloat16) * 0.8)(D, 3 * D)),
            "wo": _w((lambda *s: torch.randn(*s, dtype=torch.bfloat16) * 0.05)(D, D)),
        }
    _A_in = _A_setup()

    def _B_setup():
        B, S, D, F = 1, 2048, 640, 1728
        return {
            "x": _w((lambda *s: torch.randn(*s, dtype=torch.bfloat16) * 0.05)(B, S, D)),
            "w_gate": _w((lambda *s: torch.randn(*s, dtype=torch.bfloat16) * 0.1)(D, F)),
            "w_up": _w((lambda *s: torch.randn(*s, dtype=torch.bfloat16) * 0.1)(D, F)),
            "w_down": _w((lambda *s: torch.randn(*s, dtype=torch.bfloat16) * 0.1)(F, D)),
        }
    _B_in = _B_setup()

    return {
        "A_x": _A_in["x"],
        "A_wqkv": _A_in["wqkv"],
        "A_wo": _A_in["wo"],
        "B_x": _B_in["x"],
        "B_w_gate": _B_in["w_gate"],
        "B_w_up": _B_in["w_up"],
        "B_w_down": _B_in["w_down"],
        "gate_w": _w((lambda *s: torch.randn(*s, dtype=torch.bfloat16) * 0.05)(640) * 16.0),
    }

def reference(A_x, A_wqkv, A_wo, B_x, B_w_gate, B_w_up, B_w_down, gate_w):
    def _A_ref(x, wqkv, wo):
        B, S, D = x.shape
        H = 32; Dh = D // H
        qkv = (lambda x, *d: x.permute(*d))((x @ wqkv).reshape(B, S, 3, H, Dh), 2, 0, 3, 1, 4)
        q, k, v = qkv[0], qkv[1], qkv[2]
        scale = Dh ** -0.5
        scores = torch.einsum("bhqd,bhkd->bhqk", q, k) * scale
        p = _softmax(scores, axis=-1)
        o = torch.einsum("bhqk,bhkd->bhqd", p, v)
        return (lambda x, *d: x.permute(*d))(o, 0, 2, 1, 3).reshape(B, S, D) @ wo

    def _B_ref(x, w_gate, w_up, w_down):
        return (_gelu(x @ w_gate) * (x @ w_up)) @ w_down

    x = A_x
    g = _sigmoid((x * gate_w).sum(-1, keepdims=True))
    a = _A_ref(x, A_wqkv, A_wo)
    b = _B_ref(x, B_w_gate, B_w_up, B_w_down)
    return g * a + (1 - g) * b
```

```asm
; @launch grid=(256,1,1) block=(512,1,1) lds=163840
.amdgcn_target "amdgcn-amd-amdhsa--gfx950"
.text
.p2align 12
.fill 832, 4, 0xbf810000
.globl gated_mix__softmax_full_mha__geglu_ffn__prompt_kernel
.p2align 8
.type gated_mix__softmax_full_mha__geglu_ffn__prompt_kernel,@function
gated_mix__softmax_full_mha__geglu_ffn__prompt_kernel:
    s_cmp_ge_u32 s2, 256
    s_cbranch_scc1 K_end
    s_load_dwordx16 s[48:63], s[0:1], 0
    s_load_dwordx2 s[4:5], s[0:1], 80
    s_load_dwordx2 s[6:7], s[0:1], 72
    s_load_dwordx2 s[0:1], s[0:1], 64
    v_lshrrev_b32 v1, 6, v0
    v_and_b32 v0, 63, v0
    s_and_b32 s24, s2, 1
    v_readfirstlane_b32 s3, v1
    s_lshl_b32 s24, s24, 3
    s_lshr_b32 s25, s2, 3
    s_and_b32 s26, s25, 7
    s_add_u32 s20, s24, s26
    s_lshr_b32 s25, s25, 3
    s_and_b32 s24, s2, 2
    s_lshl_b32 s24, s24, 1
    s_add_u32 s25, s25, s24
    s_lshl_b32 s25, s25, 2
    s_and_b32 s24, s2, 4
    s_mov_b32 s26, 0x87db65fe
    s_cmp_eq_u32 s24, 0
    s_cselect_b32 s24, 0x43ca9210, s26
    s_lshr_b32 s24, s24, s25
    s_and_b32 s21, s24, 15
    s_and_b32 s22, s3, 1
    s_lshr_b32 s23, s3, 1
    s_lshl_b32 s32, s3, 10
    s_lshl_b32 s24, s3, 2
    v_lshrrev_b32 v5, 4, v0
    v_add_u32 v5, s24, v5
    v_xor_b32 v5, v5, v0
    v_and_b32 v5, 7, v5
    v_lshlrev_b32 v5, 4, v5
    v_lshrrev_b32 v6, 3, v0
    s_mul_i32 s24, s3, 10240
    v_mul_u32_u24 v6, 1280, v6
    v_add3_u32 v1, v5, v6, s24
    s_mul_i32 s25, s20, 163840
    s_mov_b32 s10, 163840
    s_mov_b32 s11, 0x00020000
    s_mov_b32 s15, 0x00020000
    s_mov_b32 s19, 0x00020000
    s_mov_b32 s36, s25
    s_cmp_ge_u32 s21, 10
    s_cbranch_scc1 L_qkvpar_1
    s_mov_b32 s39, 6
    s_mov_b32 s26, 2731
    s_mov_b32 s27, 24
    s_mov_b32 s28, 3456
    s_mul_i32 s29, s21, 384
    s_and_b32 s30, s3, 3
    s_mov_b32 s31, 4
    s_mov_b32 s42, 24
    s_lshr_b32 s43, s3, 2
    s_mul_i32 s43, s43, 12288
    s_mov_b32 s14, 2211840
    s_branch L_parj_2
L_qkvpar_1:
    s_mov_b32 s39, 0
    s_mov_b32 s26, 1561
    s_mov_b32 s27, 42
    s_mov_b32 s28, 3840
    s_sub_u32 s29, s21, 10
    s_mul_i32 s29, s29, 640
    s_mov_b32 s30, s3
    s_mov_b32 s31, 8
    s_mov_b32 s42, 40
    s_mov_b32 s43, 0
    s_mov_b32 s14, 2457600
L_parj_2:
    s_lshl_b32 s38, s28, 5
    s_mov_b32 s37, 0
    v_mov_b32 v13, 0x7fff0000
    s_lshl_b32 s24, s30, 6
    v_add_u32 v5, s24, v0
    v_mul_u32_u24 v6, s26, v5
    v_lshrrev_b32 v6, 16, v6
    v_mul_u32_u24 v7, s27, v6
    v_sub_u32 v7, v5, v7
    v_and_b32 v8, 0x13, v6
    v_and_b32 v9, 4, v6
    v_lshl_or_b32 v8, v9, 1, v8
    v_and_b32 v9, 8, v6
    v_lshrrev_b32 v9, 1, v9
    v_or_b32 v8, v8, v9
    v_mul_u32_u24 v8, s28, v8
    v_cmp_gt_u32 vcc, s42, v7
    v_and_b32 v9, s39, v6
    v_xor_b32 v7, v7, v9
    v_lshl_add_u32 v8, v7, 4, v8
    v_add_u32 v8, s29, v8
    v_cndmask_b32 v8, v13, v8, vcc
    v_cmp_gt_u32 vcc, 32, v6
    s_lshl_b32 s24, s30, 10
    s_add_u32 s24, s24, s43
    v_cndmask_b32 v2, v13, v8, vcc
    s_lshl_b32 s25, s30, 1
    s_cmp_lt_u32 s25, s27
    s_cselect_b32 s33, s24, 114688
    s_add_u32 s30, s30, s31
    s_lshl_b32 s24, s30, 6
    v_add_u32 v5, s24, v0
    v_mul_u32_u24 v6, s26, v5
    v_lshrrev_b32 v6, 16, v6
    v_mul_u32_u24 v7, s27, v6
    v_sub_u32 v7, v5, v7
    v_and_b32 v8, 0x13, v6
    v_and_b32 v9, 4, v6
    v_lshl_or_b32 v8, v9, 1, v8
    v_and_b32 v9, 8, v6
    v_lshrrev_b32 v9, 1, v9
    v_or_b32 v8, v8, v9
    v_mul_u32_u24 v8, s28, v8
    v_cmp_gt_u32 vcc, s42, v7
    v_and_b32 v9, s39, v6
    v_xor_b32 v7, v7, v9
    v_lshl_add_u32 v8, v7, 4, v8
    v_add_u32 v8, s29, v8
    v_cndmask_b32 v8, v13, v8, vcc
    v_cmp_gt_u32 vcc, 32, v6
    s_lshl_b32 s24, s30, 10
    s_add_u32 s24, s24, s43
    v_cndmask_b32 v3, v13, v8, vcc
    s_lshl_b32 s25, s30, 1
    s_cmp_lt_u32 s25, s27
    s_cselect_b32 s34, s24, 114688
    s_add_u32 s30, s30, s31
    s_lshl_b32 s24, s30, 6
    v_add_u32 v5, s24, v0
    v_mul_u32_u24 v6, s26, v5
    v_lshrrev_b32 v6, 16, v6
    v_mul_u32_u24 v7, s27, v6
    v_sub_u32 v7, v5, v7
    v_and_b32 v8, 0x13, v6
    v_and_b32 v9, 4, v6
    v_lshl_or_b32 v8, v9, 1, v8
    v_and_b32 v9, 8, v6
    v_lshrrev_b32 v9, 1, v9
    v_or_b32 v8, v8, v9
    v_mul_u32_u24 v8, s28, v8
    v_cmp_gt_u32 vcc, s42, v7
    v_and_b32 v9, s39, v6
    v_xor_b32 v7, v7, v9
    v_lshl_add_u32 v8, v7, 4, v8
    v_add_u32 v8, s29, v8
    v_cndmask_b32 v8, v13, v8, vcc
    v_cmp_gt_u32 vcc, 32, v6
    s_lshl_b32 s24, s30, 10
    s_add_u32 s24, s24, s43
    v_cndmask_b32 v4, v13, v8, vcc
    s_lshl_b32 s25, s30, 1
    s_cmp_lt_u32 s25, s27
    s_cselect_b32 s35, s24, 114688
    s_add_u32 s30, s30, s31
    s_movk_i32 s44, 320
    s_lshr_b32 s30, s3, 2
    s_lshl_b32 s30, s30, 1
    s_cmp_ge_u32 s21, 10
    s_cselect_b32 s24, 3, 2
    s_cselect_b32 s25, 7, 3
    s_cselect_b32 s30, s30, 0
    s_cselect_b32 s26, 512, s44
    s_and_b32 s27, s3, 3
    s_lshl_b32 s27, s27, 3
    s_and_b32 s31, s20, 7
    s_add_u32 s27, s27, s31
    s_lshl_b32 s27, s27, 2
    s_add_u32 s30, s30, s27
    v_lshrrev_b32 v5, s24, v0
    v_add_u32 v5, s30, v5
    v_mul_u32_u24 v5, s28, v5
    v_and_b32 v6, s25, v0
    v_lshlrev_b32 v6, 7, v6
    v_min_u32 v6, s26, v6
    v_cmp_gt_u32 vcc, 16, v0
    v_add3_u32 v5, v5, v6, s29
    s_lshr_b32 s24, s2, 6
    v_cndmask_b32 v240, v13, v5, vcc
    s_lshl_b32 s24, s24, 3
    s_add_u32 s24, s24, s3
    s_mul_i32 s24, s24, 5120
    v_lshrrev_b32 v5, 1, v0
    v_mul_u32_u24 v5, 1280, v5
    v_and_b32 v6, 1, v0
    v_lshlrev_b32 v6, 7, v6
    v_cmp_gt_u32 vcc, 8, v0
    v_add3_u32 v5, v5, v6, s24
    s_nop 0
    v_cndmask_b32 v241, v13, v5, vcc
    s_mov_b32 m0, s32
    s_mov_b32 s24, 81920
    s_cmp_lt_u32 s3, 4
    s_waitcnt lgkmcnt(0)
    s_cselect_b32 s12, s56, s58
    s_cselect_b32 s13, s57, s59
    s_cmp_ge_u32 s21, 10
    s_cselect_b32 s12, s50, s12
    s_cselect_b32 s13, s51, s13
    s_add_u32 s8, s48, s36
    s_addc_u32 s9, s49, 0
    s_cmp_eq_u32 s21, 9
    s_cbranch_scc1 K_side
    buffer_load_dword v243, v241, s[8:11], 0 offen offset:0
    s_mul_i32 s25, s38, 0
    buffer_load_dword v242, v240, s[12:15], s25 offen
    buffer_load_dwordx4 v1, s[8:11], 0 offen lds
    s_add_u32 m0, s32, 8192
    s_nop 0
    buffer_load_dwordx4 v1, s[8:11], s24 offen lds
    s_add_u32 m0, s33, 49152
    s_nop 0
    buffer_load_dwordx4 v2, s[12:15], 0 offen lds
    s_add_u32 m0, s34, 49152
    s_nop 0
    buffer_load_dwordx4 v3, s[12:15], 0 offen lds
    s_add_u32 m0, s35, 49152
    s_nop 0
    buffer_load_dwordx4 v4, s[12:15], 0 offen lds
    s_add_u32 s100, s4, 24117248
    s_addc_u32 s101, s5, 0
    s_or_b32 s24, s2, s3
    s_cbranch_scc1 L_noz_3
    v_mul_u32_u24 v5, 1280, v0
    v_mov_b32 v6, 0
    v_add_u32 v8, 102400, v5
    global_store_dword v8, v6, s[100:101] sc1
    global_store_dword v5, v6, s[100:101] sc1
    v_add_u32 v7, 81920, v5
    global_store_dword v7, v6, s[100:101] sc1
L_noz_3:
    s_cmp_ge_u32 s21, 10
    s_cbranch_scc1 K_qkv
    s_add_u32 s37, s37, s38
    s_add_u32 m0, s33, 73728
    s_nop 0
    buffer_load_dwordx4 v2, s[12:15], s37 offen lds
    s_add_u32 m0, s34, 73728
    s_nop 0
    buffer_load_dwordx4 v3, s[12:15], s37 offen lds
    s_add_u32 m0, s35, 73728
    s_nop 0
    buffer_load_dwordx4 v4, s[12:15], s37 offen lds
    v_and_b32 v13, 15, v0
    v_lshrrev_b32 v14, 4, v0
    v_lshrrev_b32 v15, 1, v13
    v_xor_b32 v15, v15, v14
    v_lshlrev_b32 v15, 4, v15
    v_lshl_add_u32 v15, v13, 7, v15
    s_lshl_b32 s24, s22, 13
    v_add_u32 v5, s24, v15
    v_xor_b32 v6, 4096, v5
    v_xor_b32 v7, 64, v5
    v_xor_b32 v8, 64, v6
    v_lshrrev_b32 v13, 2, v0
    v_and_b32 v15, 7, v13
    v_and_b32 v13, 8, v13
    v_lshl_or_b32 v15, v13, 1, v15
    v_mul_u32_u24 v15, 384, v15
    v_and_b32 v13, 3, v0
    v_mul_u32_u24 v13, 8, v13
    v_bfe_u32 v14, v0, 3, 2
    v_xor_b32 v14, s23, v14
    v_lshl_add_u32 v13, v14, 5, v13
    s_mov_b32 s24, 49152
    v_add3_u32 v9, v13, v15, s24
    v_add_u32 v10, 49152, v9
    buffer_load_dword v243, v241, s[8:11], 0 offen offset:256
    s_mul_i32 s25, s38, 4
    buffer_load_dword v242, v240, s[12:15], s25 offen
    s_getpc_b64 s[26:27]
L_pc_5:
    s_lshr_b32 s24, s2, 3
    s_lshl_b32 s24, s24, 3
    s_add_u32 s24, s24, s3
    s_lshl_b32 s24, s24, 8
    s_sub_u32 s26, s26, L_pc_5-gated_mix__softmax_full_mha__geglu_ffn__prompt_kernel
    s_subb_u32 s27, s27, 0
    v_min_u32 v246, 1, v0
    v_lshl_add_u32 v246, v246, 7, s24
    v_min_u32 v246, K_last-gated_mix__softmax_full_mha__geglu_ffn__prompt_kernel, v246
    v_mov_b32 v247, 0
    v_lshl_add_u64 v[246:247], v[246:247], 0, s[26:27]
    global_load_dword v242, v[246:247], off
    s_mov_b32 s96, s21
    s_mov_b32 s97, s22
    s_mov_b32 s98, s23
    s_and_b32 s25, s2, 7
    s_lshr_b32 s26, s2, 3
    s_lshl_b32 s21, s25, 2
    s_and_b32 s25, s26, 3
    s_add_u32 s21, s21, s25
    s_lshr_b32 s22, s26, 2
    s_and_b32 s23, s3, 3
    s_lshr_b32 s24, s3, 2
    s_lshl_b32 s30, s22, 2
    s_add_u32 s30, s30, s23
    s_mul_i32 s26, s30, 303104
    s_add_u32 s26, s26, 8388608
    s_add_u32 s56, s4, s26
    s_addc_u32 s57, s5, 0
    s_mov_b32 s58, 303104
    s_mov_b32 s59, 0x00020000
    s_lshr_b32 s25, s21, 1
    s_add_u32 s25, s25, 54
    s_lshl_b32 s25, s25, 1
    s_add_u32 s25, s25, s24
    s_lshl_b32 s25, s25, 2
    s_and_b32 s26, s21, 1
    s_add_u32 s25, s25, s26
    s_lshl_b32 s25, s25, 9
    v_and_b32 v13, 15, v0
    v_lshlrev_b32 v13, 4, v13
    v_and_b32 v14, 16, v0
    v_lshl_add_u32 v13, v14, 6, v13
    v_and_b32 v14, 32, v0
    v_lshl_add_u32 v252, v14, 3, v13
    v_add_u32 v252, s25, v252
    s_lshr_b32 s25, s21, 3
    s_add_u32 s25, s25, 70
    s_lshl_b32 s25, s25, 1
    s_add_u32 s25, s25, s24
    s_lshl_b32 s25, s25, 11
    s_lshl_b32 s26, s26, 3
    s_add_u32 s25, s25, s26
    s_and_b32 s26, s21, 6
    s_lshl_b32 s26, s26, 7
    s_add_u32 s25, s25, s26
    v_lshl_add_u32 v253, v14, 19, v13
    v_add_u32 v253, s25, v253
    s_mov_b32 s21, s96
    s_mov_b32 s22, s97
    s_mov_b32 s23, s98
    v_mov_b32 v248, -1
    v_mov_b32 v249, -1
    v_mov_b32 v250, -1
    v_mov_b32 v251, -1
    s_waitcnt vmcnt(6)
    s_barrier
    ds_read_b128 v[16:19], v5 offset:0
    ds_read_b128 v[20:23], v5 offset:2048
    ds_read_b128 v[24:27], v6 offset:0
    ds_read_b128 v[28:31], v6 offset:2048
    ds_read_b64_tr_b16 v[32:33], v9 offset:0
    ds_read_b64_tr_b16 v[34:35], v9 offset:3072
    ds_read_b64_tr_b16 v[36:37], v9 offset:12288
    ds_read_b64_tr_b16 v[38:39], v9 offset:15360
    ds_read_b64_tr_b16 v[40:41], v9 offset:128
    ds_read_b64_tr_b16 v[42:43], v9 offset:3200
    ds_read_b64_tr_b16 v[44:45], v9 offset:12416
    ds_read_b64_tr_b16 v[46:47], v9 offset:15488
    ds_read_b64_tr_b16 v[48:49], v9 offset:256
    ds_read_b64_tr_b16 v[50:51], v9 offset:3328
    ds_read_b64_tr_b16 v[52:53], v9 offset:12544
    ds_read_b64_tr_b16 v[54:55], v9 offset:15616
    s_add_u32 s37, s37, s38
    s_add_u32 m0, s33, 98304
    s_nop 0
    buffer_load_dwordx4 v2, s[12:15], s37 offen lds
    s_add_u32 m0, s34, 98304
    s_nop 0
    buffer_load_dwordx4 v3, s[12:15], s37 offen lds
    s_add_u32 m0, s35, 98304
    s_nop 0
    buffer_load_dwordx4 v4, s[12:15], s37 offen lds
    s_add_u32 m0, s32, 16384
    s_mov_b32 s36, 128
    buffer_load_dwordx4 v1, s[8:11], s36 offen lds
    s_add_u32 m0, s32, 24576
    s_mov_b32 s36, 82048
    buffer_load_dwordx4 v1, s[8:11], s36 offen lds
    s_waitcnt vmcnt(8) lgkmcnt(0)
    s_barrier
    v_mfma_f32_16x16x32_bf16 v[96:99], v[32:35], v[16:19], 0
    ds_read_b128 v[56:59], v7 offset:0
    s_add_u32 s37, s37, s38
    s_add_u32 m0, s33, 122880
    s_nop 0
    buffer_load_dwordx4 v2, s[12:15], s37 offen lds
    v_mfma_f32_16x16x32_bf16 v[100:103], v[36:39], v[16:19], 0
    ds_read_b128 v[60:63], v7 offset:2048
    v_mfma_f32_16x16x32_bf16 v[104:107], v[40:43], v[16:19], 0
    ds_read_b128 v[64:67], v8 offset:0
    v_mfma_f32_16x16x32_bf16 v[108:111], v[44:47], v[16:19], 0
    ds_read_b128 v[68:71], v8 offset:2048
    s_add_u32 m0, s34, 122880
    s_nop 0
    buffer_load_dwordx4 v3, s[12:15], s37 offen lds
    v_mfma_f32_16x16x32_bf16 v[112:115], v[48:51], v[16:19], 0
    ds_read_b64_tr_b16 v[72:73], v9 offset:24576
    v_mfma_f32_16x16x32_bf16 v[116:119], v[52:55], v[16:19], 0
    ds_read_b64_tr_b16 v[74:75], v9 offset:27648
    v_mfma_f32_16x16x32_bf16 v[120:123], v[32:35], v[20:23], 0
    ds_read_b64_tr_b16 v[76:77], v9 offset:36864
    s_add_u32 m0, s35, 122880
    s_nop 0
    buffer_load_dwordx4 v4, s[12:15], s37 offen lds
    v_mfma_f32_16x16x32_bf16 v[124:127], v[36:39], v[20:23], 0
    ds_read_b64_tr_b16 v[78:79], v9 offset:39936
    v_mfma_f32_16x16x32_bf16 v[128:131], v[40:43], v[20:23], 0
    ds_read_b64_tr_b16 v[80:81], v9 offset:24704
    v_mfma_f32_16x16x32_bf16 v[132:135], v[44:47], v[20:23], 0
    ds_read_b64_tr_b16 v[82:83], v9 offset:27776
    s_add_u32 s37, s37, s38
    s_add_u32 m0, s33, 49152
    s_nop 0
    buffer_load_dwordx4 v2, s[12:15], s37 offen lds
    v_mfma_f32_16x16x32_bf16 v[136:139], v[48:51], v[20:23], 0
    ds_read_b64_tr_b16 v[84:85], v9 offset:36992
    v_mfma_f32_16x16x32_bf16 v[140:143], v[52:55], v[20:23], 0
    ds_read_b64_tr_b16 v[86:87], v9 offset:40064
    v_mfma_f32_16x16x32_bf16 v[144:147], v[32:35], v[24:27], 0
    ds_read_b64_tr_b16 v[88:89], v9 offset:24832
    s_add_u32 m0, s34, 49152
    s_nop 0
    buffer_load_dwordx4 v3, s[12:15], s37 offen lds
    v_mfma_f32_16x16x32_bf16 v[148:151], v[36:39], v[24:27], 0
    ds_read_b64_tr_b16 v[90:91], v9 offset:27904
    v_mfma_f32_16x16x32_bf16 v[152:155], v[40:43], v[24:27], 0
    ds_read_b64_tr_b16 v[92:93], v9 offset:37120
    v_mfma_f32_16x16x32_bf16 v[156:159], v[44:47], v[24:27], 0
    ds_read_b64_tr_b16 v[94:95], v9 offset:40192
    s_add_u32 m0, s35, 49152
    s_nop 0
    buffer_load_dwordx4 v4, s[12:15], s37 offen lds
    v_mfma_f32_16x16x32_bf16 v[160:163], v[48:51], v[24:27], 0
    v_mfma_f32_16x16x32_bf16 v[164:167], v[52:55], v[24:27], 0
    v_mfma_f32_16x16x32_bf16 v[168:171], v[32:35], v[28:31], 0
    s_add_u32 m0, s32, 32768
    s_mov_b32 s36, 256
    buffer_load_dwordx4 v1, s[8:11], s36 offen lds
    v_mfma_f32_16x16x32_bf16 v[172:175], v[36:39], v[28:31], 0
    v_mfma_f32_16x16x32_bf16 v[176:179], v[40:43], v[28:31], 0
    v_mfma_f32_16x16x32_bf16 v[180:183], v[44:47], v[28:31], 0
    s_add_u32 m0, s32, 40960
    s_mov_b32 s36, 82176
    buffer_load_dwordx4 v1, s[8:11], s36 offen lds
    v_mfma_f32_16x16x32_bf16 v[184:187], v[48:51], v[28:31], 0
    v_mfma_f32_16x16x32_bf16 v[188:191], v[52:55], v[28:31], 0
    s_waitcnt vmcnt(8) lgkmcnt(0)
    s_barrier
    v_mfma_f32_16x16x32_bf16 v[96:99], v[72:75], v[56:59], v[96:99]
    ds_read_b128 v[16:19], v5 offset:16384
    s_add_u32 s37, s37, s38
    s_add_u32 m0, s33, 73728
    s_nop 0
    buffer_load_dwordx4 v2, s[12:15], s37 offen lds
    v_mfma_f32_16x16x32_bf16 v[100:103], v[76:79], v[56:59], v[100:103]
    ds_read_b128 v[20:23], v5 offset:18432
    v_mfma_f32_16x16x32_bf16 v[104:107], v[80:83], v[56:59], v[104:107]
    ds_read_b128 v[24:27], v6 offset:16384
    v_mfma_f32_16x16x32_bf16 v[108:111], v[84:87], v[56:59], v[108:111]
    ds_read_b128 v[28:31], v6 offset:18432
    v_mfma_f32_16x16x32_bf16 v[112:115], v[88:91], v[56:59], v[112:115]
    ds_read_b64_tr_b16 v[32:33], v10 offset:0
    v_mfma_f32_16x16x32_bf16 v[116:119], v[92:95], v[56:59], v[116:119]
    ds_read_b64_tr_b16 v[34:35], v10 offset:3072
    s_add_u32 m0, s34, 73728
    s_nop 0
    buffer_load_dwordx4 v3, s[12:15], s37 offen lds
    v_mfma_f32_16x16x32_bf16 v[120:123], v[72:75], v[60:63], v[120:123]
    ds_read_b64_tr_b16 v[36:37], v10 offset:12288
    v_mfma_f32_16x16x32_bf16 v[124:127], v[76:79], v[60:63], v[124:127]
    ds_read_b64_tr_b16 v[38:39], v10 offset:15360
    v_mfma_f32_16x16x32_bf16 v[128:131], v[80:83], v[60:63], v[128:131]
    ds_read_b64_tr_b16 v[40:41], v10 offset:128
    v_mfma_f32_16x16x32_bf16 v[132:135], v[84:87], v[60:63], v[132:135]
    ds_read_b64_tr_b16 v[42:43], v10 offset:3200
    v_mfma_f32_16x16x32_bf16 v[136:139], v[88:91], v[60:63], v[136:139]
    ds_read_b64_tr_b16 v[44:45], v10 offset:12416
    s_add_u32 m0, s35, 73728
    s_nop 0
    buffer_load_dwordx4 v4, s[12:15], s37 offen lds
    v_mfma_f32_16x16x32_bf16 v[140:143], v[92:95], v[60:63], v[140:143]
    ds_read_b64_tr_b16 v[46:47], v10 offset:15488
    v_mfma_f32_16x16x32_bf16 v[144:147], v[72:75], v[64:67], v[144:147]
    ds_read_b64_tr_b16 v[48:49], v10 offset:256
    v_mfma_f32_16x16x32_bf16 v[148:151], v[76:79], v[64:67], v[148:151]
    ds_read_b64_tr_b16 v[50:51], v10 offset:3328
    v_mfma_f32_16x16x32_bf16 v[152:155], v[80:83], v[64:67], v[152:155]
    ds_read_b64_tr_b16 v[52:53], v10 offset:12544
    s_or_b32 s24, s2, s3
    s_cbranch_scc1 L_noi_4
    v_mov_b32 v13, 0
    v_mov_b32 v14, 1
    s_mov_b64 exec, 1
    global_store_dword v13, v14, s[6:7] sc1
    s_mov_b64 exec, -1
L_noi_4:
    v_mfma_f32_16x16x32_bf16 v[156:159], v[84:87], v[64:67], v[156:159]
    ds_read_b64_tr_b16 v[54:55], v10 offset:15616
    v_mfma_f32_16x16x32_bf16 v[160:163], v[88:91], v[64:67], v[160:163]
    v_mfma_f32_16x16x32_bf16 v[164:167], v[92:95], v[64:67], v[164:167]
    v_mfma_f32_16x16x32_bf16 v[168:171], v[72:75], v[68:71], v[168:171]
    v_mfma_f32_16x16x32_bf16 v[172:175], v[76:79], v[68:71], v[172:175]
    buffer_load_dword v243, v241, s[8:11], 0 offen offset:512
    v_mfma_f32_16x16x32_bf16 v[176:179], v[80:83], v[68:71], v[176:179]
    v_mfma_f32_16x16x32_bf16 v[180:183], v[84:87], v[68:71], v[180:183]
    v_mfma_f32_16x16x32_bf16 v[184:187], v[88:91], v[68:71], v[184:187]
    v_mfma_f32_16x16x32_bf16 v[188:191], v[92:95], v[68:71], v[188:191]
    s_waitcnt vmcnt(9) lgkmcnt(0)
    s_barrier
    v_mfma_f32_16x16x32_bf16 v[96:99], v[32:35], v[16:19], v[96:99]
    ds_read_b128 v[56:59], v7 offset:16384
    s_add_u32 s37, s37, s38
    s_add_u32 m0, s33, 98304
    s_nop 0
    buffer_load_dwordx4 v2, s[12:15], s37 offen lds
    v_mfma_f32_16x16x32_bf16 v[100:103], v[36:39], v[16:19], v[100:103]
    ds_read_b128 v[60:63], v7 offset:18432
    v_mfma_f32_16x16x32_bf16 v[104:107], v[40:43], v[16:19], v[104:107]
    ds_read_b128 v[64:67], v8 offset:16384
    v_mfma_f32_16x16x32_bf16 v[108:111], v[44:47], v[16:19], v[108:111]
    ds_read_b128 v[68:71], v8 offset:18432
    v_mfma_f32_16x16x32_bf16 v[112:115], v[48:51], v[16:19], v[112:115]
    ds_read_b64_tr_b16 v[72:73], v10 offset:24576
    v_mfma_f32_16x16x32_bf16 v[116:119], v[52:55], v[16:19], v[116:119]
    ds_read_b64_tr_b16 v[74:75], v10 offset:27648
    s_add_u32 m0, s34, 98304
    s_nop 0
    buffer_load_dwordx4 v3, s[12:15], s37 offen lds
    v_mfma_f32_16x16x32_bf16 v[120:123], v[32:35], v[20:23], v[120:123]
    ds_read_b64_tr_b16 v[76:77], v10 offset:36864
    v_mfma_f32_16x16x32_bf16 v[124:127], v[36:39], v[20:23], v[124:127]
    ds_read_b64_tr_b16 v[78:79], v10 offset:39936
    v_mfma_f32_16x16x32_bf16 v[128:131], v[40:43], v[20:23], v[128:131]
    ds_read_b64_tr_b16 v[80:81], v10 offset:24704
    v_mfma_f32_16x16x32_bf16 v[132:135], v[44:47], v[20:23], v[132:135]
    ds_read_b64_tr_b16 v[82:83], v10 offset:27776
    v_mfma_f32_16x16x32_bf16 v[136:139], v[48:51], v[20:23], v[136:139]
    ds_read_b64_tr_b16 v[84:85], v10 offset:36992
    s_add_u32 m0, s35, 98304
    s_nop 0
    buffer_load_dwordx4 v4, s[12:15], s37 offen lds
    v_mfma_f32_16x16x32_bf16 v[140:143], v[52:55], v[20:23], v[140:143]
    ds_read_b64_tr_b16 v[86:87], v10 offset:40064
    v_mfma_f32_16x16x32_bf16 v[144:147], v[32:35], v[24:27], v[144:147]
    ds_read_b64_tr_b16 v[88:89], v10 offset:24832
    v_mfma_f32_16x16x32_bf16 v[148:151], v[36:39], v[24:27], v[148:151]
    ds_read_b64_tr_b16 v[90:91], v10 offset:27904
    v_mfma_f32_16x16x32_bf16 v[152:155], v[40:43], v[24:27], v[152:155]
    ds_read_b64_tr_b16 v[92:93], v10 offset:37120
    s_add_u32 m0, s32, 0
    s_mov_b32 s36, 384
    buffer_load_dwordx4 v1, s[8:11], s36 offen lds
    v_mfma_f32_16x16x32_bf16 v[156:159], v[44:47], v[24:27], v[156:159]
    ds_read_b64_tr_b16 v[94:95], v10 offset:40192
    v_mfma_f32_16x16x32_bf16 v[160:163], v[48:51], v[24:27], v[160:163]
    v_mfma_f32_16x16x32_bf16 v[164:167], v[52:55], v[24:27], v[164:167]
    v_mfma_f32_16x16x32_bf16 v[168:171], v[32:35], v[28:31], v[168:171]
    v_mfma_f32_16x16x32_bf16 v[172:175], v[36:39], v[28:31], v[172:175]
    s_add_u32 m0, s32, 8192
    s_mov_b32 s36, 82304
    buffer_load_dwordx4 v1, s[8:11], s36 offen lds
    v_mfma_f32_16x16x32_bf16 v[176:179], v[40:43], v[28:31], v[176:179]
    v_mfma_f32_16x16x32_bf16 v[180:183], v[44:47], v[28:31], v[180:183]
    v_mfma_f32_16x16x32_bf16 v[184:187], v[48:51], v[28:31], v[184:187]
    v_mfma_f32_16x16x32_bf16 v[188:191], v[52:55], v[28:31], v[188:191]
    s_waitcnt vmcnt(9) lgkmcnt(0)
    s_barrier
    v_mfma_f32_16x16x32_bf16 v[96:99], v[72:75], v[56:59], v[96:99]
    ds_read_b128 v[16:19], v5 offset:32768
    s_add_u32 s37, s37, s38
    s_add_u32 m0, s33, 122880
    s_nop 0
    buffer_load_dwordx4 v2, s[12:15], s37 offen lds
    v_mfma_f32_16x16x32_bf16 v[100:103], v[76:79], v[56:59], v[100:103]
    ds_read_b128 v[20:23], v5 offset:34816
    v_mfma_f32_16x16x32_bf16 v[104:107], v[80:83], v[56:59], v[104:107]
    ds_read_b128 v[24:27], v6 offset:32768
    v_mfma_f32_16x16x32_bf16 v[108:111], v[84:87], v[56:59], v[108:111]
    ds_read_b128 v[28:31], v6 offset:34816
    v_mfma_f32_16x16x32_bf16 v[112:115], v[88:91], v[56:59], v[112:115]
    ds_read_b64_tr_b16 v[32:33], v9 offset:0
    v_mfma_f32_16x16x32_bf16 v[116:119], v[92:95], v[56:59], v[116:119]
    ds_read_b64_tr_b16 v[34:35], v9 offset:3072
    v_mfma_f32_16x16x32_bf16 v[120:123], v[72:75], v[60:63], v[120:123]
    ds_read_b64_tr_b16 v[36:37], v9 offset:12288
    s_add_u32 m0, s34, 122880
    s_nop 0
    buffer_load_dwordx4 v3, s[12:15], s37 offen lds
    v_mfma_f32_16x16x32_bf16 v[124:127], v[76:79], v[60:63], v[124:127]
    ds_read_b64_tr_b16 v[38:39], v9 offset:15360
    v_mfma_f32_16x16x32_bf16 v[128:131], v[80:83], v[60:63], v[128:131]
    ds_read_b64_tr_b16 v[40:41], v9 offset:128
    v_mfma_f32_16x16x32_bf16 v[132:135], v[84:87], v[60:63], v[132:135]
    ds_read_b64_tr_b16 v[42:43], v9 offset:3200
    v_mfma_f32_16x16x32_bf16 v[136:139], v[88:91], v[60:63], v[136:139]
    ds_read_b64_tr_b16 v[44:45], v9 offset:12416
    v_mfma_f32_16x16x32_bf16 v[140:143], v[92:95], v[60:63], v[140:143]
    ds_read_b64_tr_b16 v[46:47], v9 offset:15488
    v_mfma_f32_16x16x32_bf16 v[144:147], v[72:75], v[64:67], v[144:147]
    ds_read_b64_tr_b16 v[48:49], v9 offset:256
    s_add_u32 m0, s35, 122880
    s_nop 0
    buffer_load_dwordx4 v4, s[12:15], s37 offen lds
    v_mfma_f32_16x16x32_bf16 v[148:151], v[76:79], v[64:67], v[148:151]
    ds_read_b64_tr_b16 v[50:51], v9 offset:3328
    v_mfma_f32_16x16x32_bf16 v[152:155], v[80:83], v[64:67], v[152:155]
    ds_read_b64_tr_b16 v[52:53], v9 offset:12544
    v_mfma_f32_16x16x32_bf16 v[156:159], v[84:87], v[64:67], v[156:159]
    ds_read_b64_tr_b16 v[54:55], v9 offset:15616
    v_mfma_f32_16x16x32_bf16 v[160:163], v[88:91], v[64:67], v[160:163]
    v_mfma_f32_16x16x32_bf16 v[164:167], v[92:95], v[64:67], v[164:167]
    v_mfma_f32_16x16x32_bf16 v[168:171], v[72:75], v[68:71], v[168:171]
    s_mul_i32 s25, s38, 8
    buffer_load_dword v242, v240, s[12:15], s25 offen
    v_mfma_f32_16x16x32_bf16 v[172:175], v[76:79], v[68:71], v[172:175]
    v_mfma_f32_16x16x32_bf16 v[176:179], v[80:83], v[68:71], v[176:179]
    v_mfma_f32_16x16x32_bf16 v[180:183], v[84:87], v[68:71], v[180:183]
    v_mfma_f32_16x16x32_bf16 v[184:187], v[88:91], v[68:71], v[184:187]
    v_mfma_f32_16x16x32_bf16 v[188:191], v[92:95], v[68:71], v[188:191]
    s_waitcnt vmcnt(10) lgkmcnt(0)
    s_barrier
    v_mfma_f32_16x16x32_bf16 v[96:99], v[32:35], v[16:19], v[96:99]
    ds_read_b128 v[56:59], v7 offset:32768
    s_add_u32 s37, s37, s38
    s_add_u32 m0, s33, 49152
    s_nop 0
    buffer_load_dwordx4 v2, s[12:15], s37 offen lds
    v_mfma_f32_16x16x32_bf16 v[100:103], v[36:39], v[16:19], v[100:103]
    ds_read_b128 v[60:63], v7 offset:34816
    v_mfma_f32_16x16x32_bf16 v[104:107], v[40:43], v[16:19], v[104:107]
    ds_read_b128 v[64:67], v8 offset:32768
    v_mfma_f32_16x16x32_bf16 v[108:111], v[44:47], v[16:19], v[108:111]
    ds_read_b128 v[68:71], v8 offset:34816
    v_mfma_f32_16x16x32_bf16 v[112:115], v[48:51], v[16:19], v[112:115]
    ds_read_b64_tr_b16 v[72:73], v9 offset:24576
    s_add_u32 m0, s34, 49152
    s_nop 0
    buffer_load_dwordx4 v3, s[12:15], s37 offen lds
    v_mfma_f32_16x16x32_bf16 v[116:119], v[52:55], v[16:19], v[116:119]
    ds_read_b64_tr_b16 v[74:75], v9 offset:27648
    v_mfma_f32_16x16x32_bf16 v[120:123], v[32:35], v[20:23], v[120:123]
    ds_read_b64_tr_b16 v[76:77], v9 offset:36864
    v_mfma_f32_16x16x32_bf16 v[124:127], v[36:39], v[20:23], v[124:127]
    ds_read_b64_tr_b16 v[78:79], v9 offset:39936
    v_mfma_f32_16x16x32_bf16 v[128:131], v[40:43], v[20:23], v[128:131]
    ds_read_b64_tr_b16 v[80:81], v9 offset:24704
    s_add_u32 m0, s35, 49152
    s_nop 0
    buffer_load_dwordx4 v4, s[12:15], s37 offen lds
    v_mfma_f32_16x16x32_bf16 v[132:135], v[44:47], v[20:23], v[132:135]
    ds_read_b64_tr_b16 v[82:83], v9 offset:27776
    v_mfma_f32_16x16x32_bf16 v[136:139], v[48:51], v[20:23], v[136:139]
    ds_read_b64_tr_b16 v[84:85], v9 offset:36992
    v_mfma_f32_16x16x32_bf16 v[140:143], v[52:55], v[20:23], v[140:143]
    ds_read_b64_tr_b16 v[86:87], v9 offset:40064
    v_mfma_f32_16x16x32_bf16 v[144:147], v[32:35], v[24:27], v[144:147]
    ds_read_b64_tr_b16 v[88:89], v9 offset:24832
    s_add_u32 m0, s32, 16384
    s_mov_b32 s36, 512
    buffer_load_dwordx4 v1, s[8:11], s36 offen lds
    v_mfma_f32_16x16x32_bf16 v[148:151], v[36:39], v[24:27], v[148:151]
    ds_read_b64_tr_b16 v[90:91], v9 offset:27904
    v_mfma_f32_16x16x32_bf16 v[152:155], v[40:43], v[24:27], v[152:155]
    ds_read_b64_tr_b16 v[92:93], v9 offset:37120
    v_mfma_f32_16x16x32_bf16 v[156:159], v[44:47], v[24:27], v[156:159]
    ds_read_b64_tr_b16 v[94:95], v9 offset:40192
    v_mfma_f32_16x16x32_bf16 v[160:163], v[48:51], v[24:27], v[160:163]
    s_add_u32 m0, s32, 24576
    s_mov_b32 s36, 82432
    buffer_load_dwordx4 v1, s[8:11], s36 offen lds
    v_mfma_f32_16x16x32_bf16 v[164:167], v[52:55], v[24:27], v[164:167]
    v_mfma_f32_16x16x32_bf16 v[168:171], v[32:35], v[28:31], v[168:171]
    v_mfma_f32_16x16x32_bf16 v[172:175], v[36:39], v[28:31], v[172:175]
    v_mfma_f32_16x16x32_bf16 v[176:179], v[40:43], v[28:31], v[176:179]
    buffer_load_dword v243, v241, s[8:11], 0 offen offset:768
    v_mfma_f32_16x16x32_bf16 v[180:183], v[44:47], v[28:31], v[180:183]
    v_mfma_f32_16x16x32_bf16 v[184:187], v[48:51], v[28:31], v[184:187]
    v_mfma_f32_16x16x32_bf16 v[188:191], v[52:55], v[28:31], v[188:191]
    s_waitcnt vmcnt(10) lgkmcnt(0)
    s_barrier
    v_mfma_f32_16x16x32_bf16 v[96:99], v[72:75], v[56:59], v[96:99]
    ds_read_b128 v[16:19], v5 offset:0
    s_add_u32 s37, s37, s38
    s_add_u32 m0, s33, 73728
    s_nop 0
    buffer_load_dwordx4 v2, s[12:15], s37 offen lds
    v_mfma_f32_16x16x32_bf16 v[100:103], v[76:79], v[56:59], v[100:103]
    ds_read_b128 v[20:23], v5 offset:2048
    v_mfma_f32_16x16x32_bf16 v[104:107], v[80:83], v[56:59], v[104:107]
    ds_read_b128 v[24:27], v6 offset:0
    v_mfma_f32_16x16x32_bf16 v[108:111], v[84:87], v[56:59], v[108:111]
    ds_read_b128 v[28:31], v6 offset:2048
    v_mfma_f32_16x16x32_bf16 v[112:115], v[88:91], v[56:59], v[112:115]
    ds_read_b64_tr_b16 v[32:33], v10 offset:0
    v_mfma_f32_16x16x32_bf16 v[116:119], v[92:95], v[56:59], v[116:119]
    ds_read_b64_tr_b16 v[34:35], v10 offset:3072
    v_mfma_f32_16x16x32_bf16 v[120:123], v[72:75], v[60:63], v[120:123]
    ds_read_b64_tr_b16 v[36:37], v10 offset:12288
    v_mfma_f32_16x16x32_bf16 v[124:127], v[76:79], v[60:63], v[124:127]
    ds_read_b64_tr_b16 v[38:39], v10 offset:15360
    v_mfma_f32_16x16x32_bf16 v[128:131], v[80:83], v[60:63], v[128:131]
    ds_read_b64_tr_b16 v[40:41], v10 offset:128
    s_add_u32 m0, s34, 73728
    s_nop 0
    buffer_load_dwordx4 v3, s[12:15], s37 offen lds
    v_mfma_f32_16x16x32_bf16 v[132:135], v[84:87], v[60:63], v[132:135]
    ds_read_b64_tr_b16 v[42:43], v10 offset:3200
    v_mfma_f32_16x16x32_bf16 v[136:139], v[88:91], v[60:63], v[136:139]
    ds_read_b64_tr_b16 v[44:45], v10 offset:12416
    v_mfma_f32_16x16x32_bf16 v[140:143], v[92:95], v[60:63], v[140:143]
    ds_read_b64_tr_b16 v[46:47], v10 offset:15488
    v_mfma_f32_16x16x32_bf16 v[144:147], v[72:75], v[64:67], v[144:147]
    ds_read_b64_tr_b16 v[48:49], v10 offset:256
    v_mfma_f32_16x16x32_bf16 v[148:151], v[76:79], v[64:67], v[148:151]
    ds_read_b64_tr_b16 v[50:51], v10 offset:3328
    v_mfma_f32_16x16x32_bf16 v[152:155], v[80:83], v[64:67], v[152:155]
    ds_read_b64_tr_b16 v[52:53], v10 offset:12544
    v_mfma_f32_16x16x32_bf16 v[156:159], v[84:87], v[64:67], v[156:159]
    ds_read_b64_tr_b16 v[54:55], v10 offset:15616
    v_mfma_f32_16x16x32_bf16 v[160:163], v[88:91], v[64:67], v[160:163]
    s_add_u32 m0, s35, 73728
    s_nop 0
    buffer_load_dwordx4 v4, s[12:15], s37 offen lds
    v_mfma_f32_16x16x32_bf16 v[164:167], v[92:95], v[64:67], v[164:167]
    v_mfma_f32_16x16x32_bf16 v[168:171], v[72:75], v[68:71], v[168:171]
    v_mfma_f32_16x16x32_bf16 v[172:175], v[76:79], v[68:71], v[172:175]
    v_mfma_f32_16x16x32_bf16 v[176:179], v[80:83], v[68:71], v[176:179]
    v_mfma_f32_16x16x32_bf16 v[180:183], v[84:87], v[68:71], v[180:183]
    v_mfma_f32_16x16x32_bf16 v[184:187], v[88:91], v[68:71], v[184:187]
    v_mfma_f32_16x16x32_bf16 v[188:191], v[92:95], v[68:71], v[188:191]
    s_waitcnt vmcnt(10) lgkmcnt(0)
    s_barrier
    v_mfma_f32_16x16x32_bf16 v[96:99], v[32:35], v[16:19], v[96:99]
    ds_read_b128 v[56:59], v7 offset:0
    s_add_u32 s37, s37, s38
    s_add_u32 m0, s33, 98304
    s_nop 0
    buffer_load_dwordx4 v2, s[12:15], s37 offen lds
    v_mfma_f32_16x16x32_bf16 v[100:103], v[36:39], v[16:19], v[100:103]
    ds_read_b128 v[60:63], v7 offset:2048
    v_mfma_f32_16x16x32_bf16 v[104:107], v[40:43], v[16:19], v[104:107]
    ds_read_b128 v[64:67], v8 offset:0
    v_mfma_f32_16x16x32_bf16 v[108:111], v[44:47], v[16:19], v[108:111]
    ds_read_b128 v[68:71], v8 offset:2048
    v_mfma_f32_16x16x32_bf16 v[112:115], v[48:51], v[16:19], v[112:115]
    ds_read_b64_tr_b16 v[72:73], v10 offset:24576
    v_mfma_f32_16x16x32_bf16 v[116:119], v[52:55], v[16:19], v[116:119]
    ds_read_b64_tr_b16 v[74:75], v10 offset:27648
    s_add_u32 m0, s34, 98304
    s_nop 0
    buffer_load_dwordx4 v3, s[12:15], s37 offen lds
    v_mfma_f32_16x16x32_bf16 v[120:123], v[32:35], v[20:23], v[120:123]
    ds_read_b64_tr_b16 v[76:77], v10 offset:36864
    v_mfma_f32_16x16x32_bf16 v[124:127], v[36:39], v[20:23], v[124:127]
    ds_read_b64_tr_b16 v[78:79], v10 offset:39936
    v_mfma_f32_16x16x32_bf16 v[128:131], v[40:43], v[20:23], v[128:131]
    ds_read_b64_tr_b16 v[80:81], v10 offset:24704
    v_mfma_f32_16x16x32_bf16 v[132:135], v[44:47], v[20:23], v[132:135]
    ds_read_b64_tr_b16 v[82:83], v10 offset:27776
    v_mfma_f32_16x16x32_bf16 v[136:139], v[48:51], v[20:23], v[136:139]
    ds_read_b64_tr_b16 v[84:85], v10 offset:36992
    s_add_u32 m0, s35, 98304
    s_nop 0
    buffer_load_dwordx4 v4, s[12:15], s37 offen lds
    v_mfma_f32_16x16x32_bf16 v[140:143], v[52:55], v[20:23], v[140:143]
    ds_read_b64_tr_b16 v[86:87], v10 offset:40064
    v_mfma_f32_16x16x32_bf16 v[144:147], v[32:35], v[24:27], v[144:147]
    ds_read_b64_tr_b16 v[88:89], v10 offset:24832
    v_mfma_f32_16x16x32_bf16 v[148:151], v[36:39], v[24:27], v[148:151]
    ds_read_b64_tr_b16 v[90:91], v10 offset:27904
    v_mfma_f32_16x16x32_bf16 v[152:155], v[40:43], v[24:27], v[152:155]
    ds_read_b64_tr_b16 v[92:93], v10 offset:37120
    s_add_u32 m0, s32, 32768
    s_mov_b32 s36, 640
    buffer_load_dwordx4 v1, s[8:11], s36 offen lds
    v_mfma_f32_16x16x32_bf16 v[156:159], v[44:47], v[24:27], v[156:159]
    ds_read_b64_tr_b16 v[94:95], v10 offset:40192
    v_mfma_f32_16x16x32_bf16 v[160:163], v[48:51], v[24:27], v[160:163]
    v_mfma_f32_16x16x32_bf16 v[164:167], v[52:55], v[24:27], v[164:167]
    v_mfma_f32_16x16x32_bf16 v[168:171], v[32:35], v[28:31], v[168:171]
    v_mfma_f32_16x16x32_bf16 v[172:175], v[36:39], v[28:31], v[172:175]
    s_add_u32 m0, s32, 40960
    s_mov_b32 s36, 82560
    buffer_load_dwordx4 v1, s[8:11], s36 offen lds
    v_mfma_f32_16x16x32_bf16 v[176:179], v[40:43], v[28:31], v[176:179]
    v_mfma_f32_16x16x32_bf16 v[180:183], v[44:47], v[28:31], v[180:183]
    v_mfma_f32_16x16x32_bf16 v[184:187], v[48:51], v[28:31], v[184:187]
    v_mfma_f32_16x16x32_bf16 v[188:191], v[52:55], v[28:31], v[188:191]
    s_waitcnt vmcnt(9) lgkmcnt(0)
    s_barrier
    v_mfma_f32_16x16x32_bf16 v[96:99], v[72:75], v[56:59], v[96:99]
    ds_read_b128 v[16:19], v5 offset:16384
    s_add_u32 s37, s37, s38
    s_add_u32 m0, s33, 122880
    s_nop 0
    buffer_load_dwordx4 v2, s[12:15], s37 offen lds
    v_mfma_f32_16x16x32_bf16 v[100:103], v[76:79], v[56:59], v[100:103]
    ds_read_b128 v[20:23], v5 offset:18432
    v_mfma_f32_16x16x32_bf16 v[104:107], v[80:83], v[56:59], v[104:107]
    ds_read_b128 v[24:27], v6 offset:16384
    v_mfma_f32_16x16x32_bf16 v[108:111], v[84:87], v[56:59], v[108:111]
    ds_read_b128 v[28:31], v6 offset:18432
    v_mfma_f32_16x16x32_bf16 v[112:115], v[88:91], v[56:59], v[112:115]
    ds_read_b64_tr_b16 v[32:33], v9 offset:0
    v_mfma_f32_16x16x32_bf16 v[116:119], v[92:95], v[56:59], v[116:119]
    ds_read_b64_tr_b16 v[34:35], v9 offset:3072
    s_add_u32 m0, s34, 122880
    s_nop 0
    buffer_load_dwordx4 v3, s[12:15], s37 offen lds
    v_mfma_f32_16x16x32_bf16 v[120:123], v[72:75], v[60:63], v[120:123]
    ds_read_b64_tr_b16 v[36:37], v9 offset:12288
    v_mfma_f32_16x16x32_bf16 v[124:127], v[76:79], v[60:63], v[124:127]
    ds_read_b64_tr_b16 v[38:39], v9 offset:15360
    v_mfma_f32_16x16x32_bf16 v[128:131], v[80:83], v[60:63], v[128:131]
    ds_read_b64_tr_b16 v[40:41], v9 offset:128
    v_mfma_f32_16x16x32_bf16 v[132:135], v[84:87], v[60:63], v[132:135]
    ds_read_b64_tr_b16 v[42:43], v9 offset:3200
    v_mfma_f32_16x16x32_bf16 v[136:139], v[88:91], v[60:63], v[136:139]
    ds_read_b64_tr_b16 v[44:45], v9 offset:12416
    s_add_u32 m0, s35, 122880
    s_nop 0
    buffer_load_dwordx4 v4, s[12:15], s37 offen lds
    v_mfma_f32_16x16x32_bf16 v[140:143], v[92:95], v[60:63], v[140:143]
    ds_read_b64_tr_b16 v[46:47], v9 offset:15488
    v_mfma_f32_16x16x32_bf16 v[144:147], v[72:75], v[64:67], v[144:147]
    ds_read_b64_tr_b16 v[48:49], v9 offset:256
    v_mfma_f32_16x16x32_bf16 v[148:151], v[76:79], v[64:67], v[148:151]
    ds_read_b64_tr_b16 v[50:51], v9 offset:3328
    v_mfma_f32_16x16x32_bf16 v[152:155], v[80:83], v[64:67], v[152:155]
    ds_read_b64_tr_b16 v[52:53], v9 offset:12544
    s_mul_i32 s25, s38, 12
    buffer_load_dword v242, v240, s[12:15], s25 offen
    v_mfma_f32_16x16x32_bf16 v[156:159], v[84:87], v[64:67], v[156:159]
    ds_read_b64_tr_b16 v[54:55], v9 offset:15616
    v_mfma_f32_16x16x32_bf16 v[160:163], v[88:91], v[64:67], v[160:163]
    v_mfma_f32_16x16x32_bf16 v[164:167], v[92:95], v[64:67], v[164:167]
    v_mfma_f32_16x16x32_bf16 v[168:171], v[72:75], v[68:71], v[168:171]
    v_mfma_f32_16x16x32_bf16 v[172:175], v[76:79], v[68:71], v[172:175]
    buffer_load_dword v243, v241, s[8:11], 0 offen offset:1024
    v_mfma_f32_16x16x32_bf16 v[176:179], v[80:83], v[68:71], v[176:179]
    v_mfma_f32_16x16x32_bf16 v[180:183], v[84:87], v[68:71], v[180:183]
    v_mfma_f32_16x16x32_bf16 v[184:187], v[88:91], v[68:71], v[184:187]
    v_mfma_f32_16x16x32_bf16 v[188:191], v[92:95], v[68:71], v[188:191]
    s_waitcnt vmcnt(10) lgkmcnt(0)
    s_barrier
    v_mfma_f32_16x16x32_bf16 v[96:99], v[32:35], v[16:19], v[96:99]
    ds_read_b128 v[56:59], v7 offset:16384
    s_add_u32 s37, s37, s38
    s_add_u32 m0, s33, 49152
    s_nop 0
    buffer_load_dwordx4 v2, s[12:15], s37 offen lds
    v_mfma_f32_16x16x32_bf16 v[100:103], v[36:39], v[16:19], v[100:103]
    ds_read_b128 v[60:63], v7 offset:18432
    v_mfma_f32_16x16x32_bf16 v[104:107], v[40:43], v[16:19], v[104:107]
    ds_read_b128 v[64:67], v8 offset:16384
    v_mfma_f32_16x16x32_bf16 v[108:111], v[44:47], v[16:19], v[108:111]
    ds_read_b128 v[68:71], v8 offset:18432
    v_mfma_f32_16x16x32_bf16 v[112:115], v[48:51], v[16:19], v[112:115]
    ds_read_b64_tr_b16 v[72:73], v9 offset:24576
    v_mfma_f32_16x16x32_bf16 v[116:119], v[52:55], v[16:19], v[116:119]
    ds_read_b64_tr_b16 v[74:75], v9 offset:27648
    s_add_u32 m0, s34, 49152
    s_nop 0
    buffer_load_dwordx4 v3, s[12:15], s37 offen lds
    v_mfma_f32_16x16x32_bf16 v[120:123], v[32:35], v[20:23], v[120:123]
    ds_read_b64_tr_b16 v[76:77], v9 offset:36864
    v_mfma_f32_16x16x32_bf16 v[124:127], v[36:39], v[20:23], v[124:127]
    ds_read_b64_tr_b16 v[78:79], v9 offset:39936
    v_mfma_f32_16x16x32_bf16 v[128:131], v[40:43], v[20:23], v[128:131]
    ds_read_b64_tr_b16 v[80:81], v9 offset:24704
    v_mfma_f32_16x16x32_bf16 v[132:135], v[44:47], v[20:23], v[132:135]
    ds_read_b64_tr_b16 v[82:83], v9 offset:27776
    v_mfma_f32_16x16x32_bf16 v[136:139], v[48:51], v[20:23], v[136:139]
    ds_read_b64_tr_b16 v[84:85], v9 offset:36992
    s_add_u32 m0, s35, 49152
    s_nop 0
    buffer_load_dwordx4 v4, s[12:15], s37 offen lds
    v_mfma_f32_16x16x32_bf16 v[140:143], v[52:55], v[20:23], v[140:143]
    ds_read_b64_tr_b16 v[86:87], v9 offset:40064
    v_mfma_f32_16x16x32_bf16 v[144:147], v[32:35], v[24:27], v[144:147]
    ds_read_b64_tr_b16 v[88:89], v9 offset:24832
    v_mfma_f32_16x16x32_bf16 v[148:151], v[36:39], v[24:27], v[148:151]
    ds_read_b64_tr_b16 v[90:91], v9 offset:27904
    v_mfma_f32_16x16x32_bf16 v[152:155], v[40:43], v[24:27], v[152:155]
    ds_read_b64_tr_b16 v[92:93], v9 offset:37120
    s_add_u32 m0, s32, 0
    s_mov_b32 s36, 768
    buffer_load_dwordx4 v1, s[8:11], s36 offen lds
    v_mfma_f32_16x16x32_bf16 v[156:159], v[44:47], v[24:27], v[156:159]
    ds_read_b64_tr_b16 v[94:95], v9 offset:40192
    v_mfma_f32_16x16x32_bf16 v[160:163], v[48:51], v[24:27], v[160:163]
    v_mfma_f32_16x16x32_bf16 v[164:167], v[52:55], v[24:27], v[164:167]
    v_mfma_f32_16x16x32_bf16 v[168:171], v[32:35], v[28:31], v[168:171]
    v_mfma_f32_16x16x32_bf16 v[172:175], v[36:39], v[28:31], v[172:175]
    s_add_u32 m0, s32, 8192
    s_mov_b32 s36, 82688
    buffer_load_dwordx4 v1, s[8:11], s36 offen lds
    v_mfma_f32_16x16x32_bf16 v[176:179], v[40:43], v[28:31], v[176:179]
    v_mfma_f32_16x16x32_bf16 v[180:183], v[44:47], v[28:31], v[180:183]
    v_mfma_f32_16x16x32_bf16 v[184:187], v[48:51], v[28:31], v[184:187]
    v_mfma_f32_16x16x32_bf16 v[188:191], v[52:55], v[28:31], v[188:191]
    s_waitcnt vmcnt(10) lgkmcnt(0)
    s_barrier
    v_mfma_f32_16x16x32_bf16 v[96:99], v[72:75], v[56:59], v[96:99]
    ds_read_b128 v[16:19], v5 offset:32768
    s_add_u32 s37, s37, s38
    s_add_u32 m0, s33, 73728
    s_nop 0
    buffer_load_dwordx4 v2, s[12:15], s37 offen lds
    v_mfma_f32_16x16x32_bf16 v[100:103], v[76:79], v[56:59], v[100:103]
    ds_read_b128 v[20:23], v5 offset:34816
    v_mfma_f32_16x16x32_bf16 v[104:107], v[80:83], v[56:59], v[104:107]
    ds_read_b128 v[24:27], v6 offset:32768
    v_mfma_f32_16x16x32_bf16 v[108:111], v[84:87], v[56:59], v[108:111]
    ds_read_b128 v[28:31], v6 offset:34816
    v_mfma_f32_16x16x32_bf16 v[112:115], v[88:91], v[56:59], v[112:115]
    ds_read_b64_tr_b16 v[32:33], v10 offset:0
    v_mfma_f32_16x16x32_bf16 v[116:119], v[92:95], v[56:59], v[116:119]
    ds_read_b64_tr_b16 v[34:35], v10 offset:3072
    v_mfma_f32_16x16x32_bf16 v[120:123], v[72:75], v[60:63], v[120:123]
    ds_read_b64_tr_b16 v[36:37], v10 offset:12288
    v_mfma_f32_16x16x32_bf16 v[124:127], v[76:79], v[60:63], v[124:127]
    ds_read_b64_tr_b16 v[38:39], v10 offset:15360
    v_mfma_f32_16x16x32_bf16 v[128:131], v[80:83], v[60:63], v[128:131]
    ds_read_b64_tr_b16 v[40:41], v10 offset:128
    s_add_u32 m0, s34, 73728
    s_nop 0
    buffer_load_dwordx4 v3, s[12:15], s37 offen lds
    v_mfma_f32_16x16x32_bf16 v[132:135], v[84:87], v[60:63], v[132:135]
    ds_read_b64_tr_b16 v[42:43], v10 offset:3200
    v_mfma_f32_16x16x32_bf16 v[136:139], v[88:91], v[60:63], v[136:139]
    ds_read_b64_tr_b16 v[44:45], v10 offset:12416
    v_mfma_f32_16x16x32_bf16 v[140:143], v[92:95], v[60:63], v[140:143]
    ds_read_b64_tr_b16 v[46:47], v10 offset:15488
    v_mfma_f32_16x16x32_bf16 v[144:147], v[72:75], v[64:67], v[144:147]
    ds_read_b64_tr_b16 v[48:49], v10 offset:256
    v_mfma_f32_16x16x32_bf16 v[148:151], v[76:79], v[64:67], v[148:151]
    ds_read_b64_tr_b16 v[50:51], v10 offset:3328
    v_mfma_f32_16x16x32_bf16 v[152:155], v[80:83], v[64:67], v[152:155]
    ds_read_b64_tr_b16 v[52:53], v10 offset:12544
    v_mfma_f32_16x16x32_bf16 v[156:159], v[84:87], v[64:67], v[156:159]
    ds_read_b64_tr_b16 v[54:55], v10 offset:15616
    v_mfma_f32_16x16x32_bf16 v[160:163], v[88:91], v[64:67], v[160:163]
    s_add_u32 m0, s35, 73728
    s_nop 0
    buffer_load_dwordx4 v4, s[12:15], s37 offen lds
    v_mfma_f32_16x16x32_bf16 v[164:167], v[92:95], v[64:67], v[164:167]
    v_mfma_f32_16x16x32_bf16 v[168:171], v[72:75], v[68:71], v[168:171]
    v_mfma_f32_16x16x32_bf16 v[172:175], v[76:79], v[68:71], v[172:175]
    v_mfma_f32_16x16x32_bf16 v[176:179], v[80:83], v[68:71], v[176:179]
    v_mfma_f32_16x16x32_bf16 v[180:183], v[84:87], v[68:71], v[180:183]
    v_mfma_f32_16x16x32_bf16 v[184:187], v[88:91], v[68:71], v[184:187]
    v_mfma_f32_16x16x32_bf16 v[188:191], v[92:95], v[68:71], v[188:191]
    s_waitcnt vmcnt(10) lgkmcnt(0)
    s_barrier
    v_mfma_f32_16x16x32_bf16 v[96:99], v[32:35], v[16:19], v[96:99]
    ds_read_b128 v[56:59], v7 offset:32768
    s_add_u32 s37, s37, s38
    s_add_u32 m0, s33, 98304
    s_nop 0
    buffer_load_dwordx4 v2, s[12:15], s37 offen lds
    v_mfma_f32_16x16x32_bf16 v[100:103], v[36:39], v[16:19], v[100:103]
    ds_read_b128 v[60:63], v7 offset:34816
    v_mfma_f32_16x16x32_bf16 v[104:107], v[40:43], v[16:19], v[104:107]
    ds_read_b128 v[64:67], v8 offset:32768
    v_mfma_f32_16x16x32_bf16 v[108:111], v[44:47], v[16:19], v[108:111]
    ds_read_b128 v[68:71], v8 offset:34816
    v_mfma_f32_16x16x32_bf16 v[112:115], v[48:51], v[16:19], v[112:115]
    ds_read_b64_tr_b16 v[72:73], v10 offset:24576
    v_mfma_f32_16x16x32_bf16 v[116:119], v[52:55], v[16:19], v[116:119]
    ds_read_b64_tr_b16 v[74:75], v10 offset:27648
    s_add_u32 m0, s34, 98304
    s_nop 0
    buffer_load_dwordx4 v3, s[12:15], s37 offen lds
    v_mfma_f32_16x16x32_bf16 v[120:123], v[32:35], v[20:23], v[120:123]
    ds_read_b64_tr_b16 v[76:77], v10 offset:36864
    v_mfma_f32_16x16x32_bf16 v[124:127], v[36:39], v[20:23], v[124:127]
    ds_read_b64_tr_b16 v[78:79], v10 offset:39936
    v_mfma_f32_16x16x32_bf16 v[128:131], v[40:43], v[20:23], v[128:131]
    ds_read_b64_tr_b16 v[80:81], v10 offset:24704
    v_mfma_f32_16x16x32_bf16 v[132:135], v[44:47], v[20:23], v[132:135]
    ds_read_b64_tr_b16 v[82:83], v10 offset:27776
    v_mfma_f32_16x16x32_bf16 v[136:139], v[48:51], v[20:23], v[136:139]
    ds_read_b64_tr_b16 v[84:85], v10 offset:36992
    s_add_u32 m0, s35, 98304
    s_nop 0
    buffer_load_dwordx4 v4, s[12:15], s37 offen lds
    v_mfma_f32_16x16x32_bf16 v[140:143], v[52:55], v[20:23], v[140:143]
    ds_read_b64_tr_b16 v[86:87], v10 offset:40064
    v_mfma_f32_16x16x32_bf16 v[144:147], v[32:35], v[24:27], v[144:147]
    ds_read_b64_tr_b16 v[88:89], v10 offset:24832
    v_mfma_f32_16x16x32_bf16 v[148:151], v[36:39], v[24:27], v[148:151]
    ds_read_b64_tr_b16 v[90:91], v10 offset:27904
    v_mfma_f32_16x16x32_bf16 v[152:155], v[40:43], v[24:27], v[152:155]
    ds_read_b64_tr_b16 v[92:93], v10 offset:37120
    s_add_u32 m0, s32, 16384
    s_mov_b32 s36, 896
    buffer_load_dwordx4 v1, s[8:11], s36 offen lds
    v_mfma_f32_16x16x32_bf16 v[156:159], v[44:47], v[24:27], v[156:159]
    ds_read_b64_tr_b16 v[94:95], v10 offset:40192
    v_mfma_f32_16x16x32_bf16 v[160:163], v[48:51], v[24:27], v[160:163]
    v_mfma_f32_16x16x32_bf16 v[164:167], v[52:55], v[24:27], v[164:167]
    v_mfma_f32_16x16x32_bf16 v[168:171], v[32:35], v[28:31], v[168:171]
    v_mfma_f32_16x16x32_bf16 v[172:175], v[36:39], v[28:31], v[172:175]
    s_add_u32 m0, s32, 24576
    s_mov_b32 s36, 82816
    buffer_load_dwordx4 v1, s[8:11], s36 offen lds
    v_mfma_f32_16x16x32_bf16 v[176:179], v[40:43], v[28:31], v[176:179]
    v_mfma_f32_16x16x32_bf16 v[180:183], v[44:47], v[28:31], v[180:183]
    v_mfma_f32_16x16x32_bf16 v[184:187], v[48:51], v[28:31], v[184:187]
    v_mfma_f32_16x16x32_bf16 v[188:191], v[52:55], v[28:31], v[188:191]
    s_waitcnt vmcnt(8) lgkmcnt(0)
    s_barrier
    v_mfma_f32_16x16x32_bf16 v[96:99], v[72:75], v[56:59], v[96:99]
    ds_read_b128 v[16:19], v5 offset:0
    s_add_u32 s37, s37, s38
    s_add_u32 m0, s33, 122880
    s_nop 0
    buffer_load_dwordx4 v2, s[12:15], s37 offen lds
    v_mfma_f32_16x16x32_bf16 v[100:103], v[76:79], v[56:59], v[100:103]
    ds_read_b128 v[20:23], v5 offset:2048
    v_mfma_f32_16x16x32_bf16 v[104:107], v[80:83], v[56:59], v[104:107]
    ds_read_b128 v[24:27], v6 offset:0
    v_mfma_f32_16x16x32_bf16 v[108:111], v[84:87], v[56:59], v[108:111]
    ds_read_b128 v[28:31], v6 offset:2048
    v_mfma_f32_16x16x32_bf16 v[112:115], v[88:91], v[56:59], v[112:115]
    ds_read_b64_tr_b16 v[32:33], v9 offset:0
    v_mfma_f32_16x16x32_bf16 v[116:119], v[92:95], v[56:59], v[116:119]
    ds_read_b64_tr_b16 v[34:35], v9 offset:3072
    v_mfma_f32_16x16x32_bf16 v[120:123], v[72:75], v[60:63], v[120:123]
    ds_read_b64_tr_b16 v[36:37], v9 offset:12288
    s_add_u32 m0, s34, 122880
    s_nop 0
    buffer_load_dwordx4 v3, s[12:15], s37 offen lds
    v_mfma_f32_16x16x32_bf16 v[124:127], v[76:79], v[60:63], v[124:127]
    ds_read_b64_tr_b16 v[38:39], v9 offset:15360
    v_mfma_f32_16x16x32_bf16 v[128:131], v[80:83], v[60:63], v[128:131]
    ds_read_b64_tr_b16 v[40:41], v9 offset:128
    v_mfma_f32_16x16x32_bf16 v[132:135], v[84:87], v[60:63], v[132:135]
    ds_read_b64_tr_b16 v[42:43], v9 offset:3200
    v_mfma_f32_16x16x32_bf16 v[136:139], v[88:91], v[60:63], v[136:139]
    ds_read_b64_tr_b16 v[44:45], v9 offset:12416
    v_mfma_f32_16x16x32_bf16 v[140:143], v[92:95], v[60:63], v[140:143]
    ds_read_b64_tr_b16 v[46:47], v9 offset:15488
    v_mfma_f32_16x16x32_bf16 v[144:147], v[72:75], v[64:67], v[144:147]
    ds_read_b64_tr_b16 v[48:49], v9 offset:256
    s_add_u32 m0, s35, 122880
    s_nop 0
    buffer_load_dwordx4 v4, s[12:15], s37 offen lds
    v_mfma_f32_16x16x32_bf16 v[148:151], v[76:79], v[64:67], v[148:151]
    ds_read_b64_tr_b16 v[50:51], v9 offset:3328
    v_mfma_f32_16x16x32_bf16 v[152:155], v[80:83], v[64:67], v[152:155]
    ds_read_b64_tr_b16 v[52:53], v9 offset:12544
    v_mfma_f32_16x16x32_bf16 v[156:159], v[84:87], v[64:67], v[156:159]
    ds_read_b64_tr_b16 v[54:55], v9 offset:15616
    v_mfma_f32_16x16x32_bf16 v[160:163], v[88:91], v[64:67], v[160:163]
    v_mfma_f32_16x16x32_bf16 v[164:167], v[92:95], v[64:67], v[164:167]
    v_mfma_f32_16x16x32_bf16 v[168:171], v[72:75], v[68:71], v[168:171]
    s_mul_i32 s25, s38, 16
    buffer_load_dword v242, v240, s[12:15], s25 offen
    v_mfma_f32_16x16x32_bf16 v[172:175], v[76:79], v[68:71], v[172:175]
    v_mfma_f32_16x16x32_bf16 v[176:179], v[80:83], v[68:71], v[176:179]
    v_mfma_f32_16x16x32_bf16 v[180:183], v[84:87], v[68:71], v[180:183]
    v_mfma_f32_16x16x32_bf16 v[184:187], v[88:91], v[68:71], v[184:187]
    v_mfma_f32_16x16x32_bf16 v[188:191], v[92:95], v[68:71], v[188:191]
    s_waitcnt vmcnt(9) lgkmcnt(0)
    s_barrier
    v_mfma_f32_16x16x32_bf16 v[96:99], v[32:35], v[16:19], v[96:99]
    ds_read_b128 v[56:59], v7 offset:0
    s_add_u32 s37, s37, s38
    s_add_u32 m0, s33, 49152
    s_nop 0
    buffer_load_dwordx4 v2, s[12:15], s37 offen lds
    v_mfma_f32_16x16x32_bf16 v[100:103], v[36:39], v[16:19], v[100:103]
    ds_read_b128 v[60:63], v7 offset:2048
    v_mfma_f32_16x16x32_bf16 v[104:107], v[40:43], v[16:19], v[104:107]
    ds_read_b128 v[64:67], v8 offset:0
    s_add_u32 m0, s34, 49152
    s_nop 0
    buffer_load_dwordx4 v3, s[12:15], s37 offen lds
    v_mfma_f32_16x16x32_bf16 v[108:111], v[44:47], v[16:19], v[108:111]
    ds_read_b128 v[68:71], v8 offset:2048
    v_mfma_f32_16x16x32_bf16 v[112:115], v[48:51], v[16:19], v[112:115]
    ds_read_b64_tr_b16 v[72:73], v9 offset:24576
    s_add_u32 m0, s35, 49152
    s_nop 0
    buffer_load_dwordx4 v4, s[12:15], s37 offen lds
    v_mfma_f32_16x16x32_bf16 v[116:119], v[52:55], v[16:19], v[116:119]
    ds_read_b64_tr_b16 v[74:75], v9 offset:27648
    s_add_u32 m0, s32, 32768
    s_mov_b32 s36, 1024
    buffer_load_dwordx4 v1, s[8:11], s36 offen lds
    v_mfma_f32_16x16x32_bf16 v[120:123], v[32:35], v[20:23], v[120:123]
    ds_read_b64_tr_b16 v[76:77], v9 offset:36864
    v_mfma_f32_16x16x32_bf16 v[124:127], v[36:39], v[20:23], v[124:127]
    ds_read_b64_tr_b16 v[78:79], v9 offset:39936
    s_add_u32 m0, s32, 40960
    s_mov_b32 s36, 82944
    buffer_load_dwordx4 v1, s[8:11], s36 offen lds
    v_mfma_f32_16x16x32_bf16 v[128:131], v[40:43], v[20:23], v[128:131]
    ds_read_b64_tr_b16 v[80:81], v9 offset:24704
    v_mfma_f32_16x16x32_bf16 v[132:135], v[44:47], v[20:23], v[132:135]
    ds_read_b64_tr_b16 v[82:83], v9 offset:27776
    s_lshl_b32 s26, s20, 1
    s_add_u32 s26, s26, s22
    s_mul_i32 s26, s26, 303104
    v_mfma_f32_16x16x32_bf16 v[136:139], v[48:51], v[20:23], v[136:139]
    ds_read_b64_tr_b16 v[84:85], v9 offset:36992
    s_add_u32 s26, s26, 8388608
    s_add_u32 s16, s4, s26
    s_addc_u32 s17, s5, 0
    v_mfma_f32_16x16x32_bf16 v[140:143], v[52:55], v[20:23], v[140:143]
    ds_read_b64_tr_b16 v[86:87], v9 offset:40064
    v_mfma_f32_16x16x32_bf16 v[144:147], v[32:35], v[24:27], v[144:147]
    ds_read_b64_tr_b16 v[88:89], v9 offset:24832
    s_mov_b32 s18, 303104
    s_lshl_b32 s24, s21, 2
    s_add_u32 s24, s24, s23
    v_mfma_f32_16x16x32_bf16 v[148:151], v[36:39], v[24:27], v[148:151]
    ds_read_b64_tr_b16 v[90:91], v9 offset:27904
    v_mfma_f32_16x16x32_bf16 v[152:155], v[40:43], v[24:27], v[152:155]
    ds_read_b64_tr_b16 v[92:93], v9 offset:37120
    s_lshl_b32 s24, s24, 12
    s_lshl_b32 s25, s21, 1
    s_lshr_b32 s26, s23, 1
    v_mfma_f32_16x16x32_bf16 v[156:159], v[44:47], v[24:27], v[156:159]
    ds_read_b64_tr_b16 v[94:95], v9 offset:40192
    s_add_u32 s25, s25, s26
    s_add_u32 s25, s25, 36
    s_lshl_b32 s25, s25, 3
    v_mfma_f32_16x16x32_bf16 v[160:163], v[48:51], v[24:27], v[160:163]
    v_mfma_f32_16x16x32_bf16 v[164:167], v[52:55], v[24:27], v[164:167]
    s_and_b32 s26, s23, 1
    s_add_u32 s25, s25, s26
    s_lshl_b32 s25, s25, 9
    v_mfma_f32_16x16x32_bf16 v[168:171], v[32:35], v[28:31], v[168:171]
    v_mfma_f32_16x16x32_bf16 v[172:175], v[36:39], v[28:31], v[172:175]
    v_lshlrev_b32 v13, 4, v0
    v_add_u32 v216, s24, v13
    v_xor_b32 v217, 2048, v216
    v_mfma_f32_16x16x32_bf16 v[176:179], v[40:43], v[28:31], v[176:179]
    v_and_b32 v218, 512, v13
    v_add3_u32 v218, v218, v13, s25
    s_mov_b32 s60, 0xbdd2d3e8
    v_mfma_f32_16x16x32_bf16 v[180:183], v[44:47], v[28:31], v[180:183]
    v_mfma_f32_16x16x32_bf16 v[184:187], v[48:51], v[28:31], v[184:187]
    s_mov_b32 s61, 0xbdd2d3e8
    v_mov_b32 v220, 0xc0135761
    v_mov_b32 v221, 0xc0135761
    v_mfma_f32_16x16x32_bf16 v[188:191], v[52:55], v[28:31], v[188:191]
    s_waitcnt vmcnt(9) lgkmcnt(0)
    s_barrier
    v_mfma_f32_16x16x32_bf16 v[96:99], v[72:75], v[56:59], v[96:99]
    ds_read_b128 v[16:19], v5 offset:16384
    s_add_u32 s37, s37, s38
    s_add_u32 m0, s33, 73728
    s_nop 0
    buffer_load_dwordx4 v2, s[12:15], s37 offen lds
    v_mfma_f32_16x16x32_bf16 v[100:103], v[76:79], v[56:59], v[100:103]
    ds_read_b128 v[20:23], v5 offset:18432
    v_mfma_f32_16x16x32_bf16 v[104:107], v[80:83], v[56:59], v[104:107]
    ds_read_b128 v[24:27], v6 offset:16384
    v_mfma_f32_16x16x32_bf16 v[108:111], v[84:87], v[56:59], v[108:111]
    ds_read_b128 v[28:31], v6 offset:18432
    v_mfma_f32_16x16x32_bf16 v[112:115], v[88:91], v[56:59], v[112:115]
    ds_read_b64_tr_b16 v[32:33], v10 offset:0
    v_mfma_f32_16x16x32_bf16 v[116:119], v[92:95], v[56:59], v[116:119]
    ds_read_b64_tr_b16 v[34:35], v10 offset:3072
    v_mfma_f32_16x16x32_bf16 v[120:123], v[72:75], v[60:63], v[120:123]
    ds_read_b64_tr_b16 v[36:37], v10 offset:12288
    v_mfma_f32_16x16x32_bf16 v[124:127], v[76:79], v[60:63], v[124:127]
    ds_read_b64_tr_b16 v[38:39], v10 offset:15360
    v_mfma_f32_16x16x32_bf16 v[128:131], v[80:83], v[60:63], v[128:131]
    ds_read_b64_tr_b16 v[40:41], v10 offset:128
    s_add_u32 m0, s34, 73728
    s_nop 0
    buffer_load_dwordx4 v3, s[12:15], s37 offen lds
    v_mfma_f32_16x16x32_bf16 v[132:135], v[84:87], v[60:63], v[132:135]
    ds_read_b64_tr_b16 v[42:43], v10 offset:3200
    v_mfma_f32_16x16x32_bf16 v[136:139], v[88:91], v[60:63], v[136:139]
    ds_read_b64_tr_b16 v[44:45], v10 offset:12416
    v_mfma_f32_16x16x32_bf16 v[140:143], v[92:95], v[60:63], v[140:143]
    ds_read_b64_tr_b16 v[46:47], v10 offset:15488
    v_mfma_f32_16x16x32_bf16 v[144:147], v[72:75], v[64:67], v[144:147]
    ds_read_b64_tr_b16 v[48:49], v10 offset:256
    v_mfma_f32_16x16x32_bf16 v[148:151], v[76:79], v[64:67], v[148:151]
    ds_read_b64_tr_b16 v[50:51], v10 offset:3328
    v_mfma_f32_16x16x32_bf16 v[152:155], v[80:83], v[64:67], v[152:155]
    ds_read_b64_tr_b16 v[52:53], v10 offset:12544
    v_mfma_f32_16x16x32_bf16 v[156:159], v[84:87], v[64:67], v[156:159]
    ds_read_b64_tr_b16 v[54:55], v10 offset:15616
    v_mfma_f32_16x16x32_bf16 v[160:163], v[88:91], v[64:67], v[160:163]
    s_add_u32 m0, s35, 73728
    s_nop 0
    buffer_load_dwordx4 v4, s[12:15], s37 offen lds
    v_mfma_f32_16x16x32_bf16 v[164:167], v[92:95], v[64:67], v[164:167]
    v_mfma_f32_16x16x32_bf16 v[168:171], v[72:75], v[68:71], v[168:171]
    v_mfma_f32_16x16x32_bf16 v[172:175], v[76:79], v[68:71], v[172:175]
    v_mfma_f32_16x16x32_bf16 v[176:179], v[80:83], v[68:71], v[176:179]
    v_mfma_f32_16x16x32_bf16 v[180:183], v[84:87], v[68:71], v[180:183]
    v_mfma_f32_16x16x32_bf16 v[184:187], v[88:91], v[68:71], v[184:187]
    v_mfma_f32_16x16x32_bf16 v[188:191], v[92:95], v[68:71], v[188:191]
    s_waitcnt vmcnt(9) lgkmcnt(0)
    s_barrier
    v_mfma_f32_16x16x32_bf16 v[96:99], v[32:35], v[16:19], v[96:99]
    ds_read_b128 v[56:59], v7 offset:16384
    s_add_u32 s37, s37, s38
    s_add_u32 m0, s33, 98304
    s_nop 0
    buffer_load_dwordx4 v2, s[12:15], s37 offen lds
    v_mfma_f32_16x16x32_bf16 v[100:103], v[36:39], v[16:19], v[100:103]
    ds_read_b128 v[60:63], v7 offset:18432
    v_mfma_f32_16x16x32_bf16 v[104:107], v[40:43], v[16:19], v[104:107]
    ds_read_b128 v[64:67], v8 offset:16384
    v_mfma_f32_16x16x32_bf16 v[108:111], v[44:47], v[16:19], v[108:111]
    ds_read_b128 v[68:71], v8 offset:18432
    v_mfma_f32_16x16x32_bf16 v[112:115], v[48:51], v[16:19], v[112:115]
    ds_read_b64_tr_b16 v[72:73], v10 offset:24576
    v_mfma_f32_16x16x32_bf16 v[116:119], v[52:55], v[16:19], v[116:119]
    ds_read_b64_tr_b16 v[74:75], v10 offset:27648
    s_add_u32 m0, s34, 98304
    s_nop 0
    buffer_load_dwordx4 v3, s[12:15], s37 offen lds
    v_mfma_f32_16x16x32_bf16 v[120:123], v[32:35], v[20:23], v[120:123]
    ds_read_b64_tr_b16 v[76:77], v10 offset:36864
    v_mfma_f32_16x16x32_bf16 v[124:127], v[36:39], v[20:23], v[124:127]
    ds_read_b64_tr_b16 v[78:79], v10 offset:39936
    v_mfma_f32_16x16x32_bf16 v[128:131], v[40:43], v[20:23], v[128:131]
    ds_read_b64_tr_b16 v[80:81], v10 offset:24704
    v_mfma_f32_16x16x32_bf16 v[132:135], v[44:47], v[20:23], v[132:135]
    ds_read_b64_tr_b16 v[82:83], v10 offset:27776
    v_mfma_f32_16x16x32_bf16 v[136:139], v[48:51], v[20:23], v[136:139]
    ds_read_b64_tr_b16 v[84:85], v10 offset:36992
    s_add_u32 m0, s35, 98304
    s_nop 0
    buffer_load_dwordx4 v4, s[12:15], s37 offen lds
    v_mfma_f32_16x16x32_bf16 v[140:143], v[52:55], v[20:23], v[140:143]
    ds_read_b64_tr_b16 v[86:87], v10 offset:40064
    v_mfma_f32_16x16x32_bf16 v[144:147], v[32:35], v[24:27], v[144:147]
    ds_read_b64_tr_b16 v[88:89], v10 offset:24832
    v_mfma_f32_16x16x32_bf16 v[148:151], v[36:39], v[24:27], v[148:151]
    ds_read_b64_tr_b16 v[90:91], v10 offset:27904
    v_mfma_f32_16x16x32_bf16 v[152:155], v[40:43], v[24:27], v[152:155]
    ds_read_b64_tr_b16 v[92:93], v10 offset:37120
    s_add_u32 m0, s32, 0
    s_mov_b32 s36, 1152
    buffer_load_dwordx4 v1, s[8:11], s36 offen lds
    v_mfma_f32_16x16x32_bf16 v[156:159], v[44:47], v[24:27], v[156:159]
    ds_read_b64_tr_b16 v[94:95], v10 offset:40192
    v_mfma_f32_16x16x32_bf16 v[160:163], v[48:51], v[24:27], v[160:163]
    v_mfma_f32_16x16x32_bf16 v[164:167], v[52:55], v[24:27], v[164:167]
    v_mfma_f32_16x16x32_bf16 v[168:171], v[32:35], v[28:31], v[168:171]
    v_mfma_f32_16x16x32_bf16 v[172:175], v[36:39], v[28:31], v[172:175]
    s_add_u32 m0, s32, 8192
    s_mov_b32 s36, 83072
    buffer_load_dwordx4 v1, s[8:11], s36 offen lds
    v_mfma_f32_16x16x32_bf16 v[176:179], v[40:43], v[28:31], v[176:179]
    v_mfma_f32_16x16x32_bf16 v[180:183], v[44:47], v[28:31], v[180:183]
    v_mfma_f32_16x16x32_bf16 v[184:187], v[48:51], v[28:31], v[184:187]
    v_mfma_f32_16x16x32_bf16 v[188:191], v[52:55], v[28:31], v[188:191]
    s_waitcnt vmcnt(8) lgkmcnt(0)
    s_barrier
    v_mfma_f32_16x16x32_bf16 v[96:99], v[72:75], v[56:59], v[96:99]
    ds_read_b128 v[16:19], v5 offset:32768
    s_add_u32 s37, s37, s38
    s_add_u32 m0, s33, 122880
    s_nop 0
    buffer_load_dwordx4 v2, s[12:15], s37 offen lds
    v_mfma_f32_16x16x32_bf16 v[100:103], v[76:79], v[56:59], v[100:103]
    ds_read_b128 v[20:23], v5 offset:34816
    v_mfma_f32_16x16x32_bf16 v[104:107], v[80:83], v[56:59], v[104:107]
    ds_read_b128 v[24:27], v6 offset:32768
    v_mfma_f32_16x16x32_bf16 v[108:111], v[84:87], v[56:59], v[108:111]
    ds_read_b128 v[28:31], v6 offset:34816
    v_mfma_f32_16x16x32_bf16 v[112:115], v[88:91], v[56:59], v[112:115]
    ds_read_b64_tr_b16 v[32:33], v9 offset:0
    v_mfma_f32_16x16x32_bf16 v[116:119], v[92:95], v[56:59], v[116:119]
    ds_read_b64_tr_b16 v[34:35], v9 offset:3072
    v_mfma_f32_16x16x32_bf16 v[120:123], v[72:75], v[60:63], v[120:123]
    ds_read_b64_tr_b16 v[36:37], v9 offset:12288
    v_mfma_f32_16x16x32_bf16 v[124:127], v[76:79], v[60:63], v[124:127]
    ds_read_b64_tr_b16 v[38:39], v9 offset:15360
    v_mfma_f32_16x16x32_bf16 v[128:131], v[80:83], v[60:63], v[128:131]
    ds_read_b64_tr_b16 v[40:41], v9 offset:128
    s_add_u32 m0, s34, 122880
    s_nop 0
    buffer_load_dwordx4 v3, s[12:15], s37 offen lds
    v_mfma_f32_16x16x32_bf16 v[132:135], v[84:87], v[60:63], v[132:135]
    ds_read_b64_tr_b16 v[42:43], v9 offset:3200
    v_mfma_f32_16x16x32_bf16 v[136:139], v[88:91], v[60:63], v[136:139]
    ds_read_b64_tr_b16 v[44:45], v9 offset:12416
    v_mfma_f32_16x16x32_bf16 v[140:143], v[92:95], v[60:63], v[140:143]
    ds_read_b64_tr_b16 v[46:47], v9 offset:15488
    v_mfma_f32_16x16x32_bf16 v[144:147], v[72:75], v[64:67], v[144:147]
    ds_read_b64_tr_b16 v[48:49], v9 offset:256
    v_mfma_f32_16x16x32_bf16 v[148:151], v[76:79], v[64:67], v[148:151]
    ds_read_b64_tr_b16 v[50:51], v9 offset:3328
    v_mfma_f32_16x16x32_bf16 v[152:155], v[80:83], v[64:67], v[152:155]
    ds_read_b64_tr_b16 v[52:53], v9 offset:12544
    v_mfma_f32_16x16x32_bf16 v[156:159], v[84:87], v[64:67], v[156:159]
    ds_read_b64_tr_b16 v[54:55], v9 offset:15616
    v_mfma_f32_16x16x32_bf16 v[160:163], v[88:91], v[64:67], v[160:163]
    s_add_u32 m0, s35, 122880
    s_nop 0
    buffer_load_dwordx4 v4, s[12:15], s37 offen lds
    v_mfma_f32_16x16x32_bf16 v[164:167], v[92:95], v[64:67], v[164:167]
    v_mfma_f32_16x16x32_bf16 v[168:171], v[72:75], v[68:71], v[168:171]
    v_mfma_f32_16x16x32_bf16 v[172:175], v[76:79], v[68:71], v[172:175]
    v_mfma_f32_16x16x32_bf16 v[176:179], v[80:83], v[68:71], v[176:179]
    v_mfma_f32_16x16x32_bf16 v[180:183], v[84:87], v[68:71], v[180:183]
    v_mfma_f32_16x16x32_bf16 v[184:187], v[88:91], v[68:71], v[184:187]
    v_mfma_f32_16x16x32_bf16 v[188:191], v[92:95], v[68:71], v[188:191]
    s_waitcnt vmcnt(8) lgkmcnt(0)
    s_barrier
    v_mfma_f32_16x16x32_bf16 v[96:99], v[32:35], v[16:19], v[96:99]
    ds_read_b128 v[56:59], v7 offset:32768
    v_mov_b32 v255, 0
    global_load_dword v255, v255, s[6:7] sc1
    v_mfma_f32_16x16x32_bf16 v[100:103], v[36:39], v[16:19], v[100:103]
    ds_read_b128 v[60:63], v7 offset:34816
    v_mfma_f32_16x16x32_bf16 v[104:107], v[40:43], v[16:19], v[104:107]
    ds_read_b128 v[64:67], v8 offset:32768
    s_and_b32 s25, s2, 7
    s_lshr_b32 s26, s2, 3
    s_lshl_b32 s21, s25, 2
    v_mfma_f32_16x16x32_bf16 v[108:111], v[44:47], v[16:19], v[108:111]
    ds_read_b128 v[68:71], v8 offset:34816
    v_mfma_f32_16x16x32_bf16 v[112:115], v[48:51], v[16:19], v[112:115]
    ds_read_b64_tr_b16 v[72:73], v9 offset:24576
    s_and_b32 s25, s26, 3
    s_add_u32 s21, s21, s25
    s_lshr_b32 s22, s26, 2
    v_mfma_f32_16x16x32_bf16 v[116:119], v[52:55], v[16:19], v[116:119]
    ds_read_b64_tr_b16 v[74:75], v9 offset:27648
    v_mfma_f32_16x16x32_bf16 v[120:123], v[32:35], v[20:23], v[120:123]
    ds_read_b64_tr_b16 v[76:77], v9 offset:36864
    s_and_b32 s23, s3, 3
    s_lshr_b32 s24, s3, 2
    s_lshl_b32 s30, s22, 2
    v_mfma_f32_16x16x32_bf16 v[124:127], v[36:39], v[20:23], v[124:127]
    ds_read_b64_tr_b16 v[78:79], v9 offset:39936
    v_mfma_f32_16x16x32_bf16 v[128:131], v[40:43], v[20:23], v[128:131]
    ds_read_b64_tr_b16 v[80:81], v9 offset:24704
    s_add_u32 s30, s30, s23
    v_lshlrev_b32 v14, 4, v0
    v_and_b32 v11, 31, v0
    v_mfma_f32_16x16x32_bf16 v[132:135], v[44:47], v[20:23], v[132:135]
    ds_read_b64_tr_b16 v[82:83], v9 offset:27776
    v_lshlrev_b32 v3, 3, v11
    v_lshrrev_b32 v13, 5, v0
    v_mul_u32_u24 v4, 320, v13
    v_mfma_f32_16x16x32_bf16 v[136:139], v[48:51], v[20:23], v[136:139]
    ds_read_b64_tr_b16 v[84:85], v9 offset:36992
    v_mfma_f32_16x16x32_bf16 v[140:143], v[52:55], v[20:23], v[140:143]
    ds_read_b64_tr_b16 v[86:87], v9 offset:40064
    v_lshl_add_u32 v4, v11, 4, v4
    v_lshl_add_u32 v12, v13, 20, v3
    s_mul_i32 s25, s21, 163840
    v_mfma_f32_16x16x32_bf16 v[144:147], v[32:35], v[24:27], v[144:147]
    ds_read_b64_tr_b16 v[88:89], v9 offset:24832
    v_mfma_f32_16x16x32_bf16 v[148:151], v[36:39], v[24:27], v[148:151]
    ds_read_b64_tr_b16 v[90:91], v9 offset:27904
    s_lshl_b32 s26, s21, 5
    s_add_u32 s26, s26, s30
    s_mul_i32 s26, s26, 2560
    v_mfma_f32_16x16x32_bf16 v[152:155], v[40:43], v[24:27], v[152:155]
    ds_read_b64_tr_b16 v[92:93], v9 offset:37120
    v_mfma_f32_16x16x32_bf16 v[156:159], v[44:47], v[24:27], v[156:159]
    ds_read_b64_tr_b16 v[94:95], v9 offset:40192
    s_add_u32 s26, s26, 5242880
    s_mov_b32 s10, 163840
    s_mov_b32 s11, 0x00020000
    v_mfma_f32_16x16x32_bf16 v[160:163], v[48:51], v[24:27], v[160:163]
    s_mov_b32 s14, 2560
    s_mov_b32 s15, 0x00020000
    s_add_u32 s8, s4, s25
    s_addc_u32 s9, s5, 0
    v_mfma_f32_16x16x32_bf16 v[164:167], v[52:55], v[24:27], v[164:167]
    v_mfma_f32_16x16x32_bf16 v[168:171], v[32:35], v[28:31], v[168:171]
    s_add_u32 s12, s4, s26
    s_addc_u32 s13, s5, 0
    s_mul_i32 s25, s24, 81920
    v_mfma_f32_16x16x32_bf16 v[172:175], v[36:39], v[28:31], v[172:175]
    v_mfma_f32_16x16x32_bf16 v[176:179], v[40:43], v[28:31], v[176:179]
    s_lshl_b32 s26, s23, 10
    s_add_u32 s27, s25, s26
    v_add_u32 v2, s25, v14
    v_mfma_f32_16x16x32_bf16 v[180:183], v[44:47], v[28:31], v[180:183]
    v_mfma_f32_16x16x32_bf16 v[184:187], v[48:51], v[28:31], v[184:187]
    v_add_u32 v3, s25, v3
    v_add_u32 v4, s25, v4
    v_mfma_f32_16x16x32_bf16 v[188:191], v[52:55], v[28:31], v[188:191]
    s_waitcnt vmcnt(4) lgkmcnt(0)
    s_barrier
    v_mfma_f32_16x16x32_bf16 v[96:99], v[72:75], v[56:59], v[96:99]
    ds_read_b128 v[16:19], v5 offset:0
    s_mov_b64 s[44:45], s[0:1]
    s_and_b32 s52, s2, 6
    s_lshl_b32 s52, s52, 2
    v_mfma_f32_16x16x32_bf16 v[100:103], v[76:79], v[56:59], v[100:103]
    ds_read_b128 v[20:23], v5 offset:2048
    v_mfma_f32_16x16x32_bf16 v[104:107], v[80:83], v[56:59], v[104:107]
    ds_read_b128 v[24:27], v6 offset:0
    s_lshr_b32 s53, s2, 3
    s_and_b32 s48, s53, 7
    s_add_u32 s48, s48, s52
    v_mfma_f32_16x16x32_bf16 v[108:111], v[84:87], v[56:59], v[108:111]
    ds_read_b128 v[28:31], v6 offset:2048
    v_mfma_f32_16x16x32_bf16 v[112:115], v[88:91], v[56:59], v[112:115]
    ds_read_b64_tr_b16 v[32:33], v10 offset:0
    s_and_b32 s52, s2, 1
    s_lshl_b32 s52, s52, 2
    s_lshr_b32 s49, s53, 3
    v_mfma_f32_16x16x32_bf16 v[116:119], v[92:95], v[56:59], v[116:119]
    ds_read_b64_tr_b16 v[34:35], v10 offset:3072
    s_add_u32 s49, s49, s52
    s_mul_i32 s52, s48, 303104
    s_add_u32 s52, s52, 8388608
    v_mfma_f32_16x16x32_bf16 v[120:123], v[72:75], v[60:63], v[120:123]
    ds_read_b64_tr_b16 v[36:37], v10 offset:12288
    v_mfma_f32_16x16x32_bf16 v[124:127], v[76:79], v[60:63], v[124:127]
    ds_read_b64_tr_b16 v[38:39], v10 offset:15360
    s_add_u32 s36, s4, s52
    s_addc_u32 s37, s5, 0
    s_mov_b32 s38, 303104
    v_mfma_f32_16x16x32_bf16 v[128:131], v[80:83], v[60:63], v[128:131]
    ds_read_b64_tr_b16 v[40:41], v10 offset:128
    v_mfma_f32_16x16x32_bf16 v[132:135], v[84:87], v[60:63], v[132:135]
    ds_read_b64_tr_b16 v[42:43], v10 offset:3200
    s_mov_b32 s39, 0x00020000
    s_mul_i32 s52, s49, 378880
    s_add_u32 s52, s52, 18874368
    v_mfma_f32_16x16x32_bf16 v[136:139], v[88:91], v[60:63], v[136:139]
    ds_read_b64_tr_b16 v[44:45], v10 offset:12416
    s_add_u32 s40, s4, s52
    s_addc_u32 s41, s5, 0
    s_mov_b32 s42, 378880
    v_mfma_f32_16x16x32_bf16 v[140:143], v[92:95], v[60:63], v[140:143]
    ds_read_b64_tr_b16 v[46:47], v10 offset:15488
    v_mfma_f32_16x16x32_bf16 v[144:147], v[72:75], v[64:67], v[144:147]
    ds_read_b64_tr_b16 v[48:49], v10 offset:256
    s_mov_b32 s43, 0x00020000
    s_lshr_b32 s52, s3, 2
    s_mul_i32 s52, s52, 81920
    v_mfma_f32_16x16x32_bf16 v[148:151], v[76:79], v[64:67], v[148:151]
    ds_read_b64_tr_b16 v[50:51], v10 offset:3328
    v_mfma_f32_16x16x32_bf16 v[152:155], v[80:83], v[64:67], v[152:155]
    ds_read_b64_tr_b16 v[52:53], v10 offset:12544
    s_and_b32 s53, s3, 3
    s_mul_i32 s54, s53, 15360
    s_add_u32 s54, s54, s52
    v_mfma_f32_16x16x32_bf16 v[156:159], v[84:87], v[64:67], v[156:159]
    ds_read_b64_tr_b16 v[54:55], v10 offset:15616
    s_mul_i32 s55, s53, 5120
    s_add_u32 s55, s55, s52
    s_add_u32 s55, s55, 61440
    v_mfma_f32_16x16x32_bf16 v[160:163], v[88:91], v[64:67], v[160:163]
    v_mfma_f32_16x16x32_bf16 v[164:167], v[92:95], v[64:67], v[164:167]
    v_lshlrev_b32 v14, 4, v0
    v_add_u32 v15, 4096, v14
    s_and_b32 s52, s49, 3
    v_mfma_f32_16x16x32_bf16 v[168:171], v[72:75], v[68:71], v[168:171]
    v_mfma_f32_16x16x32_bf16 v[172:175], v[76:79], v[68:71], v[172:175]
    s_mul_i32 s52, s52, 2
    s_and_b32 s53, s48, 7
    s_mul_i32 s53, s53, 1
    v_mfma_f32_16x16x32_bf16 v[176:179], v[80:83], v[68:71], v[176:179]
    s_add_u32 s52, s52, s53
    s_and_b32 s52, s52, 7
    s_mul_i32 s52, s52, 27
    v_mfma_f32_16x16x32_bf16 v[180:183], v[84:87], v[68:71], v[180:183]
    v_mfma_f32_16x16x32_bf16 v[184:187], v[88:91], v[68:71], v[184:187]
    s_lshr_b32 s52, s52, 2
    s_add_u32 s62, s52, s3
    v_mfma_f32_16x16x32_bf16 v[188:191], v[92:95], v[68:71], v[188:191]
    s_waitcnt vmcnt(1) lgkmcnt(0)
    s_barrier
    v_mfma_f32_16x16x32_bf16 v[96:99], v[32:35], v[16:19], v[96:99]
    ds_read_b128 v[56:59], v7 offset:0
    s_lshr_b32 s25, s21, 4
    s_mul_i32 s25, s25, 4369
    v_mfma_f32_16x16x32_bf16 v[100:103], v[36:39], v[16:19], v[100:103]
    ds_read_b128 v[60:63], v7 offset:2048
    v_mfma_f32_16x16x32_bf16 v[104:107], v[40:43], v[16:19], v[104:107]
    ds_read_b128 v[64:67], v8 offset:0
    v_mfma_f32_16x16x32_bf16 v[108:111], v[44:47], v[16:19], v[108:111]
    ds_read_b128 v[68:71], v8 offset:2048
    s_add_u32 s25, s25, 4947
    s_lshl_b32 s26, s22, 1
    v_mfma_f32_16x16x32_bf16 v[112:115], v[48:51], v[16:19], v[112:115]
    ds_read_b64_tr_b16 v[72:73], v10 offset:24576
    v_mfma_f32_16x16x32_bf16 v[116:119], v[52:55], v[16:19], v[116:119]
    ds_read_b64_tr_b16 v[74:75], v10 offset:27648
    v_mfma_f32_16x16x32_bf16 v[120:123], v[32:35], v[20:23], v[120:123]
    ds_read_b64_tr_b16 v[76:77], v10 offset:36864
    v_cmp_gt_u32 vcc, 48, v0
    v_lshrrev_b32 v1, 4, v0
    v_mfma_f32_16x16x32_bf16 v[124:127], v[36:39], v[20:23], v[124:127]
    ds_read_b64_tr_b16 v[78:79], v10 offset:39936
    v_mfma_f32_16x16x32_bf16 v[128:131], v[40:43], v[20:23], v[128:131]
    ds_read_b64_tr_b16 v[80:81], v10 offset:24704
    v_mfma_f32_16x16x32_bf16 v[132:135], v[44:47], v[20:23], v[132:135]
    ds_read_b64_tr_b16 v[82:83], v10 offset:27776
    v_lshlrev_b32 v1, 2, v1
    v_bfe_u32 v1, s25, v1, 4
    v_mfma_f32_16x16x32_bf16 v[136:139], v[48:51], v[20:23], v[136:139]
    ds_read_b64_tr_b16 v[84:85], v10 offset:36992
    v_mfma_f32_16x16x32_bf16 v[140:143], v[52:55], v[20:23], v[140:143]
    ds_read_b64_tr_b16 v[86:87], v10 offset:40064
    v_mfma_f32_16x16x32_bf16 v[144:147], v[32:35], v[24:27], v[144:147]
    ds_read_b64_tr_b16 v[88:89], v10 offset:24832
    v_and_b32 v11, 1, v0
    v_add_u32 v11, s26, v11
    v_mfma_f32_16x16x32_bf16 v[148:151], v[36:39], v[24:27], v[148:151]
    ds_read_b64_tr_b16 v[90:91], v10 offset:27904
    v_mfma_f32_16x16x32_bf16 v[152:155], v[40:43], v[24:27], v[152:155]
    ds_read_b64_tr_b16 v[92:93], v10 offset:37120
    v_mfma_f32_16x16x32_bf16 v[156:159], v[44:47], v[24:27], v[156:159]
    ds_read_b64_tr_b16 v[94:95], v10 offset:40192
    v_and_b32 v13, 15, v0
    v_cndmask_b32 v11, v11, v13, vcc
    v_mfma_f32_16x16x32_bf16 v[160:163], v[48:51], v[24:27], v[160:163]
    v_mfma_f32_16x16x32_bf16 v[164:167], v[52:55], v[24:27], v[164:167]
    v_mfma_f32_16x16x32_bf16 v[168:171], v[32:35], v[28:31], v[168:171]
    v_mul_u32_u24 v1, 20480, v1
    v_mul_u32_u24 v11, 1280, v11
    v_mfma_f32_16x16x32_bf16 v[172:175], v[36:39], v[28:31], v[172:175]
    v_mfma_f32_16x16x32_bf16 v[176:179], v[40:43], v[28:31], v[176:179]
    v_mfma_f32_16x16x32_bf16 v[180:183], v[44:47], v[28:31], v[180:183]
    v_add_u32 v1, v1, v11
    v_mfma_f32_16x16x32_bf16 v[184:187], v[48:51], v[28:31], v[184:187]
    v_mfma_f32_16x16x32_bf16 v[188:191], v[52:55], v[28:31], v[188:191]
    s_waitcnt vmcnt(63) lgkmcnt(0)
    s_barrier
    v_mfma_f32_16x16x32_bf16 v[96:99], v[72:75], v[56:59], v[96:99]
    v_mfma_f32_16x16x32_bf16 v[100:103], v[76:79], v[56:59], v[100:103]
    v_mfma_f32_16x16x32_bf16 v[104:107], v[80:83], v[56:59], v[104:107]
    v_mfma_f32_16x16x32_bf16 v[108:111], v[84:87], v[56:59], v[108:111]
    v_mfma_f32_16x16x32_bf16 v[112:115], v[88:91], v[56:59], v[112:115]
    v_mfma_f32_16x16x32_bf16 v[116:119], v[92:95], v[56:59], v[116:119]
    v_mfma_f32_16x16x32_bf16 v[120:123], v[72:75], v[60:63], v[120:123]
    v_mfma_f32_16x16x32_bf16 v[124:127], v[76:79], v[60:63], v[124:127]
    v_mfma_f32_16x16x32_bf16 v[128:131], v[80:83], v[60:63], v[128:131]
    v_mfma_f32_16x16x32_bf16 v[132:135], v[84:87], v[60:63], v[132:135]
    v_mfma_f32_16x16x32_bf16 v[136:139], v[88:91], v[60:63], v[136:139]
    v_mfma_f32_16x16x32_bf16 v[140:143], v[92:95], v[60:63], v[140:143]
    v_mfma_f32_16x16x32_bf16 v[144:147], v[72:75], v[64:67], v[144:147]
    v_mfma_f32_16x16x32_bf16 v[148:151], v[76:79], v[64:67], v[148:151]
    v_mfma_f32_16x16x32_bf16 v[152:155], v[80:83], v[64:67], v[152:155]
    v_mfma_f32_16x16x32_bf16 v[156:159], v[84:87], v[64:67], v[156:159]
    v_mfma_f32_16x16x32_bf16 v[160:163], v[88:91], v[64:67], v[160:163]
    v_mfma_f32_16x16x32_bf16 v[164:167], v[92:95], v[64:67], v[164:167]
    v_mfma_f32_16x16x32_bf16 v[168:171], v[72:75], v[68:71], v[168:171]
    v_mfma_f32_16x16x32_bf16 v[172:175], v[76:79], v[68:71], v[172:175]
    v_mfma_f32_16x16x32_bf16 v[176:179], v[80:83], v[68:71], v[176:179]
    v_mfma_f32_16x16x32_bf16 v[180:183], v[84:87], v[68:71], v[180:183]
    v_mfma_f32_16x16x32_bf16 v[184:187], v[88:91], v[68:71], v[184:187]
    v_mfma_f32_16x16x32_bf16 v[188:191], v[92:95], v[68:71], v[188:191]
    s_waitcnt vmcnt(0)
    v_cmp_ne_u32 vcc, 1, v255
    s_cbranch_vccnz L_ispin_6
L_iback_7:
    s_nop 1
    v_pk_mul_f32 v[16:17], v[96:97], v[96:97]
    v_pk_mul_f32 v[18:19], v[98:99], v[98:99]
    v_pk_fma_f32 v[16:17], v[16:17], s[60:61], v[220:221]
    v_pk_fma_f32 v[18:19], v[18:19], s[60:61], v[220:221]
    v_pk_mul_f32 v[16:17], v[16:17], v[96:97]
    v_pk_mul_f32 v[18:19], v[18:19], v[98:99]
    v_exp_f32 v16, v16
    v_exp_f32 v17, v17
    v_exp_f32 v18, v18
    v_exp_f32 v19, v19
    v_pk_mul_f32 v[100:101], v[100:101], v[96:97]
    v_pk_mul_f32 v[102:103], v[102:103], v[98:99]
    v_pk_add_f32 v[16:17], v[16:17], 1.0 op_sel_hi:[1,0]
    v_pk_add_f32 v[18:19], v[18:19], 1.0 op_sel_hi:[1,0]
    v_rcp_f32 v16, v16
    v_rcp_f32 v17, v17
    v_rcp_f32 v18, v18
    v_rcp_f32 v19, v19
    s_nop 0
    v_pk_mul_f32 v[100:101], v[100:101], v[16:17]
    v_pk_mul_f32 v[102:103], v[102:103], v[18:19]
    v_cvt_pk_bf16_f32 v192, v100, v101
    v_cvt_pk_bf16_f32 v193, v102, v103
    v_pk_mul_f32 v[20:21], v[104:105], v[104:105]
    v_pk_mul_f32 v[22:23], v[106:107], v[106:107]
    v_pk_fma_f32 v[20:21], v[20:21], s[60:61], v[220:221]
    v_pk_fma_f32 v[22:23], v[22:23], s[60:61], v[220:221]
    v_pk_mul_f32 v[20:21], v[20:21], v[104:105]
    v_pk_mul_f32 v[22:23], v[22:23], v[106:107]
    v_exp_f32 v20, v20
    v_exp_f32 v21, v21
    v_exp_f32 v22, v22
    v_exp_f32 v23, v23
    v_pk_mul_f32 v[108:109], v[108:109], v[104:105]
    v_pk_mul_f32 v[110:111], v[110:111], v[106:107]
    v_pk_add_f32 v[20:21], v[20:21], 1.0 op_sel_hi:[1,0]
    v_pk_add_f32 v[22:23], v[22:23], 1.0 op_sel_hi:[1,0]
    v_rcp_f32 v20, v20
    v_rcp_f32 v21, v21
    v_rcp_f32 v22, v22
    v_rcp_f32 v23, v23
    s_nop 0
    v_pk_mul_f32 v[108:109], v[108:109], v[20:21]
    v_pk_mul_f32 v[110:111], v[110:111], v[22:23]
    v_cvt_pk_bf16_f32 v194, v108, v109
    v_cvt_pk_bf16_f32 v195, v110, v111
    v_pk_mul_f32 v[24:25], v[112:113], v[112:113]
    v_pk_mul_f32 v[26:27], v[114:115], v[114:115]
    v_pk_fma_f32 v[24:25], v[24:25], s[60:61], v[220:221]
    v_pk_fma_f32 v[26:27], v[26:27], s[60:61], v[220:221]
    v_pk_mul_f32 v[24:25], v[24:25], v[112:113]
    v_pk_mul_f32 v[26:27], v[26:27], v[114:115]
    v_exp_f32 v24, v24
    v_exp_f32 v25, v25
    v_exp_f32 v26, v26
    v_exp_f32 v27, v27
    v_pk_mul_f32 v[116:117], v[116:117], v[112:113]
    v_pk_mul_f32 v[118:119], v[118:119], v[114:115]
    v_pk_add_f32 v[24:25], v[24:25], 1.0 op_sel_hi:[1,0]
    v_pk_add_f32 v[26:27], v[26:27], 1.0 op_sel_hi:[1,0]
    v_rcp_f32 v24, v24
    v_rcp_f32 v25, v25
    v_rcp_f32 v26, v26
    v_rcp_f32 v27, v27
    s_nop 0
    v_pk_mul_f32 v[116:117], v[116:117], v[24:25]
    v_pk_mul_f32 v[118:119], v[118:119], v[26:27]
    v_cvt_pk_bf16_f32 v208, v116, v117
    v_cvt_pk_bf16_f32 v209, v118, v119
    v_pk_mul_f32 v[28:29], v[120:121], v[120:121]
    v_pk_mul_f32 v[30:31], v[122:123], v[122:123]
    v_pk_fma_f32 v[28:29], v[28:29], s[60:61], v[220:221]
    v_pk_fma_f32 v[30:31], v[30:31], s[60:61], v[220:221]
    v_pk_mul_f32 v[28:29], v[28:29], v[120:121]
    v_pk_mul_f32 v[30:31], v[30:31], v[122:123]
    v_exp_f32 v28, v28
    v_exp_f32 v29, v29
    v_exp_f32 v30, v30
    v_exp_f32 v31, v31
    v_pk_mul_f32 v[124:125], v[124:125], v[120:121]
    v_pk_mul_f32 v[126:127], v[126:127], v[122:123]
    v_pk_add_f32 v[28:29], v[28:29], 1.0 op_sel_hi:[1,0]
    v_pk_add_f32 v[30:31], v[30:31], 1.0 op_sel_hi:[1,0]
    v_rcp_f32 v28, v28
    v_rcp_f32 v29, v29
    v_rcp_f32 v30, v30
    v_rcp_f32 v31, v31
    s_nop 0
    v_pk_mul_f32 v[124:125], v[124:125], v[28:29]
    v_pk_mul_f32 v[126:127], v[126:127], v[30:31]
    v_cvt_pk_bf16_f32 v196, v124, v125
    v_cvt_pk_bf16_f32 v197, v126, v127
    v_pk_mul_f32 v[16:17], v[128:129], v[128:129]
    v_pk_mul_f32 v[18:19], v[130:131], v[130:131]
    v_pk_fma_f32 v[16:17], v[16:17], s[60:61], v[220:221]
    v_pk_fma_f32 v[18:19], v[18:19], s[60:61], v[220:221]
    v_pk_mul_f32 v[16:17], v[16:17], v[128:129]
    v_pk_mul_f32 v[18:19], v[18:19], v[130:131]
    v_exp_f32 v16, v16
    v_exp_f32 v17, v17
    v_exp_f32 v18, v18
    v_exp_f32 v19, v19
    v_pk_mul_f32 v[132:133], v[132:133], v[128:129]
    v_pk_mul_f32 v[134:135], v[134:135], v[130:131]
    v_pk_add_f32 v[16:17], v[16:17], 1.0 op_sel_hi:[1,0]
    v_pk_add_f32 v[18:19], v[18:19], 1.0 op_sel_hi:[1,0]
    v_rcp_f32 v16, v16
    v_rcp_f32 v17, v17
    v_rcp_f32 v18, v18
    v_rcp_f32 v19, v19
    s_nop 0
    v_pk_mul_f32 v[132:133], v[132:133], v[16:17]
    v_pk_mul_f32 v[134:135], v[134:135], v[18:19]
    v_cvt_pk_bf16_f32 v198, v132, v133
    v_cvt_pk_bf16_f32 v199, v134, v135
    v_pk_mul_f32 v[20:21], v[136:137], v[136:137]
    v_pk_mul_f32 v[22:23], v[138:139], v[138:139]
    v_pk_fma_f32 v[20:21], v[20:21], s[60:61], v[220:221]
    v_pk_fma_f32 v[22:23], v[22:23], s[60:61], v[220:221]
    v_pk_mul_f32 v[20:21], v[20:21], v[136:137]
    v_pk_mul_f32 v[22:23], v[22:23], v[138:139]
    v_exp_f32 v20, v20
    v_exp_f32 v21, v21
    v_exp_f32 v22, v22
    v_exp_f32 v23, v23
    v_pk_mul_f32 v[140:141], v[140:141], v[136:137]
    v_pk_mul_f32 v[142:143], v[142:143], v[138:139]
    v_pk_add_f32 v[20:21], v[20:21], 1.0 op_sel_hi:[1,0]
    v_pk_add_f32 v[22:23], v[22:23], 1.0 op_sel_hi:[1,0]
    v_rcp_f32 v20, v20
    v_rcp_f32 v21, v21
    v_rcp_f32 v22, v22
    v_rcp_f32 v23, v23
    s_nop 0
    v_pk_mul_f32 v[140:141], v[140:141], v[20:21]
    v_pk_mul_f32 v[142:143], v[142:143], v[22:23]
    v_cvt_pk_bf16_f32 v210, v140, v141
    v_cvt_pk_bf16_f32 v211, v142, v143
    v_pk_mul_f32 v[24:25], v[144:145], v[144:145]
    v_pk_mul_f32 v[26:27], v[146:147], v[146:147]
    v_pk_fma_f32 v[24:25], v[24:25], s[60:61], v[220:221]
    v_pk_fma_f32 v[26:27], v[26:27], s[60:61], v[220:221]
    v_pk_mul_f32 v[24:25], v[24:25], v[144:145]
    v_pk_mul_f32 v[26:27], v[26:27], v[146:147]
    v_exp_f32 v24, v24
    v_exp_f32 v25, v25
    v_exp_f32 v26, v26
    v_exp_f32 v27, v27
    v_pk_mul_f32 v[148:149], v[148:149], v[144:145]
    v_pk_mul_f32 v[150:151], v[150:151], v[146:147]
    v_pk_add_f32 v[24:25], v[24:25], 1.0 op_sel_hi:[1,0]
    v_pk_add_f32 v[26:27], v[26:27], 1.0 op_sel_hi:[1,0]
    v_rcp_f32 v24, v24
    v_rcp_f32 v25, v25
    v_rcp_f32 v26, v26
    v_rcp_f32 v27, v27
    s_nop 0
    v_pk_mul_f32 v[148:149], v[148:149], v[24:25]
    v_pk_mul_f32 v[150:151], v[150:151], v[26:27]
    v_cvt_pk_bf16_f32 v200, v148, v149
    v_cvt_pk_bf16_f32 v201, v150, v151
    v_pk_mul_f32 v[28:29], v[152:153], v[152:153]
    v_pk_mul_f32 v[30:31], v[154:155], v[154:155]
    v_pk_fma_f32 v[28:29], v[28:29], s[60:61], v[220:221]
    v_pk_fma_f32 v[30:31], v[30:31], s[60:61], v[220:221]
    v_pk_mul_f32 v[28:29], v[28:29], v[152:153]
    v_pk_mul_f32 v[30:31], v[30:31], v[154:155]
    v_exp_f32 v28, v28
    v_exp_f32 v29, v29
    v_exp_f32 v30, v30
    v_exp_f32 v31, v31
    v_pk_mul_f32 v[156:157], v[156:157], v[152:153]
    v_pk_mul_f32 v[158:159], v[158:159], v[154:155]
    v_pk_add_f32 v[28:29], v[28:29], 1.0 op_sel_hi:[1,0]
    v_pk_add_f32 v[30:31], v[30:31], 1.0 op_sel_hi:[1,0]
    v_rcp_f32 v28, v28
    v_rcp_f32 v29, v29
    v_rcp_f32 v30, v30
    v_rcp_f32 v31, v31
    s_nop 0
    v_pk_mul_f32 v[156:157], v[156:157], v[28:29]
    v_pk_mul_f32 v[158:159], v[158:159], v[30:31]
    v_cvt_pk_bf16_f32 v202, v156, v157
    v_cvt_pk_bf16_f32 v203, v158, v159
    s_mov_b32 s34, 65536
    s_cmp_ge_u32 s3, 1
    s_cbranch_scc1 L_qdone_9
L_qspin_8:
    s_sleep 8
    global_load_dword v6, v1, s[100:101] offset:0 sc1
    s_waitcnt vmcnt(0)
    v_cmp_ne_u32 vcc, 1, v6
    s_sub_u32 s34, s34, 1
    s_cbranch_scc1 L_qdone_9
    s_cbranch_vccnz L_qspin_8
L_qdone_9:
    s_barrier
    s_mul_i32 s26, s24, 1280
    s_sub_u32 s25, 1280, s26
    buffer_load_dwordx4 v[88:91], v14, s[12:15], s25 offen sc1
    buffer_load_dwordx2 v[92:93], v12, s[12:15], s25 offen offset:1024 sc1
    s_add_u32 m0, s27, 0
    s_nop 0
    buffer_load_dwordx4 v14, s[8:11], m0 offen sc1 lds
    buffer_load_dwordx4 v[94:97], v14, s[12:15], s26 offen offset:0 sc1
    buffer_load_dwordx2 v[98:99], v12, s[12:15], s26 offen offset:1024 sc1
    s_add_u32 m0, s27, 4096
    s_nop 0
    buffer_load_dwordx4 v14, s[8:11], m0 offen sc1 lds
    s_add_u32 m0, s27, 8192
    s_nop 0
    buffer_load_dwordx4 v14, s[8:11], m0 offen sc1 lds
    v_pk_mul_f32 v[16:17], v[160:161], v[160:161]
    v_pk_mul_f32 v[18:19], v[162:163], v[162:163]
    v_pk_fma_f32 v[16:17], v[16:17], s[60:61], v[220:221]
    v_pk_fma_f32 v[18:19], v[18:19], s[60:61], v[220:221]
    v_pk_mul_f32 v[16:17], v[16:17], v[160:161]
    v_pk_mul_f32 v[18:19], v[18:19], v[162:163]
    v_exp_f32 v16, v16
    v_exp_f32 v17, v17
    v_exp_f32 v18, v18
    v_exp_f32 v19, v19
    v_pk_mul_f32 v[164:165], v[164:165], v[160:161]
    v_pk_mul_f32 v[166:167], v[166:167], v[162:163]
    v_pk_add_f32 v[16:17], v[16:17], 1.0 op_sel_hi:[1,0]
    v_pk_add_f32 v[18:19], v[18:19], 1.0 op_sel_hi:[1,0]
    v_rcp_f32 v16, v16
    v_rcp_f32 v17, v17
    v_rcp_f32 v18, v18
    v_rcp_f32 v19, v19
    s_nop 0
    v_pk_mul_f32 v[164:165], v[164:165], v[16:17]
    v_pk_mul_f32 v[166:167], v[166:167], v[18:19]
    v_cvt_pk_bf16_f32 v212, v164, v165
    v_cvt_pk_bf16_f32 v213, v166, v167
    v_pk_mul_f32 v[20:21], v[168:169], v[168:169]
    v_pk_mul_f32 v[22:23], v[170:171], v[170:171]
    v_pk_fma_f32 v[20:21], v[20:21], s[60:61], v[220:221]
    v_pk_fma_f32 v[22:23], v[22:23], s[60:61], v[220:221]
    v_pk_mul_f32 v[20:21], v[20:21], v[168:169]
    v_pk_mul_f32 v[22:23], v[22:23], v[170:171]
    v_exp_f32 v20, v20
    v_exp_f32 v21, v21
    v_exp_f32 v22, v22
    v_exp_f32 v23, v23
    v_pk_mul_f32 v[172:173], v[172:173], v[168:169]
    v_pk_mul_f32 v[174:175], v[174:175], v[170:171]
    v_pk_add_f32 v[20:21], v[20:21], 1.0 op_sel_hi:[1,0]
    v_pk_add_f32 v[22:23], v[22:23], 1.0 op_sel_hi:[1,0]
    v_rcp_f32 v20, v20
    v_rcp_f32 v21, v21
    v_rcp_f32 v22, v22
    v_rcp_f32 v23, v23
    s_nop 0
    v_pk_mul_f32 v[172:173], v[172:173], v[20:21]
    v_pk_mul_f32 v[174:175], v[174:175], v[22:23]
    v_cvt_pk_bf16_f32 v204, v172, v173
    v_cvt_pk_bf16_f32 v205, v174, v175
    v_pk_mul_f32 v[24:25], v[176:177], v[176:177]
    v_pk_mul_f32 v[26:27], v[178:179], v[178:179]
    v_pk_fma_f32 v[24:25], v[24:25], s[60:61], v[220:221]
    v_pk_fma_f32 v[26:27], v[26:27], s[60:61], v[220:221]
    v_pk_mul_f32 v[24:25], v[24:25], v[176:177]
    v_pk_mul_f32 v[26:27], v[26:27], v[178:179]
    v_exp_f32 v24, v24
    v_exp_f32 v25, v25
    v_exp_f32 v26, v26
    v_exp_f32 v27, v27
    v_pk_mul_f32 v[180:181], v[180:181], v[176:177]
    v_pk_mul_f32 v[182:183], v[182:183], v[178:179]
    v_pk_add_f32 v[24:25], v[24:25], 1.0 op_sel_hi:[1,0]
    v_pk_add_f32 v[26:27], v[26:27], 1.0 op_sel_hi:[1,0]
    v_rcp_f32 v24, v24
    v_rcp_f32 v25, v25
    v_rcp_f32 v26, v26
    v_rcp_f32 v27, v27
    s_nop 0
    v_pk_mul_f32 v[180:181], v[180:181], v[24:25]
    v_pk_mul_f32 v[182:183], v[182:183], v[26:27]
    v_cvt_pk_bf16_f32 v206, v180, v181
    v_cvt_pk_bf16_f32 v207, v182, v183
    v_pk_mul_f32 v[28:29], v[184:185], v[184:185]
    v_pk_mul_f32 v[30:31], v[186:187], v[186:187]
    v_pk_fma_f32 v[28:29], v[28:29], s[60:61], v[220:221]
    v_pk_fma_f32 v[30:31], v[30:31], s[60:61], v[220:221]
    v_pk_mul_f32 v[28:29], v[28:29], v[184:185]
    v_pk_mul_f32 v[30:31], v[30:31], v[186:187]
    v_exp_f32 v28, v28
    v_exp_f32 v29, v29
    v_exp_f32 v30, v30
    v_exp_f32 v31, v31
    v_pk_mul_f32 v[188:189], v[188:189], v[184:185]
    v_pk_mul_f32 v[190:191], v[190:191], v[186:187]
    v_pk_add_f32 v[28:29], v[28:29], 1.0 op_sel_hi:[1,0]
    v_pk_add_f32 v[30:31], v[30:31], 1.0 op_sel_hi:[1,0]
    v_rcp_f32 v28, v28
    v_rcp_f32 v29, v29
    v_rcp_f32 v30, v30
    v_rcp_f32 v31, v31
    s_nop 0
    v_pk_mul_f32 v[188:189], v[188:189], v[28:29]
    v_pk_mul_f32 v[190:191], v[190:191], v[30:31]
    v_cvt_pk_bf16_f32 v214, v188, v189
    v_cvt_pk_bf16_f32 v215, v190, v191
    s_nop 1
    v_permlane32_swap_b32 v208, v210
    v_permlane32_swap_b32 v209, v211
    v_permlane32_swap_b32 v212, v214
    v_permlane32_swap_b32 v213, v215
    s_mov_b32 s28, 0x000fffff
    s_mov_b32 s29, 0x000fffff
    v_and_b32 v10, 27, v0
    v_cmp_eq_u32 vcc, 24, v10
    v_mov_b32 v10, 0x3f803f80
    s_nop 0
    v_cndmask_b32 v112, 0, v10, vcc
    v_cndmask_b32 v113, 0, v10, vcc
    v_cndmask_b32 v114, 0, v10, vcc
    v_cndmask_b32 v115, 0, v10, vcc
    v_cndmask_b32 v116, 0, v10, vcc
    v_cndmask_b32 v117, 0, v10, vcc
    v_cndmask_b32 v118, 0, v10, vcc
    v_cndmask_b32 v119, 0, v10, vcc
    v_cndmask_b32 v120, 0, v10, vcc
    v_cndmask_b32 v121, 0, v10, vcc
    v_cndmask_b32 v122, 0, v10, vcc
    v_cndmask_b32 v123, 0, v10, vcc
    s_waitcnt vmcnt(1) lgkmcnt(0)
    s_branch K_att
K_side:
    s_add_u32 s100, s4, 24117248
    s_addc_u32 s101, s5, 0
    v_bfe_u32 v6, v0, 3, 2
    v_mul_u32_u24 v6, 1280, v6
    v_and_b32 v7, 7, v0
    v_lshl_add_u32 v1, v7, 4, v6
    v_lshrrev_b32 v6, 5, v0
    v_mul_u32_u24 v2, 1280, v6
    v_lshrrev_b32 v6, 4, v0
    v_lshlrev_b32 v6, 10, v6
    v_bfe_u32 v7, v0, 2, 2
    v_lshl_add_u32 v6, v7, 7, v6
    v_and_b32 v7, 3, v0
    v_lshl_add_u32 v6, v7, 3, v6
    s_mul_i32 s36, s3, 20480
    v_add_u32 v4, s36, v6
    v_lshlrev_b32 v5, 4, v0
    s_add_u32 s16, s4, 18874368
    s_addc_u32 s17, s5, 0
    s_mov_b32 s18, 3031040
    s_mov_b32 s54, s36
    s_lshl_b32 s24, s20, 3
    s_add_u32 s24, s24, s3
    s_add_u32 s24, s24, 0
    s_mul_i32 s29, s24, 6554
    s_lshr_b32 s29, s29, 16
    s_mul_i32 s30, s29, 10
    s_sub_u32 s30, s24, s30
    s_mov_b32 s26, 5120
    s_mov_b32 s28, 8
    s_lshr_b32 s25, s29, 2
    s_lshl_b32 s25, s25, 3
    s_add_u32 s25, s25, s29
    s_lshl_b32 s25, s25, 4
    s_mov_b32 s27, 10240
    s_mov_b32 s28, 64
L_tyj_14:
    v_mad_u32_u24 v3, v2, s28, v1
    s_mul_i32 s25, s25, 1280
    s_lshl_b32 s31, s30, 7
    s_add_u32 s25, s25, s31
    s_lshl_b32 s33, s30, 2
    s_mul_i32 s32, s29, 5120
    s_mov_b32 s31, 2211840
    s_cmp_ge_u32 s29, 54
    s_cselect_b32 s12, s52, s60
    s_cselect_b32 s13, s53, s61
    s_cselect_b32 s14, 819200, s31
    s_add_u32 m0, s54, 0
    s_add_u32 s26, s25, s26
    buffer_load_dwordx4 v3, s[12:15], s25 offen lds
    s_add_u32 m0, m0, 1024
    s_add_u32 s25, s25, s27
    buffer_load_dwordx4 v3, s[12:15], s26 offen lds
    s_add_u32 m0, m0, 1024
    s_add_u32 s26, s26, s27
    buffer_load_dwordx4 v3, s[12:15], s25 offen lds
    s_add_u32 m0, m0, 1024
    s_nop 0
    buffer_load_dwordx4 v3, s[12:15], s26 offen lds
    s_lshl_b32 s24, s20, 3
    s_add_u32 s24, s24, s3
    s_add_u32 s24, s24, 128
    s_mul_i32 s29, s24, 6554
    s_lshr_b32 s29, s29, 16
    s_mul_i32 s30, s29, 10
    s_sub_u32 s30, s24, s30
    s_mov_b32 s26, 5120
    s_mov_b32 s28, 8
    s_lshr_b32 s25, s29, 2
    s_lshl_b32 s25, s25, 3
    s_add_u32 s25, s25, s29
    s_lshl_b32 s25, s25, 4
    s_mov_b32 s27, 10240
    s_mov_b32 s28, 64
L_tyj_19:
    v_mad_u32_u24 v3, v2, s28, v1
    s_mul_i32 s25, s25, 1280
    s_lshl_b32 s31, s30, 7
    s_add_u32 s25, s25, s31
    s_lshl_b32 s35, s30, 2
    s_mul_i32 s34, s29, 5120
    s_mov_b32 s31, 2211840
    s_cmp_ge_u32 s29, 54
    s_cselect_b32 s12, s52, s60
    s_cselect_b32 s13, s53, s61
    s_cselect_b32 s14, 819200, s31
    s_add_u32 m0, s54, 4096
    s_add_u32 s26, s25, s26
    buffer_load_dwordx4 v3, s[12:15], s25 offen lds
    s_add_u32 m0, m0, 1024
    s_add_u32 s25, s25, s27
    buffer_load_dwordx4 v3, s[12:15], s26 offen lds
    s_add_u32 m0, m0, 1024
    s_add_u32 s26, s26, s27
    buffer_load_dwordx4 v3, s[12:15], s25 offen lds
    s_add_u32 m0, m0, 1024
    s_nop 0
    buffer_load_dwordx4 v3, s[12:15], s26 offen lds
    s_lshl_b32 s24, s20, 3
    s_add_u32 s24, s24, s3
    s_add_u32 s24, s24, 256
    s_mul_i32 s29, s24, 6554
    s_lshr_b32 s29, s29, 16
    s_mul_i32 s30, s29, 10
    s_sub_u32 s30, s24, s30
    s_mov_b32 s26, 5120
    s_mov_b32 s28, 8
    s_cmp_ge_u32 s29, 36
    s_cbranch_scc1 L_ty1_21
    s_lshr_b32 s25, s29, 2
    s_lshl_b32 s25, s25, 3
    s_add_u32 s25, s25, s29
    s_lshl_b32 s25, s25, 4
    s_mov_b32 s27, 10240
    s_mov_b32 s28, 64
    s_branch L_tyj_24
L_ty1_21:
    s_sub_u32 s25, s29, 36
    s_lshr_b32 s31, s25, 1
    s_lshl_b32 s31, s31, 2
    s_add_u32 s25, s25, s31
    s_add_u32 s25, s25, 4
    s_lshl_b32 s25, s25, 5
    s_mov_b32 s27, 20480
L_tyj_24:
    v_mad_u32_u24 v3, v2, s28, v1
    s_mul_i32 s25, s25, 1280
    s_lshl_b32 s31, s30, 7
    s_add_u32 s25, s25, s31
    s_lshl_b32 s37, s30, 2
    s_mul_i32 s36, s29, 5120
    s_mov_b32 s31, 2211840
    s_cmp_ge_u32 s29, 54
    s_cselect_b32 s12, s52, s60
    s_cselect_b32 s13, s53, s61
    s_cselect_b32 s14, 819200, s31
    s_add_u32 m0, s54, 8192
    s_add_u32 s26, s25, s26
    buffer_load_dwordx4 v3, s[12:15], s25 offen lds
    s_add_u32 m0, m0, 1024
    s_add_u32 s25, s25, s27
    buffer_load_dwordx4 v3, s[12:15], s26 offen lds
    s_add_u32 m0, m0, 1024
    s_add_u32 s26, s26, s27
    buffer_load_dwordx4 v3, s[12:15], s25 offen lds
    s_add_u32 m0, m0, 1024
    s_nop 0
    buffer_load_dwordx4 v3, s[12:15], s26 offen lds
    s_lshl_b32 s24, s20, 3
    s_add_u32 s24, s24, s3
    s_add_u32 s24, s24, 384
    s_mul_i32 s29, s24, 6554
    s_lshr_b32 s29, s29, 16
    s_mul_i32 s30, s29, 10
    s_sub_u32 s30, s24, s30
    s_mov_b32 s26, 5120
    s_mov_b32 s28, 8
    s_sub_u32 s25, s29, 36
    s_lshr_b32 s31, s25, 1
    s_lshl_b32 s31, s31, 2
    s_add_u32 s25, s25, s31
    s_add_u32 s25, s25, 4
    s_lshl_b32 s25, s25, 5
    s_mov_b32 s27, 20480
L_tyj_29:
    v_mad_u32_u24 v3, v2, s28, v1
    s_mul_i32 s25, s25, 1280
    s_lshl_b32 s31, s30, 7
    s_add_u32 s25, s25, s31
    s_lshl_b32 s39, s30, 2
    s_mul_i32 s38, s29, 5120
    s_mov_b32 s31, 2211840
    s_cmp_ge_u32 s29, 54
    s_cselect_b32 s12, s52, s60
    s_cselect_b32 s13, s53, s61
    s_cselect_b32 s14, 819200, s31
    s_add_u32 m0, s54, 12288
    s_add_u32 s26, s25, s26
    buffer_load_dwordx4 v3, s[12:15], s25 offen lds
    s_add_u32 m0, m0, 1024
    s_add_u32 s25, s25, s27
    buffer_load_dwordx4 v3, s[12:15], s26 offen lds
    s_add_u32 m0, m0, 1024
    s_add_u32 s26, s26, s27
    buffer_load_dwordx4 v3, s[12:15], s25 offen lds
    s_add_u32 m0, m0, 1024
    s_nop 0
    buffer_load_dwordx4 v3, s[12:15], s26 offen lds
    s_lshl_b32 s24, s20, 3
    s_add_u32 s24, s24, s3
    s_add_u32 s24, s24, 512
    s_mul_i32 s29, s24, 6554
    s_lshr_b32 s29, s29, 16
    s_mul_i32 s30, s29, 10
    s_sub_u32 s30, s24, s30
    s_mov_b32 s26, 5120
    s_mov_b32 s28, 8
    s_cmp_ge_u32 s29, 54
    s_cbranch_scc1 L_ty2_32
    s_sub_u32 s25, s29, 36
    s_lshr_b32 s31, s25, 1
    s_lshl_b32 s31, s31, 2
    s_add_u32 s25, s25, s31
    s_add_u32 s25, s25, 4
    s_lshl_b32 s25, s25, 5
    s_mov_b32 s27, 20480
    s_branch L_tyj_34
L_ty2_32:
    s_sub_u32 s25, s29, 54
    s_mul_i32 s25, s25, 40
    s_mov_b32 s27, 25600
L_tyj_34:
    v_mad_u32_u24 v3, v2, s28, v1
    s_mul_i32 s25, s25, 1280
    s_lshl_b32 s31, s30, 7
    s_add_u32 s25, s25, s31
    s_lshl_b32 s41, s30, 2
    s_mul_i32 s40, s29, 5120
    s_mov_b32 s31, 2211840
    s_cmp_ge_u32 s29, 54
    s_cselect_b32 s12, s52, s60
    s_cselect_b32 s13, s53, s61
    s_cselect_b32 s14, 819200, s31
    s_add_u32 m0, s54, 16384
    s_add_u32 s26, s25, s26
    buffer_load_dwordx4 v3, s[12:15], s25 offen lds
    s_add_u32 m0, m0, 1024
    s_add_u32 s25, s25, s27
    buffer_load_dwordx4 v3, s[12:15], s26 offen lds
    s_add_u32 m0, m0, 1024
    s_add_u32 s26, s26, s27
    buffer_load_dwordx4 v3, s[12:15], s25 offen lds
    s_add_u32 m0, m0, 1024
    s_nop 0
    buffer_load_dwordx4 v3, s[12:15], s26 offen lds
    s_getpc_b64 s[26:27]
L_pc_35:
    s_lshr_b32 s24, s2, 3
    s_lshl_b32 s24, s24, 3
    s_add_u32 s24, s24, s3
    s_lshl_b32 s24, s24, 8
    s_sub_u32 s26, s26, L_pc_35-gated_mix__softmax_full_mha__geglu_ffn__prompt_kernel
    s_subb_u32 s27, s27, 0
    v_min_u32 v246, 1, v0
    v_lshl_add_u32 v246, v246, 7, s24
    v_min_u32 v246, K_last-gated_mix__softmax_full_mha__geglu_ffn__prompt_kernel, v246
    v_mov_b32 v247, 0
    v_lshl_add_u64 v[246:247], v[246:247], 0, s[26:27]
    global_load_dword v242, v[246:247], off
    s_mov_b32 s96, s21
    s_mov_b32 s97, s22
    s_mov_b32 s98, s23
    s_and_b32 s25, s2, 7
    s_lshr_b32 s26, s2, 3
    s_lshl_b32 s21, s25, 2
    s_and_b32 s25, s26, 3
    s_add_u32 s21, s21, s25
    s_lshr_b32 s22, s26, 2
    s_and_b32 s23, s3, 3
    s_lshr_b32 s24, s3, 2
    s_lshl_b32 s30, s22, 2
    s_add_u32 s30, s30, s23
    s_mul_i32 s26, s30, 303104
    s_add_u32 s26, s26, 8388608
    s_add_u32 s56, s4, s26
    s_addc_u32 s57, s5, 0
    s_mov_b32 s58, 303104
    s_mov_b32 s59, 0x00020000
    s_lshr_b32 s25, s21, 1
    s_add_u32 s25, s25, 54
    s_lshl_b32 s25, s25, 1
    s_add_u32 s25, s25, s24
    s_lshl_b32 s25, s25, 2
    s_and_b32 s26, s21, 1
    s_add_u32 s25, s25, s26
    s_lshl_b32 s25, s25, 9
    v_and_b32 v13, 15, v0
    v_lshlrev_b32 v13, 4, v13
    v_and_b32 v14, 16, v0
    v_lshl_add_u32 v13, v14, 6, v13
    v_and_b32 v14, 32, v0
    v_lshl_add_u32 v252, v14, 3, v13
    v_add_u32 v252, s25, v252
    s_lshr_b32 s25, s21, 3
    s_add_u32 s25, s25, 70
    s_lshl_b32 s25, s25, 1
    s_add_u32 s25, s25, s24
    s_lshl_b32 s25, s25, 11
    s_lshl_b32 s26, s26, 3
    s_add_u32 s25, s25, s26
    s_and_b32 s26, s21, 6
    s_lshl_b32 s26, s26, 7
    s_add_u32 s25, s25, s26
    v_lshl_add_u32 v253, v14, 19, v13
    v_add_u32 v253, s25, v253
    s_mov_b32 s21, s96
    s_mov_b32 s22, s97
    s_mov_b32 s23, s98
    v_mov_b32 v248, -1
    v_mov_b32 v249, -1
    v_mov_b32 v250, -1
    v_mov_b32 v251, -1
    v_mov_b32 v255, 0
    global_load_dword v255, v255, s[6:7] sc1
    s_waitcnt vmcnt(18)
    ds_read_b64_tr_b16 v[16:17], v4 offset:0
    ds_read_b64_tr_b16 v[18:19], v4 offset:512
    ds_read_b64_tr_b16 v[20:21], v4 offset:32
    ds_read_b64_tr_b16 v[22:23], v4 offset:544
    ds_read_b64_tr_b16 v[24:25], v4 offset:64
    ds_read_b64_tr_b16 v[26:27], v4 offset:576
    ds_read_b64_tr_b16 v[28:29], v4 offset:96
    ds_read_b64_tr_b16 v[30:31], v4 offset:608
    s_waitcnt lgkmcnt(0)
    s_lshl_b32 s24, s20, 3
    s_add_u32 s24, s24, s3
    s_add_u32 s24, s24, 640
    s_mul_i32 s29, s24, 6554
    s_lshr_b32 s29, s29, 16
    s_mul_i32 s30, s29, 10
    s_sub_u32 s30, s24, s30
    s_mov_b32 s26, 5120
    s_mov_b32 s28, 8
    s_cmp_ge_u32 s29, 70
    s_cbranch_scc1 L_ty3_40
    s_sub_u32 s25, s29, 54
    s_mul_i32 s25, s25, 40
    s_mov_b32 s27, 25600
    s_branch L_tyj_41
L_ty3_40:
    s_sub_u32 s25, s29, 70
    s_mul_i32 s25, s25, 160
    s_add_u32 s25, s25, 16
    s_mov_b32 s26, 51200
    s_mov_b32 s27, 102400
    s_mov_b32 s28, 20
L_tyj_41:
    v_mad_u32_u24 v3, v2, s28, v1
    s_mul_i32 s25, s25, 1280
    s_lshl_b32 s31, s30, 7
    s_add_u32 s25, s25, s31
    s_lshl_b32 s43, s30, 2
    s_mul_i32 s42, s29, 5120
    s_mov_b32 s31, 2211840
    s_cmp_ge_u32 s29, 54
    s_cselect_b32 s12, s52, s60
    s_cselect_b32 s13, s53, s61
    s_cselect_b32 s14, 819200, s31
    s_cmp_ge_u32 s29, 74
    s_cselect_b32 s25, 0x7f000000, s25
    s_cselect_b32 s42, 0x7f000000, s42
    s_add_u32 m0, s54, 0
    s_add_u32 s26, s25, s26
    buffer_load_dwordx4 v3, s[12:15], s25 offen lds
    s_add_u32 m0, m0, 1024
    s_add_u32 s25, s25, s27
    buffer_load_dwordx4 v3, s[12:15], s26 offen lds
    s_add_u32 m0, m0, 1024
    s_add_u32 s26, s26, s27
    buffer_load_dwordx4 v3, s[12:15], s25 offen lds
    s_add_u32 m0, m0, 1024
    s_nop 0
    buffer_load_dwordx4 v3, s[12:15], s26 offen lds
    s_mul_i32 s24, s33, 13108
    s_lshr_b32 s24, s24, 16
    s_mul_i32 s24, s24, 373760
    s_lshl_b32 s25, s33, 10
    s_add_u32 s24, s24, s25
    s_add_u32 s24, s24, s32
    s_add_u32 s33, s33, 1
    s_waitcnt lgkmcnt(6)
    buffer_store_dwordx4 v[16:19], v5, s[16:19], s24 offen sc1
    s_mul_i32 s24, s33, 13108
    s_lshr_b32 s24, s24, 16
    s_mul_i32 s24, s24, 373760
    s_lshl_b32 s25, s33, 10
    s_add_u32 s24, s24, s25
    s_add_u32 s24, s24, s32
    s_add_u32 s33, s33, 1
    s_waitcnt lgkmcnt(4)
    buffer_store_dwordx4 v[20:23], v5, s[16:19], s24 offen sc1
    s_mul_i32 s24, s33, 13108
    s_lshr_b32 s24, s24, 16
    s_mul_i32 s24, s24, 373760
    s_lshl_b32 s25, s33, 10
    s_add_u32 s24, s24, s25
    s_add_u32 s24, s24, s32
    s_add_u32 s33, s33, 1
    s_waitcnt lgkmcnt(2)
    buffer_store_dwordx4 v[24:27], v5, s[16:19], s24 offen sc1
    s_mul_i32 s24, s33, 13108
    s_lshr_b32 s24, s24, 16
    s_mul_i32 s24, s24, 373760
    s_lshl_b32 s25, s33, 10
    s_add_u32 s24, s24, s25
    s_add_u32 s24, s24, s32
    s_add_u32 s33, s33, 1
    s_waitcnt lgkmcnt(0)
    buffer_store_dwordx4 v[28:31], v5, s[16:19], s24 offen sc1
    s_waitcnt vmcnt(22)
    ds_read_b64_tr_b16 v[32:33], v4 offset:4096
    ds_read_b64_tr_b16 v[34:35], v4 offset:4608
    ds_read_b64_tr_b16 v[36:37], v4 offset:4128
    ds_read_b64_tr_b16 v[38:39], v4 offset:4640
    ds_read_b64_tr_b16 v[40:41], v4 offset:4160
    ds_read_b64_tr_b16 v[42:43], v4 offset:4672
    ds_read_b64_tr_b16 v[44:45], v4 offset:4192
    ds_read_b64_tr_b16 v[46:47], v4 offset:4704
    s_mul_i32 s24, s35, 13108
    s_lshr_b32 s24, s24, 16
    s_mul_i32 s24, s24, 373760
    s_lshl_b32 s25, s35, 10
    s_add_u32 s24, s24, s25
    s_add_u32 s24, s24, s34
    s_add_u32 s35, s35, 1
    s_waitcnt lgkmcnt(6)
    buffer_store_dwordx4 v[32:35], v5, s[16:19], s24 offen sc1
    s_mul_i32 s24, s35, 13108
    s_lshr_b32 s24, s24, 16
    s_mul_i32 s24, s24, 373760
    s_lshl_b32 s25, s35, 10
    s_add_u32 s24, s24, s25
    s_add_u32 s24, s24, s34
    s_add_u32 s35, s35, 1
    s_waitcnt lgkmcnt(4)
    buffer_store_dwordx4 v[36:39], v5, s[16:19], s24 offen sc1
    s_mul_i32 s24, s35, 13108
    s_lshr_b32 s24, s24, 16
    s_mul_i32 s24, s24, 373760
    s_lshl_b32 s25, s35, 10
    s_add_u32 s24, s24, s25
    s_add_u32 s24, s24, s34
    s_add_u32 s35, s35, 1
    s_waitcnt lgkmcnt(2)
    buffer_store_dwordx4 v[40:43], v5, s[16:19], s24 offen sc1
    s_mul_i32 s24, s35, 13108
    s_lshr_b32 s24, s24, 16
    s_mul_i32 s24, s24, 373760
    s_lshl_b32 s25, s35, 10
    s_add_u32 s24, s24, s25
    s_add_u32 s24, s24, s34
    s_add_u32 s35, s35, 1
    s_waitcnt lgkmcnt(0)
    buffer_store_dwordx4 v[44:47], v5, s[16:19], s24 offen sc1
    s_waitcnt vmcnt(22)
    ds_read_b64_tr_b16 v[48:49], v4 offset:8192
    ds_read_b64_tr_b16 v[50:51], v4 offset:8704
    ds_read_b64_tr_b16 v[52:53], v4 offset:8224
    ds_read_b64_tr_b16 v[54:55], v4 offset:8736
    ds_read_b64_tr_b16 v[56:57], v4 offset:8256
    ds_read_b64_tr_b16 v[58:59], v4 offset:8768
    ds_read_b64_tr_b16 v[60:61], v4 offset:8288
    ds_read_b64_tr_b16 v[62:63], v4 offset:8800
    s_mul_i32 s24, s37, 13108
    s_lshr_b32 s24, s24, 16
    s_mul_i32 s24, s24, 373760
    s_lshl_b32 s25, s37, 10
    s_add_u32 s24, s24, s25
    s_add_u32 s24, s24, s36
    s_add_u32 s37, s37, 1
    s_waitcnt lgkmcnt(6)
    buffer_store_dwordx4 v[48:51], v5, s[16:19], s24 offen sc1
    s_mul_i32 s24, s37, 13108
    s_lshr_b32 s24, s24, 16
    s_mul_i32 s24, s24, 373760
    s_lshl_b32 s25, s37, 10
    s_add_u32 s24, s24, s25
    s_add_u32 s24, s24, s36
    s_add_u32 s37, s37, 1
    s_waitcnt lgkmcnt(4)
    buffer_store_dwordx4 v[52:55], v5, s[16:19], s24 offen sc1
    s_mul_i32 s24, s37, 13108
    s_lshr_b32 s24, s24, 16
    s_mul_i32 s24, s24, 373760
    s_lshl_b32 s25, s37, 10
    s_add_u32 s24, s24, s25
    s_add_u32 s24, s24, s36
    s_add_u32 s37, s37, 1
    s_waitcnt lgkmcnt(2)
    buffer_store_dwordx4 v[56:59], v5, s[16:19], s24 offen sc1
    s_mul_i32 s24, s37, 13108
    s_lshr_b32 s24, s24, 16
    s_mul_i32 s24, s24, 373760
    s_lshl_b32 s25, s37, 10
    s_add_u32 s24, s24, s25
    s_add_u32 s24, s24, s36
    s_add_u32 s37, s37, 1
    s_waitcnt lgkmcnt(0)
    buffer_store_dwordx4 v[60:63], v5, s[16:19], s24 offen sc1
    s_waitcnt vmcnt(22)
    ds_read_b64_tr_b16 v[64:65], v4 offset:12288
    ds_read_b64_tr_b16 v[66:67], v4 offset:12800
    ds_read_b64_tr_b16 v[68:69], v4 offset:12320
    ds_read_b64_tr_b16 v[70:71], v4 offset:12832
    ds_read_b64_tr_b16 v[72:73], v4 offset:12352
    ds_read_b64_tr_b16 v[74:75], v4 offset:12864
    ds_read_b64_tr_b16 v[76:77], v4 offset:12384
    ds_read_b64_tr_b16 v[78:79], v4 offset:12896
    s_mul_i32 s24, s39, 13108
    s_lshr_b32 s24, s24, 16
    s_mul_i32 s24, s24, 373760
    s_lshl_b32 s25, s39, 10
    s_add_u32 s24, s24, s25
    s_add_u32 s24, s24, s38
    s_add_u32 s39, s39, 1
    s_waitcnt lgkmcnt(6)
    buffer_store_dwordx4 v[64:67], v5, s[16:19], s24 offen sc1
    s_mul_i32 s24, s39, 13108
    s_lshr_b32 s24, s24, 16
    s_mul_i32 s24, s24, 373760
    s_lshl_b32 s25, s39, 10
    s_add_u32 s24, s24, s25
    s_add_u32 s24, s24, s38
    s_add_u32 s39, s39, 1
    s_waitcnt lgkmcnt(4)
    buffer_store_dwordx4 v[68:71], v5, s[16:19], s24 offen sc1
    s_mul_i32 s24, s39, 13108
    s_lshr_b32 s24, s24, 16
    s_mul_i32 s24, s24, 373760
    s_lshl_b32 s25, s39, 10
    s_add_u32 s24, s24, s25
    s_add_u32 s24, s24, s38
    s_add_u32 s39, s39, 1
    s_waitcnt lgkmcnt(2)
    buffer_store_dwordx4 v[72:75], v5, s[16:19], s24 offen sc1
    s_mul_i32 s24, s39, 13108
    s_lshr_b32 s24, s24, 16
    s_mul_i32 s24, s24, 373760
    s_lshl_b32 s25, s39, 10
    s_add_u32 s24, s24, s25
    s_add_u32 s24, s24, s38
    s_add_u32 s39, s39, 1
    s_waitcnt lgkmcnt(0)
    buffer_store_dwordx4 v[76:79], v5, s[16:19], s24 offen sc1
    s_waitcnt vmcnt(22)
    ds_read_b64_tr_b16 v[80:81], v4 offset:16384
    ds_read_b64_tr_b16 v[82:83], v4 offset:16896
    ds_read_b64_tr_b16 v[84:85], v4 offset:16416
    ds_read_b64_tr_b16 v[86:87], v4 offset:16928
    ds_read_b64_tr_b16 v[88:89], v4 offset:16448
    ds_read_b64_tr_b16 v[90:91], v4 offset:16960
    ds_read_b64_tr_b16 v[92:93], v4 offset:16480
    ds_read_b64_tr_b16 v[94:95], v4 offset:16992
    s_mul_i32 s24, s41, 13108
    s_lshr_b32 s24, s24, 16
    s_mul_i32 s24, s24, 373760
    s_lshl_b32 s25, s41, 10
    s_add_u32 s24, s24, s25
    s_add_u32 s24, s24, s40
    s_add_u32 s41, s41, 1
    s_waitcnt lgkmcnt(6)
    buffer_store_dwordx4 v[80:83], v5, s[16:19], s24 offen sc1
    s_mul_i32 s24, s41, 13108
    s_lshr_b32 s24, s24, 16
    s_mul_i32 s24, s24, 373760
    s_lshl_b32 s25, s41, 10
    s_add_u32 s24, s24, s25
    s_add_u32 s24, s24, s40
    s_add_u32 s41, s41, 1
    s_waitcnt lgkmcnt(4)
    buffer_store_dwordx4 v[84:87], v5, s[16:19], s24 offen sc1
    s_mul_i32 s24, s41, 13108
    s_lshr_b32 s24, s24, 16
    s_mul_i32 s24, s24, 373760
    s_lshl_b32 s25, s41, 10
    s_add_u32 s24, s24, s25
    s_add_u32 s24, s24, s40
    s_add_u32 s41, s41, 1
    s_waitcnt lgkmcnt(2)
    buffer_store_dwordx4 v[88:91], v5, s[16:19], s24 offen sc1
    s_mul_i32 s24, s41, 13108
    s_lshr_b32 s24, s24, 16
    s_mul_i32 s24, s24, 373760
    s_lshl_b32 s25, s41, 10
    s_add_u32 s24, s24, s25
    s_add_u32 s24, s24, s40
    s_add_u32 s41, s41, 1
    s_waitcnt lgkmcnt(0)
    buffer_store_dwordx4 v[92:95], v5, s[16:19], s24 offen sc1
    s_waitcnt vmcnt(20)
    ds_read_b64_tr_b16 v[96:97], v4 offset:0
    ds_read_b64_tr_b16 v[98:99], v4 offset:512
    ds_read_b64_tr_b16 v[100:101], v4 offset:32
    ds_read_b64_tr_b16 v[102:103], v4 offset:544
    ds_read_b64_tr_b16 v[104:105], v4 offset:64
    ds_read_b64_tr_b16 v[106:107], v4 offset:576
    ds_read_b64_tr_b16 v[108:109], v4 offset:96
    ds_read_b64_tr_b16 v[110:111], v4 offset:608
    s_mul_i32 s24, s43, 13108
    s_lshr_b32 s24, s24, 16
    s_mul_i32 s24, s24, 373760
    s_lshl_b32 s25, s43, 10
    s_add_u32 s24, s24, s25
    s_add_u32 s24, s24, s42
    s_add_u32 s43, s43, 1
    s_waitcnt lgkmcnt(6)
    buffer_store_dwordx4 v[96:99], v5, s[16:19], s24 offen sc1
    s_mul_i32 s24, s43, 13108
    s_lshr_b32 s24, s24, 16
    s_mul_i32 s24, s24, 373760
    s_lshl_b32 s25, s43, 10
    s_add_u32 s24, s24, s25
    s_add_u32 s24, s24, s42
    s_add_u32 s43, s43, 1
    s_waitcnt lgkmcnt(4)
    buffer_store_dwordx4 v[100:103], v5, s[16:19], s24 offen sc1
    s_mul_i32 s24, s43, 13108
    s_lshr_b32 s24, s24, 16
    s_mul_i32 s24, s24, 373760
    s_lshl_b32 s25, s43, 10
    s_add_u32 s24, s24, s25
    s_add_u32 s24, s24, s42
    s_add_u32 s43, s43, 1
    s_waitcnt lgkmcnt(2)
    buffer_store_dwordx4 v[104:107], v5, s[16:19], s24 offen sc1
    s_mul_i32 s24, s43, 13108
    s_lshr_b32 s24, s24, 16
    s_mul_i32 s24, s24, 373760
    s_lshl_b32 s25, s43, 10
    s_add_u32 s24, s24, s25
    s_add_u32 s24, s24, s42
    s_add_u32 s43, s43, 1
    s_waitcnt lgkmcnt(0)
    buffer_store_dwordx4 v[108:111], v5, s[16:19], s24 offen sc1
    s_mul_i32 s24, s3, 20480
    v_lshrrev_b32 v6, 4, v0
    v_mul_u32_u24 v7, 1280, v6
    v_and_b32 v8, 15, v0
    v_lshlrev_b32 v9, 4, v8
    v_add3_u32 v7, v7, v9, s24
    global_load_dwordx4 v[192:195], v9, s[62:63] offset:0
    global_load_dwordx4 v[196:199], v9, s[62:63] offset:256
    global_load_dwordx4 v[200:203], v9, s[62:63] offset:512
    global_load_dwordx4 v[204:207], v9, s[62:63] offset:768
    global_load_dwordx4 v[208:211], v9, s[62:63] offset:1024
    s_mov_b32 s25, 0
    buffer_load_dwordx4 v[112:115], v7, s[8:11], s25 offen offset:0
    buffer_load_dwordx4 v[116:119], v7, s[8:11], s25 offen offset:256
    buffer_load_dwordx4 v[120:123], v7, s[8:11], s25 offen offset:512
    buffer_load_dwordx4 v[124:127], v7, s[8:11], s25 offen offset:768
    buffer_load_dwordx4 v[128:131], v7, s[8:11], s25 offen offset:1024
    s_mov_b32 s25, 5120
    buffer_load_dwordx4 v[132:135], v7, s[8:11], s25 offen offset:0
    buffer_load_dwordx4 v[136:139], v7, s[8:11], s25 offen offset:256
    buffer_load_dwordx4 v[140:143], v7, s[8:11], s25 offen offset:512
    buffer_load_dwordx4 v[144:147], v7, s[8:11], s25 offen offset:768
    buffer_load_dwordx4 v[148:151], v7, s[8:11], s25 offen offset:1024
    s_mov_b32 s25, 10240
    buffer_load_dwordx4 v[152:155], v7, s[8:11], s25 offen offset:0
    buffer_load_dwordx4 v[156:159], v7, s[8:11], s25 offen offset:256
    buffer_load_dwordx4 v[160:163], v7, s[8:11], s25 offen offset:512
    buffer_load_dwordx4 v[164:167], v7, s[8:11], s25 offen offset:768
    buffer_load_dwordx4 v[168:171], v7, s[8:11], s25 offen offset:1024
    s_mov_b32 s25, 15360
    buffer_load_dwordx4 v[172:175], v7, s[8:11], s25 offen offset:0
    buffer_load_dwordx4 v[176:179], v7, s[8:11], s25 offen offset:256
    buffer_load_dwordx4 v[180:183], v7, s[8:11], s25 offen offset:512
    buffer_load_dwordx4 v[184:187], v7, s[8:11], s25 offen offset:768
    buffer_load_dwordx4 v[188:191], v7, s[8:11], s25 offen offset:1024
    s_lshl_b32 s25, s20, 9
    s_add_u32 s25, s25, 23068672
    s_add_u32 s16, s4, s25
    s_addc_u32 s17, s5, 0
    s_mov_b32 s18, 512
    s_lshl_b32 s24, s3, 4
    v_and_b32 v9, 3, v0
    v_lshl_add_u32 v6, v9, 2, v6
    v_add_u32 v6, s24, v6
    v_lshlrev_b32 v6, 2, v6
    v_and_b32 v8, 12, v0
    v_lshl_add_u32 v6, v8, 20, v6
    v_mov_b32 v16, 0
    v_mov_b32 v17, 0
    s_waitcnt vmcnt(15)
    v_dot2_f32_bf16 v16, v112, v192, v16
    v_dot2_f32_bf16 v17, v113, v193, v17
    v_dot2_f32_bf16 v16, v114, v194, v16
    v_dot2_f32_bf16 v17, v115, v195, v17
    v_dot2_f32_bf16 v16, v116, v196, v16
    v_dot2_f32_bf16 v17, v117, v197, v17
    v_dot2_f32_bf16 v16, v118, v198, v16
    v_dot2_f32_bf16 v17, v119, v199, v17
    v_dot2_f32_bf16 v16, v120, v200, v16
    v_dot2_f32_bf16 v17, v121, v201, v17
    v_dot2_f32_bf16 v16, v122, v202, v16
    v_dot2_f32_bf16 v17, v123, v203, v17
    v_dot2_f32_bf16 v16, v124, v204, v16
    v_dot2_f32_bf16 v17, v125, v205, v17
    v_dot2_f32_bf16 v16, v126, v206, v16
    v_dot2_f32_bf16 v17, v127, v207, v17
    v_dot2_f32_bf16 v16, v128, v208, v16
    v_dot2_f32_bf16 v17, v129, v209, v17
    v_dot2_f32_bf16 v16, v130, v210, v16
    v_dot2_f32_bf16 v17, v131, v211, v17
    v_mov_b32 v18, 0
    v_mov_b32 v19, 0
    s_waitcnt vmcnt(10)
    v_dot2_f32_bf16 v18, v132, v192, v18
    v_dot2_f32_bf16 v19, v133, v193, v19
    v_dot2_f32_bf16 v18, v134, v194, v18
    v_dot2_f32_bf16 v19, v135, v195, v19
    v_dot2_f32_bf16 v18, v136, v196, v18
    v_dot2_f32_bf16 v19, v137, v197, v19
    v_dot2_f32_bf16 v18, v138, v198, v18
    v_dot2_f32_bf16 v19, v139, v199, v19
    v_dot2_f32_bf16 v18, v140, v200, v18
    v_dot2_f32_bf16 v19, v141, v201, v19
    v_dot2_f32_bf16 v18, v142, v202, v18
    v_dot2_f32_bf16 v19, v143, v203, v19
    v_dot2_f32_bf16 v18, v144, v204, v18
    v_dot2_f32_bf16 v19, v145, v205, v19
    v_dot2_f32_bf16 v18, v146, v206, v18
    v_dot2_f32_bf16 v19, v147, v207, v19
    v_dot2_f32_bf16 v18, v148, v208, v18
    v_dot2_f32_bf16 v19, v149, v209, v19
    v_dot2_f32_bf16 v18, v150, v210, v18
    v_dot2_f32_bf16 v19, v151, v211, v19
    v_mov_b32 v20, 0
    v_mov_b32 v21, 0
    s_waitcnt vmcnt(5)
    v_dot2_f32_bf16 v20, v152, v192, v20
    v_dot2_f32_bf16 v21, v153, v193, v21
    v_dot2_f32_bf16 v20, v154, v194, v20
    v_dot2_f32_bf16 v21, v155, v195, v21
    v_dot2_f32_bf16 v20, v156, v196, v20
    v_dot2_f32_bf16 v21, v157, v197, v21
    v_dot2_f32_bf16 v20, v158, v198, v20
    v_dot2_f32_bf16 v21, v159, v199, v21
    v_dot2_f32_bf16 v20, v160, v200, v20
    v_dot2_f32_bf16 v21, v161, v201, v21
    v_dot2_f32_bf16 v20, v162, v202, v20
    v_dot2_f32_bf16 v21, v163, v203, v21
    v_dot2_f32_bf16 v20, v164, v204, v20
    v_dot2_f32_bf16 v21, v165, v205, v21
    v_dot2_f32_bf16 v20, v166, v206, v20
    v_dot2_f32_bf16 v21, v167, v207, v21
    v_dot2_f32_bf16 v20, v168, v208, v20
    v_dot2_f32_bf16 v21, v169, v209, v21
    v_dot2_f32_bf16 v20, v170, v210, v20
    v_dot2_f32_bf16 v21, v171, v211, v21
    v_mov_b32 v22, 0
    v_mov_b32 v23, 0
    s_waitcnt vmcnt(0)
    v_dot2_f32_bf16 v22, v172, v192, v22
    v_dot2_f32_bf16 v23, v173, v193, v23
    v_dot2_f32_bf16 v22, v174, v194, v22
    v_dot2_f32_bf16 v23, v175, v195, v23
    v_dot2_f32_bf16 v22, v176, v196, v22
    v_dot2_f32_bf16 v23, v177, v197, v23
    v_dot2_f32_bf16 v22, v178, v198, v22
    v_dot2_f32_bf16 v23, v179, v199, v23
    v_dot2_f32_bf16 v22, v180, v200, v22
    v_dot2_f32_bf16 v23, v181, v201, v23
    v_dot2_f32_bf16 v22, v182, v202, v22
    v_dot2_f32_bf16 v23, v183, v203, v23
    v_dot2_f32_bf16 v22, v184, v204, v22
    v_dot2_f32_bf16 v23, v185, v205, v23
    v_dot2_f32_bf16 v22, v186, v206, v22
    v_dot2_f32_bf16 v23, v187, v207, v23
    v_dot2_f32_bf16 v22, v188, v208, v22
    v_dot2_f32_bf16 v23, v189, v209, v23
    v_dot2_f32_bf16 v22, v190, v210, v22
    v_dot2_f32_bf16 v23, v191, v211, v23
    s_nop 3
    v_add_f32 v16, v16, v17
    v_add_f32 v18, v18, v19
    v_add_f32 v20, v20, v21
    v_add_f32 v22, v22, v23
    s_nop 0
    v_add_f32_dpp v16, v16, v16 row_ror:8 row_mask:0xf bank_mask:0xf
    v_add_f32_dpp v18, v18, v18 row_ror:8 row_mask:0xf bank_mask:0xf
    v_add_f32_dpp v20, v20, v20 row_ror:8 row_mask:0xf bank_mask:0xf
    v_add_f32_dpp v22, v22, v22 row_ror:8 row_mask:0xf bank_mask:0xf
    s_nop 0
    v_add_f32_dpp v16, v16, v16 row_ror:4 row_mask:0xf bank_mask:0xf
    v_add_f32_dpp v18, v18, v18 row_ror:4 row_mask:0xf bank_mask:0xf
    v_add_f32_dpp v20, v20, v20 row_ror:4 row_mask:0xf bank_mask:0xf
    v_add_f32_dpp v22, v22, v22 row_ror:4 row_mask:0xf bank_mask:0xf
    s_nop 0
    v_add_f32_dpp v16, v16, v16 row_ror:2 row_mask:0xf bank_mask:0xf
    v_add_f32_dpp v18, v18, v18 row_ror:2 row_mask:0xf bank_mask:0xf
    v_add_f32_dpp v20, v20, v20 row_ror:2 row_mask:0xf bank_mask:0xf
    v_add_f32_dpp v22, v22, v22 row_ror:2 row_mask:0xf bank_mask:0xf
    s_nop 0
    v_add_f32_dpp v16, v16, v16 row_ror:1 row_mask:0xf bank_mask:0xf
    v_add_f32_dpp v18, v18, v18 row_ror:1 row_mask:0xf bank_mask:0xf
    v_add_f32_dpp v20, v20, v20 row_ror:1 row_mask:0xf bank_mask:0xf
    v_add_f32_dpp v22, v22, v22 row_ror:1 row_mask:0xf bank_mask:0xf
    v_cmp_eq_u32 vcc, 1, v9
    s_nop 1
    v_cndmask_b32 v16, v16, v18, vcc
    v_cmp_eq_u32 vcc, 2, v9
    s_nop 1
    v_cndmask_b32 v16, v16, v20, vcc
    v_cmp_eq_u32 vcc, 3, v9
    s_nop 1
    v_cndmask_b32 v16, v16, v22, vcc
    v_mul_f32 v16, 0x3fb8aa3b, v16
    v_min_f32 v16, 0x42200000, v16
    v_exp_f32 v16, v16
    s_nop 0
    buffer_store_dword v16, v6, s[16:19], 0 offen sc1
    s_branch K_pub
K_qkv:
    s_cmp_ge_u32 s21, 14
    s_cbranch_scc1 K_v
    s_add_u32 s37, s37, s38
    s_add_u32 m0, s33, 70656
    s_nop 0
    buffer_load_dwordx4 v2, s[12:15], s37 offen lds
    s_add_u32 m0, s34, 70656
    s_nop 0
    buffer_load_dwordx4 v3, s[12:15], s37 offen lds
    s_add_u32 m0, s35, 70656
    s_nop 0
    buffer_load_dwordx4 v4, s[12:15], s37 offen lds
    v_and_b32 v13, 15, v0
    v_lshrrev_b32 v14, 4, v0
    v_lshrrev_b32 v15, 1, v13
    v_xor_b32 v15, v15, v14
    v_lshlrev_b32 v15, 4, v15
    v_lshl_add_u32 v15, v13, 7, v15
    s_lshl_b32 s24, s22, 13
    v_add_u32 v5, s24, v15
    v_xor_b32 v6, 4096, v5
    v_xor_b32 v7, 64, v5
    v_xor_b32 v8, 64, v6
    v_lshrrev_b32 v13, 2, v0
    v_and_b32 v15, 7, v13
    v_and_b32 v13, 8, v13
    v_lshl_or_b32 v15, v13, 1, v15
    v_mul_u32_u24 v15, 672, v15
    v_and_b32 v13, 3, v0
    v_mul_u32_u24 v13, 40, v13
    s_mul_i32 s24, s23, 160
    s_add_u32 s24, s24, 49152
    v_add3_u32 v9, v13, v15, s24
    v_add_u32 v10, 43008, v9
    buffer_load_dword v243, v241, s[8:11], 0 offen offset:256
    s_mul_i32 s25, s38, 4
    buffer_load_dword v242, v240, s[12:15], s25 offen
    s_getpc_b64 s[26:27]
L_pc_43:
    s_lshr_b32 s24, s2, 3
    s_lshl_b32 s24, s24, 3
    s_add_u32 s24, s24, s3
    s_lshl_b32 s24, s24, 8
    s_sub_u32 s26, s26, L_pc_43-gated_mix__softmax_full_mha__geglu_ffn__prompt_kernel
    s_subb_u32 s27, s27, 0
    v_min_u32 v246, 1, v0
    v_lshl_add_u32 v246, v246, 7, s24
    v_min_u32 v246, K_last-gated_mix__softmax_full_mha__geglu_ffn__prompt_kernel, v246
    v_mov_b32 v247, 0
    v_lshl_add_u64 v[246:247], v[246:247], 0, s[26:27]
    global_load_dword v242, v[246:247], off
    s_mov_b32 s96, s21
    s_mov_b32 s97, s22
    s_mov_b32 s98, s23
    s_and_b32 s25, s2, 7
    s_lshr_b32 s26, s2, 3
    s_lshl_b32 s21, s25, 2
    s_and_b32 s25, s26, 3
    s_add_u32 s21, s21, s25
    s_lshr_b32 s22, s26, 2
    s_and_b32 s23, s3, 3
    s_lshr_b32 s24, s3, 2
    s_lshl_b32 s30, s22, 2
    s_add_u32 s30, s30, s23
    s_mul_i32 s26, s30, 303104
    s_add_u32 s26, s26, 8388608
    s_add_u32 s56, s4, s26
    s_addc_u32 s57, s5, 0
    s_mov_b32 s58, 303104
    s_mov_b32 s59, 0x00020000
    s_lshr_b32 s25, s21, 1
    s_add_u32 s25, s25, 54
    s_lshl_b32 s25, s25, 1
    s_add_u32 s25, s25, s24
    s_lshl_b32 s25, s25, 2
    s_and_b32 s26, s21, 1
    s_add_u32 s25, s25, s26
    s_lshl_b32 s25, s25, 9
    v_and_b32 v13, 15, v0
    v_lshlrev_b32 v13, 4, v13
    v_and_b32 v14, 16, v0
    v_lshl_add_u32 v13, v14, 6, v13
    v_and_b32 v14, 32, v0
    v_lshl_add_u32 v252, v14, 3, v13
    v_add_u32 v252, s25, v252
    s_lshr_b32 s25, s21, 3
    s_add_u32 s25, s25, 70
    s_lshl_b32 s25, s25, 1
    s_add_u32 s25, s25, s24
    s_lshl_b32 s25, s25, 11
    s_lshl_b32 s26, s26, 3
    s_add_u32 s25, s25, s26
    s_and_b32 s26, s21, 6
    s_lshl_b32 s26, s26, 7
    s_add_u32 s25, s25, s26
    v_lshl_add_u32 v253, v14, 19, v13
    v_add_u32 v253, s25, v253
    s_mov_b32 s21, s96
    s_mov_b32 s22, s97
    s_mov_b32 s23, s98
    v_mov_b32 v248, -1
    v_mov_b32 v249, -1
    v_mov_b32 v250, -1
    v_mov_b32 v251, -1
    s_waitcnt vmcnt(6)
    s_barrier
    ds_read_b128 v[16:19], v5 offset:0
    ds_read_b128 v[20:23], v5 offset:2048
    ds_read_b128 v[24:27], v6 offset:0
    ds_read_b128 v[28:31], v6 offset:2048
    ds_read_b64_tr_b16 v[32:33], v9 offset:0
    ds_read_b64_tr_b16 v[34:35], v9 offset:5376
    ds_read_b64_tr_b16 v[36:37], v9 offset:8
    ds_read_b64_tr_b16 v[38:39], v9 offset:5384
    ds_read_b64_tr_b16 v[40:41], v9 offset:16
    ds_read_b64_tr_b16 v[42:43], v9 offset:5392
    ds_read_b64_tr_b16 v[44:45], v9 offset:24
    ds_read_b64_tr_b16 v[46:47], v9 offset:5400
    ds_read_b64_tr_b16 v[48:49], v9 offset:32
    ds_read_b64_tr_b16 v[50:51], v9 offset:5408
    s_add_u32 s37, s37, s38
    s_add_u32 m0, s33, 92160
    s_nop 0
    buffer_load_dwordx4 v2, s[12:15], s37 offen lds
    s_add_u32 m0, s34, 92160
    s_nop 0
    buffer_load_dwordx4 v3, s[12:15], s37 offen lds
    s_add_u32 m0, s35, 92160
    s_nop 0
    buffer_load_dwordx4 v4, s[12:15], s37 offen lds
    s_add_u32 m0, s32, 16384
    s_mov_b32 s36, 128
    buffer_load_dwordx4 v1, s[8:11], s36 offen lds
    s_add_u32 m0, s32, 24576
    s_mov_b32 s36, 82048
    buffer_load_dwordx4 v1, s[8:11], s36 offen lds
    s_waitcnt vmcnt(8) lgkmcnt(0)
    s_barrier
    v_mfma_f32_16x16x32_bf16 v[96:99], v[32:35], v[16:19], 0
    ds_read_b128 v[56:59], v7 offset:0
    s_add_u32 s37, s37, s38
    s_add_u32 m0, s33, 113664
    s_nop 0
    buffer_load_dwordx4 v2, s[12:15], s37 offen lds
    v_mfma_f32_16x16x32_bf16 v[100:103], v[36:39], v[16:19], 0
    ds_read_b128 v[60:63], v7 offset:2048
    v_mfma_f32_16x16x32_bf16 v[104:107], v[40:43], v[16:19], 0
    ds_read_b128 v[64:67], v8 offset:0
    v_mfma_f32_16x16x32_bf16 v[108:111], v[44:47], v[16:19], 0
    ds_read_b128 v[68:71], v8 offset:2048
    s_add_u32 m0, s34, 113664
    s_nop 0
    buffer_load_dwordx4 v3, s[12:15], s37 offen lds
    v_mfma_f32_16x16x32_bf16 v[112:115], v[48:51], v[16:19], 0
    ds_read_b64_tr_b16 v[72:73], v9 offset:21504
    v_mfma_f32_16x16x32_bf16 v[116:119], v[32:35], v[20:23], 0
    ds_read_b64_tr_b16 v[74:75], v9 offset:26880
    s_add_u32 m0, s35, 113664
    s_nop 0
    buffer_load_dwordx4 v4, s[12:15], s37 offen lds
    v_mfma_f32_16x16x32_bf16 v[120:123], v[36:39], v[20:23], 0
    ds_read_b64_tr_b16 v[76:77], v9 offset:21512
    v_mfma_f32_16x16x32_bf16 v[124:127], v[40:43], v[20:23], 0
    ds_read_b64_tr_b16 v[78:79], v9 offset:26888
    v_mfma_f32_16x16x32_bf16 v[128:131], v[44:47], v[20:23], 0
    ds_read_b64_tr_b16 v[80:81], v9 offset:21520
    s_add_u32 s37, s37, s38
    s_add_u32 m0, s33, 135168
    s_nop 0
    buffer_load_dwordx4 v2, s[12:15], s37 offen lds
    v_mfma_f32_16x16x32_bf16 v[132:135], v[48:51], v[20:23], 0
    ds_read_b64_tr_b16 v[82:83], v9 offset:26896
    v_mfma_f32_16x16x32_bf16 v[136:139], v[32:35], v[24:27], 0
    ds_read_b64_tr_b16 v[84:85], v9 offset:21528
    s_add_u32 m0, s34, 135168
    s_nop 0
    buffer_load_dwordx4 v3, s[12:15], s37 offen lds
    v_mfma_f32_16x16x32_bf16 v[140:143], v[36:39], v[24:27], 0
    ds_read_b64_tr_b16 v[86:87], v9 offset:26904
    v_mfma_f32_16x16x32_bf16 v[144:147], v[40:43], v[24:27], 0
    ds_read_b64_tr_b16 v[88:89], v9 offset:21536
    s_add_u32 m0, s35, 135168
    s_nop 0
    buffer_load_dwordx4 v4, s[12:15], s37 offen lds
    v_mfma_f32_16x16x32_bf16 v[148:151], v[44:47], v[24:27], 0
    ds_read_b64_tr_b16 v[90:91], v9 offset:26912
    v_mfma_f32_16x16x32_bf16 v[152:155], v[48:51], v[24:27], 0
    v_mfma_f32_16x16x32_bf16 v[156:159], v[32:35], v[28:31], 0
    s_add_u32 m0, s32, 32768
    s_mov_b32 s36, 256
    buffer_load_dwordx4 v1, s[8:11], s36 offen lds
    v_mfma_f32_16x16x32_bf16 v[160:163], v[36:39], v[28:31], 0
    v_mfma_f32_16x16x32_bf16 v[164:167], v[40:43], v[28:31], 0
    s_add_u32 m0, s32, 40960
    s_mov_b32 s36, 82176
    buffer_load_dwordx4 v1, s[8:11], s36 offen lds
    v_mfma_f32_16x16x32_bf16 v[168:171], v[44:47], v[28:31], 0
    v_mfma_f32_16x16x32_bf16 v[172:175], v[48:51], v[28:31], 0
    s_waitcnt vmcnt(8) lgkmcnt(0)
    s_barrier
    v_mfma_f32_16x16x32_bf16 v[96:99], v[72:75], v[56:59], v[96:99]
    ds_read_b128 v[16:19], v5 offset:16384
    s_add_u32 s37, s37, s38
    s_add_u32 m0, s33, 49152
    s_nop 0
    buffer_load_dwordx4 v2, s[12:15], s37 offen lds
    v_mfma_f32_16x16x32_bf16 v[100:103], v[76:79], v[56:59], v[100:103]
    ds_read_b128 v[20:23], v5 offset:18432
    v_mfma_f32_16x16x32_bf16 v[104:107], v[80:83], v[56:59], v[104:107]
    ds_read_b128 v[24:27], v6 offset:16384
    v_mfma_f32_16x16x32_bf16 v[108:111], v[84:87], v[56:59], v[108:111]
    ds_read_b128 v[28:31], v6 offset:18432
    s_add_u32 m0, s34, 49152
    s_nop 0
    buffer_load_dwordx4 v3, s[12:15], s37 offen lds
    v_mfma_f32_16x16x32_bf16 v[112:115], v[88:91], v[56:59], v[112:115]
    ds_read_b64_tr_b16 v[32:33], v10 offset:0
    v_mfma_f32_16x16x32_bf16 v[116:119], v[72:75], v[60:63], v[116:119]
    ds_read_b64_tr_b16 v[34:35], v10 offset:5376
    s_add_u32 m0, s35, 49152
    s_nop 0
    buffer_load_dwordx4 v4, s[12:15], s37 offen lds
    v_mfma_f32_16x16x32_bf16 v[120:123], v[76:79], v[60:63], v[120:123]
    ds_read_b64_tr_b16 v[36:37], v10 offset:8
    v_mfma_f32_16x16x32_bf16 v[124:127], v[80:83], v[60:63], v[124:127]
    ds_read_b64_tr_b16 v[38:39], v10 offset:5384
    s_add_u32 s37, s37, s38
    s_add_u32 m0, s33, 70656
    s_nop 0
    buffer_load_dwordx4 v2, s[12:15], s37 offen lds
    v_mfma_f32_16x16x32_bf16 v[128:131], v[84:87], v[60:63], v[128:131]
    ds_read_b64_tr_b16 v[40:41], v10 offset:16
    v_mfma_f32_16x16x32_bf16 v[132:135], v[88:91], v[60:63], v[132:135]
    ds_read_b64_tr_b16 v[42:43], v10 offset:5392
    s_add_u32 m0, s34, 70656
    s_nop 0
    buffer_load_dwordx4 v3, s[12:15], s37 offen lds
    v_mfma_f32_16x16x32_bf16 v[136:139], v[72:75], v[64:67], v[136:139]
    ds_read_b64_tr_b16 v[44:45], v10 offset:24
    v_mfma_f32_16x16x32_bf16 v[140:143], v[76:79], v[64:67], v[140:143]
    ds_read_b64_tr_b16 v[46:47], v10 offset:5400
    s_add_u32 m0, s35, 70656
    s_nop 0
    buffer_load_dwordx4 v4, s[12:15], s37 offen lds
    v_mfma_f32_16x16x32_bf16 v[144:147], v[80:83], v[64:67], v[144:147]
    ds_read_b64_tr_b16 v[48:49], v10 offset:32
    v_mfma_f32_16x16x32_bf16 v[148:151], v[84:87], v[64:67], v[148:151]
    ds_read_b64_tr_b16 v[50:51], v10 offset:5408
    s_add_u32 m0, s32, 0
    s_mov_b32 s36, 384
    buffer_load_dwordx4 v1, s[8:11], s36 offen lds
    v_mfma_f32_16x16x32_bf16 v[152:155], v[88:91], v[64:67], v[152:155]
    v_mfma_f32_16x16x32_bf16 v[156:159], v[72:75], v[68:71], v[156:159]
    s_add_u32 m0, s32, 8192
    s_mov_b32 s36, 82304
    buffer_load_dwordx4 v1, s[8:11], s36 offen lds
    v_mfma_f32_16x16x32_bf16 v[160:163], v[76:79], v[68:71], v[160:163]
    v_mfma_f32_16x16x32_bf16 v[164:167], v[80:83], v[68:71], v[164:167]
    s_or_b32 s24, s2, s3
    s_cbranch_scc1 L_noi_42
    v_mov_b32 v13, 0
    v_mov_b32 v14, 1
    s_mov_b64 exec, 1
    global_store_dword v13, v14, s[6:7] sc1
    s_mov_b64 exec, -1
L_noi_42:
    v_mfma_f32_16x16x32_bf16 v[168:171], v[84:87], v[68:71], v[168:171]
    v_mfma_f32_16x16x32_bf16 v[172:175], v[88:91], v[68:71], v[172:175]
    s_waitcnt vmcnt(13) lgkmcnt(0)
    s_barrier
    v_mfma_f32_16x16x32_bf16 v[96:99], v[32:35], v[16:19], v[96:99]
    ds_read_b128 v[56:59], v7 offset:16384
    s_add_u32 s37, s37, s38
    s_add_u32 m0, s33, 92160
    s_nop 0
    buffer_load_dwordx4 v2, s[12:15], s37 offen lds
    v_mfma_f32_16x16x32_bf16 v[100:103], v[36:39], v[16:19], v[100:103]
    ds_read_b128 v[60:63], v7 offset:18432
    v_mfma_f32_16x16x32_bf16 v[104:107], v[40:43], v[16:19], v[104:107]
    ds_read_b128 v[64:67], v8 offset:16384
    v_mfma_f32_16x16x32_bf16 v[108:111], v[44:47], v[16:19], v[108:111]
    ds_read_b128 v[68:71], v8 offset:18432
    v_mfma_f32_16x16x32_bf16 v[112:115], v[48:51], v[16:19], v[112:115]
    ds_read_b64_tr_b16 v[72:73], v10 offset:21504
    s_add_u32 m0, s34, 92160
    s_nop 0
    buffer_load_dwordx4 v3, s[12:15], s37 offen lds
    v_mfma_f32_16x16x32_bf16 v[116:119], v[32:35], v[20:23], v[116:119]
    ds_read_b64_tr_b16 v[74:75], v10 offset:26880
    v_mfma_f32_16x16x32_bf16 v[120:123], v[36:39], v[20:23], v[120:123]
    ds_read_b64_tr_b16 v[76:77], v10 offset:21512
    v_mfma_f32_16x16x32_bf16 v[124:127], v[40:43], v[20:23], v[124:127]
    ds_read_b64_tr_b16 v[78:79], v10 offset:26888
    v_mfma_f32_16x16x32_bf16 v[128:131], v[44:47], v[20:23], v[128:131]
    ds_read_b64_tr_b16 v[80:81], v10 offset:21520
    s_add_u32 m0, s35, 92160
    s_nop 0
    buffer_load_dwordx4 v4, s[12:15], s37 offen lds
    v_mfma_f32_16x16x32_bf16 v[132:135], v[48:51], v[20:23], v[132:135]
    ds_read_b64_tr_b16 v[82:83], v10 offset:26896
    v_mfma_f32_16x16x32_bf16 v[136:139], v[32:35], v[24:27], v[136:139]
    ds_read_b64_tr_b16 v[84:85], v10 offset:21528
    v_mfma_f32_16x16x32_bf16 v[140:143], v[36:39], v[24:27], v[140:143]
    ds_read_b64_tr_b16 v[86:87], v10 offset:26904
    v_mfma_f32_16x16x32_bf16 v[144:147], v[40:43], v[24:27], v[144:147]
    ds_read_b64_tr_b16 v[88:89], v10 offset:21536
    buffer_load_dword v243, v241, s[8:11], 0 offen offset:512
    v_mfma_f32_16x16x32_bf16 v[148:151], v[44:47], v[24:27], v[148:151]
    ds_read_b64_tr_b16 v[90:91], v10 offset:26912
    v_mfma_f32_16x16x32_bf16 v[152:155], v[48:51], v[24:27], v[152:155]
    v_mfma_f32_16x16x32_bf16 v[156:159], v[32:35], v[28:31], v[156:159]
    v_mfma_f32_16x16x32_bf16 v[160:163], v[36:39], v[28:31], v[160:163]
    s_mul_i32 s25, s38, 8
    buffer_load_dword v242, v240, s[12:15], s25 offen
    v_mfma_f32_16x16x32_bf16 v[164:167], v[40:43], v[28:31], v[164:167]
    v_mfma_f32_16x16x32_bf16 v[168:171], v[44:47], v[28:31], v[168:171]
    v_mfma_f32_16x16x32_bf16 v[172:175], v[48:51], v[28:31], v[172:175]
    s_waitcnt vmcnt(13) lgkmcnt(0)
    s_barrier
    v_mfma_f32_16x16x32_bf16 v[96:99], v[72:75], v[56:59], v[96:99]
    ds_read_b128 v[16:19], v5 offset:32768
    s_add_u32 s37, s37, s38
    s_add_u32 m0, s33, 113664
    s_nop 0
    buffer_load_dwordx4 v2, s[12:15], s37 offen lds
    v_mfma_f32_16x16x32_bf16 v[100:103], v[76:79], v[56:59], v[100:103]
    ds_read_b128 v[20:23], v5 offset:34816
    v_mfma_f32_16x16x32_bf16 v[104:107], v[80:83], v[56:59], v[104:107]
    ds_read_b128 v[24:27], v6 offset:32768
    v_mfma_f32_16x16x32_bf16 v[108:111], v[84:87], v[56:59], v[108:111]
    ds_read_b128 v[28:31], v6 offset:34816
    v_mfma_f32_16x16x32_bf16 v[112:115], v[88:91], v[56:59], v[112:115]
    ds_read_b64_tr_b16 v[32:33], v10 offset:43008
    s_add_u32 m0, s34, 113664
    s_nop 0
    buffer_load_dwordx4 v3, s[12:15], s37 offen lds
    v_mfma_f32_16x16x32_bf16 v[116:119], v[72:75], v[60:63], v[116:119]
    ds_read_b64_tr_b16 v[34:35], v10 offset:48384
    v_mfma_f32_16x16x32_bf16 v[120:123], v[76:79], v[60:63], v[120:123]
    ds_read_b64_tr_b16 v[36:37], v10 offset:43016
    v_mfma_f32_16x16x32_bf16 v[124:127], v[80:83], v[60:63], v[124:127]
    ds_read_b64_tr_b16 v[38:39], v10 offset:48392
    v_mfma_f32_16x16x32_bf16 v[128:131], v[84:87], v[60:63], v[128:131]
    ds_read_b64_tr_b16 v[40:41], v10 offset:43024
    s_add_u32 m0, s35, 113664
    s_nop 0
    buffer_load_dwordx4 v4, s[12:15], s37 offen lds
    v_mfma_f32_16x16x32_bf16 v[132:135], v[88:91], v[60:63], v[132:135]
    ds_read_b64_tr_b16 v[42:43], v10 offset:48400
    v_mfma_f32_16x16x32_bf16 v[136:139], v[72:75], v[64:67], v[136:139]
    ds_read_b64_tr_b16 v[44:45], v10 offset:43032
    v_mfma_f32_16x16x32_bf16 v[140:143], v[76:79], v[64:67], v[140:143]
    ds_read_b64_tr_b16 v[46:47], v10 offset:48408
    v_mfma_f32_16x16x32_bf16 v[144:147], v[80:83], v[64:67], v[144:147]
    ds_read_b64_tr_b16 v[48:49], v10 offset:43040
    s_add_u32 m0, s32, 16384
    s_mov_b32 s36, 512
    buffer_load_dwordx4 v1, s[8:11], s36 offen lds
    v_mfma_f32_16x16x32_bf16 v[148:151], v[84:87], v[64:67], v[148:151]
    ds_read_b64_tr_b16 v[50:51], v10 offset:48416
    v_mfma_f32_16x16x32_bf16 v[152:155], v[88:91], v[64:67], v[152:155]
    v_mfma_f32_16x16x32_bf16 v[156:159], v[72:75], v[68:71], v[156:159]
    v_mfma_f32_16x16x32_bf16 v[160:163], v[76:79], v[68:71], v[160:163]
    s_add_u32 m0, s32, 24576
    s_mov_b32 s36, 82432
    buffer_load_dwordx4 v1, s[8:11], s36 offen lds
    v_mfma_f32_16x16x32_bf16 v[164:167], v[80:83], v[68:71], v[164:167]
    v_mfma_f32_16x16x32_bf16 v[168:171], v[84:87], v[68:71], v[168:171]
    v_mfma_f32_16x16x32_bf16 v[172:175], v[88:91], v[68:71], v[172:175]
    s_waitcnt vmcnt(15) lgkmcnt(0)
    s_barrier
    v_mfma_f32_16x16x32_bf16 v[96:99], v[32:35], v[16:19], v[96:99]
    ds_read_b128 v[56:59], v7 offset:32768
    s_add_u32 s37, s37, s38
    s_add_u32 m0, s33, 135168
    s_nop 0
    buffer_load_dwordx4 v2, s[12:15], s37 offen lds
    v_mfma_f32_16x16x32_bf16 v[100:103], v[36:39], v[16:19], v[100:103]
    ds_read_b128 v[60:63], v7 offset:34816
    v_mfma_f32_16x16x32_bf16 v[104:107], v[40:43], v[16:19], v[104:107]
    ds_read_b128 v[64:67], v8 offset:32768
    v_mfma_f32_16x16x32_bf16 v[108:111], v[44:47], v[16:19], v[108:111]
    ds_read_b128 v[68:71], v8 offset:34816
    v_mfma_f32_16x16x32_bf16 v[112:115], v[48:51], v[16:19], v[112:115]
    ds_read_b64_tr_b16 v[72:73], v9 offset:0
    v_mfma_f32_16x16x32_bf16 v[116:119], v[32:35], v[20:23], v[116:119]
    ds_read_b64_tr_b16 v[74:75], v9 offset:5376
    v_mfma_f32_16x16x32_bf16 v[120:123], v[36:39], v[20:23], v[120:123]
    ds_read_b64_tr_b16 v[76:77], v9 offset:8
    v_mfma_f32_16x16x32_bf16 v[124:127], v[40:43], v[20:23], v[124:127]
    ds_read_b64_tr_b16 v[78:79], v9 offset:5384
    s_add_u32 m0, s34, 135168
    s_nop 0
    buffer_load_dwordx4 v3, s[12:15], s37 offen lds
    v_mfma_f32_16x16x32_bf16 v[128:131], v[44:47], v[20:23], v[128:131]
    ds_read_b64_tr_b16 v[80:81], v9 offset:16
    v_mfma_f32_16x16x32_bf16 v[132:135], v[48:51], v[20:23], v[132:135]
    ds_read_b64_tr_b16 v[82:83], v9 offset:5392
    v_mfma_f32_16x16x32_bf16 v[136:139], v[32:35], v[24:27], v[136:139]
    ds_read_b64_tr_b16 v[84:85], v9 offset:24
    v_mfma_f32_16x16x32_bf16 v[140:143], v[36:39], v[24:27], v[140:143]
    ds_read_b64_tr_b16 v[86:87], v9 offset:5400
    v_mfma_f32_16x16x32_bf16 v[144:147], v[40:43], v[24:27], v[144:147]
    ds_read_b64_tr_b16 v[88:89], v9 offset:32
    v_mfma_f32_16x16x32_bf16 v[148:151], v[44:47], v[24:27], v[148:151]
    ds_read_b64_tr_b16 v[90:91], v9 offset:5408
    s_add_u32 m0, s35, 135168
    s_nop 0
    buffer_load_dwordx4 v4, s[12:15], s37 offen lds
    v_mfma_f32_16x16x32_bf16 v[152:155], v[48:51], v[24:27], v[152:155]
    v_mfma_f32_16x16x32_bf16 v[156:159], v[32:35], v[28:31], v[156:159]
    v_mfma_f32_16x16x32_bf16 v[160:163], v[36:39], v[28:31], v[160:163]
    v_mfma_f32_16x16x32_bf16 v[164:167], v[40:43], v[28:31], v[164:167]
    v_mfma_f32_16x16x32_bf16 v[168:171], v[44:47], v[28:31], v[168:171]
    v_mfma_f32_16x16x32_bf16 v[172:175], v[48:51], v[28:31], v[172:175]
    s_waitcnt vmcnt(13) lgkmcnt(0)
    s_barrier
    v_mfma_f32_16x16x32_bf16 v[96:99], v[72:75], v[56:59], v[96:99]
    ds_read_b128 v[16:19], v5 offset:0
    s_add_u32 s37, s37, s38
    s_add_u32 m0, s33, 49152
    s_nop 0
    buffer_load_dwordx4 v2, s[12:15], s37 offen lds
    v_mfma_f32_16x16x32_bf16 v[100:103], v[76:79], v[56:59], v[100:103]
    ds_read_b128 v[20:23], v5 offset:2048
    v_mfma_f32_16x16x32_bf16 v[104:107], v[80:83], v[56:59], v[104:107]
    ds_read_b128 v[24:27], v6 offset:0
    v_mfma_f32_16x16x32_bf16 v[108:111], v[84:87], v[56:59], v[108:111]
    ds_read_b128 v[28:31], v6 offset:2048
    v_mfma_f32_16x16x32_bf16 v[112:115], v[88:91], v[56:59], v[112:115]
    ds_read_b64_tr_b16 v[32:33], v9 offset:21504
    s_add_u32 m0, s34, 49152
    s_nop 0
    buffer_load_dwordx4 v3, s[12:15], s37 offen lds
    v_mfma_f32_16x16x32_bf16 v[116:119], v[72:75], v[60:63], v[116:119]
    ds_read_b64_tr_b16 v[34:35], v9 offset:26880
    v_mfma_f32_16x16x32_bf16 v[120:123], v[76:79], v[60:63], v[120:123]
    ds_read_b64_tr_b16 v[36:37], v9 offset:21512
    v_mfma_f32_16x16x32_bf16 v[124:127], v[80:83], v[60:63], v[124:127]
    ds_read_b64_tr_b16 v[38:39], v9 offset:26888
    v_mfma_f32_16x16x32_bf16 v[128:131], v[84:87], v[60:63], v[128:131]
    ds_read_b64_tr_b16 v[40:41], v9 offset:21520
    s_add_u32 m0, s35, 49152
    s_nop 0
    buffer_load_dwordx4 v4, s[12:15], s37 offen lds
    v_mfma_f32_16x16x32_bf16 v[132:135], v[88:91], v[60:63], v[132:135]
    ds_read_b64_tr_b16 v[42:43], v9 offset:26896
    v_mfma_f32_16x16x32_bf16 v[136:139], v[72:75], v[64:67], v[136:139]
    ds_read_b64_tr_b16 v[44:45], v9 offset:21528
    v_mfma_f32_16x16x32_bf16 v[140:143], v[76:79], v[64:67], v[140:143]
    ds_read_b64_tr_b16 v[46:47], v9 offset:26904
    v_mfma_f32_16x16x32_bf16 v[144:147], v[80:83], v[64:67], v[144:147]
    ds_read_b64_tr_b16 v[48:49], v9 offset:21536
    s_add_u32 m0, s32, 32768
    s_mov_b32 s36, 640
    buffer_load_dwordx4 v1, s[8:11], s36 offen lds
    v_mfma_f32_16x16x32_bf16 v[148:151], v[84:87], v[64:67], v[148:151]
    ds_read_b64_tr_b16 v[50:51], v9 offset:26912
    v_mfma_f32_16x16x32_bf16 v[152:155], v[88:91], v[64:67], v[152:155]
    v_mfma_f32_16x16x32_bf16 v[156:159], v[72:75], v[68:71], v[156:159]
    v_mfma_f32_16x16x32_bf16 v[160:163], v[76:79], v[68:71], v[160:163]
    s_add_u32 m0, s32, 40960
    s_mov_b32 s36, 82560
    buffer_load_dwordx4 v1, s[8:11], s36 offen lds
    v_mfma_f32_16x16x32_bf16 v[164:167], v[80:83], v[68:71], v[164:167]
    v_mfma_f32_16x16x32_bf16 v[168:171], v[84:87], v[68:71], v[168:171]
    v_mfma_f32_16x16x32_bf16 v[172:175], v[88:91], v[68:71], v[172:175]
    s_waitcnt vmcnt(15) lgkmcnt(0)
    s_barrier
    v_mfma_f32_16x16x32_bf16 v[96:99], v[32:35], v[16:19], v[96:99]
    ds_read_b128 v[56:59], v7 offset:0
    s_add_u32 s37, s37, s38
    s_add_u32 m0, s33, 70656
    s_nop 0
    buffer_load_dwordx4 v2, s[12:15], s37 offen lds
    v_mfma_f32_16x16x32_bf16 v[100:103], v[36:39], v[16:19], v[100:103]
    ds_read_b128 v[60:63], v7 offset:2048
    v_mfma_f32_16x16x32_bf16 v[104:107], v[40:43], v[16:19], v[104:107]
    ds_read_b128 v[64:67], v8 offset:0
    v_mfma_f32_16x16x32_bf16 v[108:111], v[44:47], v[16:19], v[108:111]
    ds_read_b128 v[68:71], v8 offset:2048
    v_mfma_f32_16x16x32_bf16 v[112:115], v[48:51], v[16:19], v[112:115]
    ds_read_b64_tr_b16 v[72:73], v10 offset:0
    s_add_u32 m0, s34, 70656
    s_nop 0
    buffer_load_dwordx4 v3, s[12:15], s37 offen lds
    v_mfma_f32_16x16x32_bf16 v[116:119], v[32:35], v[20:23], v[116:119]
    ds_read_b64_tr_b16 v[74:75], v10 offset:5376
    v_mfma_f32_16x16x32_bf16 v[120:123], v[36:39], v[20:23], v[120:123]
    ds_read_b64_tr_b16 v[76:77], v10 offset:8
    v_mfma_f32_16x16x32_bf16 v[124:127], v[40:43], v[20:23], v[124:127]
    ds_read_b64_tr_b16 v[78:79], v10 offset:5384
    v_mfma_f32_16x16x32_bf16 v[128:131], v[44:47], v[20:23], v[128:131]
    ds_read_b64_tr_b16 v[80:81], v10 offset:16
    s_add_u32 m0, s35, 70656
    s_nop 0
    buffer_load_dwordx4 v4, s[12:15], s37 offen lds
    v_mfma_f32_16x16x32_bf16 v[132:135], v[48:51], v[20:23], v[132:135]
    ds_read_b64_tr_b16 v[82:83], v10 offset:5392
    v_mfma_f32_16x16x32_bf16 v[136:139], v[32:35], v[24:27], v[136:139]
    ds_read_b64_tr_b16 v[84:85], v10 offset:24
    v_mfma_f32_16x16x32_bf16 v[140:143], v[36:39], v[24:27], v[140:143]
    ds_read_b64_tr_b16 v[86:87], v10 offset:5400
    v_mfma_f32_16x16x32_bf16 v[144:147], v[40:43], v[24:27], v[144:147]
    ds_read_b64_tr_b16 v[88:89], v10 offset:32
    buffer_load_dword v243, v241, s[8:11], 0 offen offset:768
    v_mfma_f32_16x16x32_bf16 v[148:151], v[44:47], v[24:27], v[148:151]
    ds_read_b64_tr_b16 v[90:91], v10 offset:5408
    v_mfma_f32_16x16x32_bf16 v[152:155], v[48:51], v[24:27], v[152:155]
    v_mfma_f32_16x16x32_bf16 v[156:159], v[32:35], v[28:31], v[156:159]
    v_mfma_f32_16x16x32_bf16 v[160:163], v[36:39], v[28:31], v[160:163]
    s_mul_i32 s25, s38, 12
    buffer_load_dword v242, v240, s[12:15], s25 offen
    v_mfma_f32_16x16x32_bf16 v[164:167], v[40:43], v[28:31], v[164:167]
    v_mfma_f32_16x16x32_bf16 v[168:171], v[44:47], v[28:31], v[168:171]
    v_mfma_f32_16x16x32_bf16 v[172:175], v[48:51], v[28:31], v[172:175]
    s_waitcnt vmcnt(13) lgkmcnt(0)
    s_barrier
    v_mfma_f32_16x16x32_bf16 v[96:99], v[72:75], v[56:59], v[96:99]
    ds_read_b128 v[16:19], v5 offset:16384
    s_add_u32 s37, s37, s38
    s_add_u32 m0, s33, 92160
    s_nop 0
    buffer_load_dwordx4 v2, s[12:15], s37 offen lds
    v_mfma_f32_16x16x32_bf16 v[100:103], v[76:79], v[56:59], v[100:103]
    ds_read_b128 v[20:23], v5 offset:18432
    v_mfma_f32_16x16x32_bf16 v[104:107], v[80:83], v[56:59], v[104:107]
    ds_read_b128 v[24:27], v6 offset:16384
    v_mfma_f32_16x16x32_bf16 v[108:111], v[84:87], v[56:59], v[108:111]
    ds_read_b128 v[28:31], v6 offset:18432
    v_mfma_f32_16x16x32_bf16 v[112:115], v[88:91], v[56:59], v[112:115]
    ds_read_b64_tr_b16 v[32:33], v10 offset:21504
    s_add_u32 m0, s34, 92160
    s_nop 0
    buffer_load_dwordx4 v3, s[12:15], s37 offen lds
    v_mfma_f32_16x16x32_bf16 v[116:119], v[72:75], v[60:63], v[116:119]
    ds_read_b64_tr_b16 v[34:35], v10 offset:26880
    v_mfma_f32_16x16x32_bf16 v[120:123], v[76:79], v[60:63], v[120:123]
    ds_read_b64_tr_b16 v[36:37], v10 offset:21512
    v_mfma_f32_16x16x32_bf16 v[124:127], v[80:83], v[60:63], v[124:127]
    ds_read_b64_tr_b16 v[38:39], v10 offset:26888
    v_mfma_f32_16x16x32_bf16 v[128:131], v[84:87], v[60:63], v[128:131]
    ds_read_b64_tr_b16 v[40:41], v10 offset:21520
    s_add_u32 m0, s35, 92160
    s_nop 0
    buffer_load_dwordx4 v4, s[12:15], s37 offen lds
    v_mfma_f32_16x16x32_bf16 v[132:135], v[88:91], v[60:63], v[132:135]
    ds_read_b64_tr_b16 v[42:43], v10 offset:26896
    v_mfma_f32_16x16x32_bf16 v[136:139], v[72:75], v[64:67], v[136:139]
    ds_read_b64_tr_b16 v[44:45], v10 offset:21528
    v_mfma_f32_16x16x32_bf16 v[140:143], v[76:79], v[64:67], v[140:143]
    ds_read_b64_tr_b16 v[46:47], v10 offset:26904
    v_mfma_f32_16x16x32_bf16 v[144:147], v[80:83], v[64:67], v[144:147]
    ds_read_b64_tr_b16 v[48:49], v10 offset:21536
    s_add_u32 m0, s32, 0
    s_mov_b32 s36, 768
    buffer_load_dwordx4 v1, s[8:11], s36 offen lds
    v_mfma_f32_16x16x32_bf16 v[148:151], v[84:87], v[64:67], v[148:151]
    ds_read_b64_tr_b16 v[50:51], v10 offset:26912
    v_mfma_f32_16x16x32_bf16 v[152:155], v[88:91], v[64:67], v[152:155]
    v_mfma_f32_16x16x32_bf16 v[156:159], v[72:75], v[68:71], v[156:159]
    v_mfma_f32_16x16x32_bf16 v[160:163], v[76:79], v[68:71], v[160:163]
    s_add_u32 m0, s32, 8192
    s_mov_b32 s36, 82688
    buffer_load_dwordx4 v1, s[8:11], s36 offen lds
    v_mfma_f32_16x16x32_bf16 v[164:167], v[80:83], v[68:71], v[164:167]
    v_mfma_f32_16x16x32_bf16 v[168:171], v[84:87], v[68:71], v[168:171]
    v_mfma_f32_16x16x32_bf16 v[172:175], v[88:91], v[68:71], v[172:175]
    s_waitcnt vmcnt(15) lgkmcnt(0)
    s_barrier
    v_mfma_f32_16x16x32_bf16 v[96:99], v[32:35], v[16:19], v[96:99]
    ds_read_b128 v[56:59], v7 offset:16384
    s_add_u32 s37, s37, s38
    s_add_u32 m0, s33, 113664
    s_nop 0
    buffer_load_dwordx4 v2, s[12:15], s37 offen lds
    v_mfma_f32_16x16x32_bf16 v[100:103], v[36:39], v[16:19], v[100:103]
    ds_read_b128 v[60:63], v7 offset:18432
    v_mfma_f32_16x16x32_bf16 v[104:107], v[40:43], v[16:19], v[104:107]
    ds_read_b128 v[64:67], v8 offset:16384
    v_mfma_f32_16x16x32_bf16 v[108:111], v[44:47], v[16:19], v[108:111]
    ds_read_b128 v[68:71], v8 offset:18432
    v_mfma_f32_16x16x32_bf16 v[112:115], v[48:51], v[16:19], v[112:115]
    ds_read_b64_tr_b16 v[72:73], v10 offset:43008
    v_mfma_f32_16x16x32_bf16 v[116:119], v[32:35], v[20:23], v[116:119]
    ds_read_b64_tr_b16 v[74:75], v10 offset:48384
    v_mfma_f32_16x16x32_bf16 v[120:123], v[36:39], v[20:23], v[120:123]
    ds_read_b64_tr_b16 v[76:77], v10 offset:43016
    v_mfma_f32_16x16x32_bf16 v[124:127], v[40:43], v[20:23], v[124:127]
    ds_read_b64_tr_b16 v[78:79], v10 offset:48392
    s_add_u32 m0, s34, 113664
    s_nop 0
    buffer_load_dwordx4 v3, s[12:15], s37 offen lds
    v_mfma_f32_16x16x32_bf16 v[128:131], v[44:47], v[20:23], v[128:131]
    ds_read_b64_tr_b16 v[80:81], v10 offset:43024
    v_mfma_f32_16x16x32_bf16 v[132:135], v[48:51], v[20:23], v[132:135]
    ds_read_b64_tr_b16 v[82:83], v10 offset:48400
    v_mfma_f32_16x16x32_bf16 v[136:139], v[32:35], v[24:27], v[136:139]
    ds_read_b64_tr_b16 v[84:85], v10 offset:43032
    v_mfma_f32_16x16x32_bf16 v[140:143], v[36:39], v[24:27], v[140:143]
    ds_read_b64_tr_b16 v[86:87], v10 offset:48408
    v_mfma_f32_16x16x32_bf16 v[144:147], v[40:43], v[24:27], v[144:147]
    ds_read_b64_tr_b16 v[88:89], v10 offset:43040
    v_mfma_f32_16x16x32_bf16 v[148:151], v[44:47], v[24:27], v[148:151]
    ds_read_b64_tr_b16 v[90:91], v10 offset:48416
    s_add_u32 m0, s35, 113664
    s_nop 0
    buffer_load_dwordx4 v4, s[12:15], s37 offen lds
    v_mfma_f32_16x16x32_bf16 v[152:155], v[48:51], v[24:27], v[152:155]
    v_mfma_f32_16x16x32_bf16 v[156:159], v[32:35], v[28:31], v[156:159]
    v_mfma_f32_16x16x32_bf16 v[160:163], v[36:39], v[28:31], v[160:163]
    v_mfma_f32_16x16x32_bf16 v[164:167], v[40:43], v[28:31], v[164:167]
    v_mfma_f32_16x16x32_bf16 v[168:171], v[44:47], v[28:31], v[168:171]
    v_mfma_f32_16x16x32_bf16 v[172:175], v[48:51], v[28:31], v[172:175]
    s_waitcnt vmcnt(13) lgkmcnt(0)
    s_barrier
    v_mfma_f32_16x16x32_bf16 v[96:99], v[72:75], v[56:59], v[96:99]
    ds_read_b128 v[16:19], v5 offset:32768
    s_add_u32 s37, s37, s38
    s_add_u32 m0, s33, 135168
    s_nop 0
    buffer_load_dwordx4 v2, s[12:15], s37 offen lds
    v_mfma_f32_16x16x32_bf16 v[100:103], v[76:79], v[56:59], v[100:103]
    ds_read_b128 v[20:23], v5 offset:34816
    v_mfma_f32_16x16x32_bf16 v[104:107], v[80:83], v[56:59], v[104:107]
    ds_read_b128 v[24:27], v6 offset:32768
    v_mfma_f32_16x16x32_bf16 v[108:111], v[84:87], v[56:59], v[108:111]
    ds_read_b128 v[28:31], v6 offset:34816
    v_mfma_f32_16x16x32_bf16 v[112:115], v[88:91], v[56:59], v[112:115]
    ds_read_b64_tr_b16 v[32:33], v9 offset:0
    s_add_u32 m0, s34, 135168
    s_nop 0
    buffer_load_dwordx4 v3, s[12:15], s37 offen lds
    v_mfma_f32_16x16x32_bf16 v[116:119], v[72:75], v[60:63], v[116:119]
    ds_read_b64_tr_b16 v[34:35], v9 offset:5376
    v_mfma_f32_16x16x32_bf16 v[120:123], v[76:79], v[60:63], v[120:123]
    ds_read_b64_tr_b16 v[36:37], v9 offset:8
    v_mfma_f32_16x16x32_bf16 v[124:127], v[80:83], v[60:63], v[124:127]
    ds_read_b64_tr_b16 v[38:39], v9 offset:5384
    v_mfma_f32_16x16x32_bf16 v[128:131], v[84:87], v[60:63], v[128:131]
    ds_read_b64_tr_b16 v[40:41], v9 offset:16
    s_add_u32 m0, s35, 135168
    s_nop 0
    buffer_load_dwordx4 v4, s[12:15], s37 offen lds
    v_mfma_f32_16x16x32_bf16 v[132:135], v[88:91], v[60:63], v[132:135]
    ds_read_b64_tr_b16 v[42:43], v9 offset:5392
    v_mfma_f32_16x16x32_bf16 v[136:139], v[72:75], v[64:67], v[136:139]
    ds_read_b64_tr_b16 v[44:45], v9 offset:24
    v_mfma_f32_16x16x32_bf16 v[140:143], v[76:79], v[64:67], v[140:143]
    ds_read_b64_tr_b16 v[46:47], v9 offset:5400
    v_mfma_f32_16x16x32_bf16 v[144:147], v[80:83], v[64:67], v[144:147]
    ds_read_b64_tr_b16 v[48:49], v9 offset:32
    s_add_u32 m0, s32, 16384
    s_mov_b32 s36, 896
    buffer_load_dwordx4 v1, s[8:11], s36 offen lds
    v_mfma_f32_16x16x32_bf16 v[148:151], v[84:87], v[64:67], v[148:151]
    ds_read_b64_tr_b16 v[50:51], v9 offset:5408
    v_mfma_f32_16x16x32_bf16 v[152:155], v[88:91], v[64:67], v[152:155]
    v_mfma_f32_16x16x32_bf16 v[156:159], v[72:75], v[68:71], v[156:159]
    v_mfma_f32_16x16x32_bf16 v[160:163], v[76:79], v[68:71], v[160:163]
    s_add_u32 m0, s32, 24576
    s_mov_b32 s36, 82816
    buffer_load_dwordx4 v1, s[8:11], s36 offen lds
    v_mfma_f32_16x16x32_bf16 v[164:167], v[80:83], v[68:71], v[164:167]
    v_mfma_f32_16x16x32_bf16 v[168:171], v[84:87], v[68:71], v[168:171]
    v_mfma_f32_16x16x32_bf16 v[172:175], v[88:91], v[68:71], v[172:175]
    s_waitcnt vmcnt(15) lgkmcnt(0)
    s_barrier
    v_mfma_f32_16x16x32_bf16 v[96:99], v[32:35], v[16:19], v[96:99]
    ds_read_b128 v[56:59], v7 offset:32768
    s_add_u32 s37, s37, s38
    s_add_u32 m0, s33, 49152
    s_nop 0
    buffer_load_dwordx4 v2, s[12:15], s37 offen lds
    v_mfma_f32_16x16x32_bf16 v[100:103], v[36:39], v[16:19], v[100:103]
    ds_read_b128 v[60:63], v7 offset:34816
    v_mfma_f32_16x16x32_bf16 v[104:107], v[40:43], v[16:19], v[104:107]
    ds_read_b128 v[64:67], v8 offset:32768
    v_mfma_f32_16x16x32_bf16 v[108:111], v[44:47], v[16:19], v[108:111]
    ds_read_b128 v[68:71], v8 offset:34816
    v_mfma_f32_16x16x32_bf16 v[112:115], v[48:51], v[16:19], v[112:115]
    ds_read_b64_tr_b16 v[72:73], v9 offset:21504
    s_add_u32 m0, s34, 49152
    s_nop 0
    buffer_load_dwordx4 v3, s[12:15], s37 offen lds
    v_mfma_f32_16x16x32_bf16 v[116:119], v[32:35], v[20:23], v[116:119]
    ds_read_b64_tr_b16 v[74:75], v9 offset:26880
    v_mfma_f32_16x16x32_bf16 v[120:123], v[36:39], v[20:23], v[120:123]
    ds_read_b64_tr_b16 v[76:77], v9 offset:21512
    v_mfma_f32_16x16x32_bf16 v[124:127], v[40:43], v[20:23], v[124:127]
    ds_read_b64_tr_b16 v[78:79], v9 offset:26888
    v_mfma_f32_16x16x32_bf16 v[128:131], v[44:47], v[20:23], v[128:131]
    ds_read_b64_tr_b16 v[80:81], v9 offset:21520
    s_add_u32 m0, s35, 49152
    s_nop 0
    buffer_load_dwordx4 v4, s[12:15], s37 offen lds
    v_mfma_f32_16x16x32_bf16 v[132:135], v[48:51], v[20:23], v[132:135]
    ds_read_b64_tr_b16 v[82:83], v9 offset:26896
    v_mfma_f32_16x16x32_bf16 v[136:139], v[32:35], v[24:27], v[136:139]
    ds_read_b64_tr_b16 v[84:85], v9 offset:21528
    v_mfma_f32_16x16x32_bf16 v[140:143], v[36:39], v[24:27], v[140:143]
    ds_read_b64_tr_b16 v[86:87], v9 offset:26904
    v_mfma_f32_16x16x32_bf16 v[144:147], v[40:43], v[24:27], v[144:147]
    ds_read_b64_tr_b16 v[88:89], v9 offset:21536
    buffer_load_dword v243, v241, s[8:11], 0 offen offset:1024
    v_mfma_f32_16x16x32_bf16 v[148:151], v[44:47], v[24:27], v[148:151]
    ds_read_b64_tr_b16 v[90:91], v9 offset:26912
    v_mfma_f32_16x16x32_bf16 v[152:155], v[48:51], v[24:27], v[152:155]
    v_mfma_f32_16x16x32_bf16 v[156:159], v[32:35], v[28:31], v[156:159]
    v_mfma_f32_16x16x32_bf16 v[160:163], v[36:39], v[28:31], v[160:163]
    s_mul_i32 s25, s38, 16
    buffer_load_dword v242, v240, s[12:15], s25 offen
    v_mfma_f32_16x16x32_bf16 v[164:167], v[40:43], v[28:31], v[164:167]
    v_mfma_f32_16x16x32_bf16 v[168:171], v[44:47], v[28:31], v[168:171]
    v_mfma_f32_16x16x32_bf16 v[172:175], v[48:51], v[28:31], v[172:175]
    s_waitcnt vmcnt(13) lgkmcnt(0)
    s_barrier
    v_mfma_f32_16x16x32_bf16 v[96:99], v[72:75], v[56:59], v[96:99]
    ds_read_b128 v[16:19], v5 offset:0
    s_add_u32 s37, s37, s38
    s_add_u32 m0, s33, 70656
    s_nop 0
    buffer_load_dwordx4 v2, s[12:15], s37 offen lds
    v_mfma_f32_16x16x32_bf16 v[100:103], v[76:79], v[56:59], v[100:103]
    ds_read_b128 v[20:23], v5 offset:2048
    v_mfma_f32_16x16x32_bf16 v[104:107], v[80:83], v[56:59], v[104:107]
    ds_read_b128 v[24:27], v6 offset:0
    v_mfma_f32_16x16x32_bf16 v[108:111], v[84:87], v[56:59], v[108:111]
    ds_read_b128 v[28:31], v6 offset:2048
    v_mfma_f32_16x16x32_bf16 v[112:115], v[88:91], v[56:59], v[112:115]
    ds_read_b64_tr_b16 v[32:33], v10 offset:0
    s_add_u32 m0, s34, 70656
    s_nop 0
    buffer_load_dwordx4 v3, s[12:15], s37 offen lds
    v_mfma_f32_16x16x32_bf16 v[116:119], v[72:75], v[60:63], v[116:119]
    ds_read_b64_tr_b16 v[34:35], v10 offset:5376
    v_mfma_f32_16x16x32_bf16 v[120:123], v[76:79], v[60:63], v[120:123]
    ds_read_b64_tr_b16 v[36:37], v10 offset:8
    v_mfma_f32_16x16x32_bf16 v[124:127], v[80:83], v[60:63], v[124:127]
    ds_read_b64_tr_b16 v[38:39], v10 offset:5384
    v_mfma_f32_16x16x32_bf16 v[128:131], v[84:87], v[60:63], v[128:131]
    ds_read_b64_tr_b16 v[40:41], v10 offset:16
    s_add_u32 m0, s35, 70656
    s_nop 0
    buffer_load_dwordx4 v4, s[12:15], s37 offen lds
    v_mfma_f32_16x16x32_bf16 v[132:135], v[88:91], v[60:63], v[132:135]
    ds_read_b64_tr_b16 v[42:43], v10 offset:5392
    v_mfma_f32_16x16x32_bf16 v[136:139], v[72:75], v[64:67], v[136:139]
    ds_read_b64_tr_b16 v[44:45], v10 offset:24
    v_mfma_f32_16x16x32_bf16 v[140:143], v[76:79], v[64:67], v[140:143]
    ds_read_b64_tr_b16 v[46:47], v10 offset:5400
    v_mfma_f32_16x16x32_bf16 v[144:147], v[80:83], v[64:67], v[144:147]
    ds_read_b64_tr_b16 v[48:49], v10 offset:32
    s_add_u32 m0, s32, 32768
    s_mov_b32 s36, 1024
    buffer_load_dwordx4 v1, s[8:11], s36 offen lds
    v_mfma_f32_16x16x32_bf16 v[148:151], v[84:87], v[64:67], v[148:151]
    ds_read_b64_tr_b16 v[50:51], v10 offset:5408
    v_mfma_f32_16x16x32_bf16 v[152:155], v[88:91], v[64:67], v[152:155]
    v_mfma_f32_16x16x32_bf16 v[156:159], v[72:75], v[68:71], v[156:159]
    v_mfma_f32_16x16x32_bf16 v[160:163], v[76:79], v[68:71], v[160:163]
    s_add_u32 m0, s32, 40960
    s_mov_b32 s36, 82944
    buffer_load_dwordx4 v1, s[8:11], s36 offen lds
    v_mfma_f32_16x16x32_bf16 v[164:167], v[80:83], v[68:71], v[164:167]
    v_mfma_f32_16x16x32_bf16 v[168:171], v[84:87], v[68:71], v[168:171]
    v_mfma_f32_16x16x32_bf16 v[172:175], v[88:91], v[68:71], v[172:175]
    s_waitcnt vmcnt(15) lgkmcnt(0)
    s_barrier
    v_mfma_f32_16x16x32_bf16 v[96:99], v[32:35], v[16:19], v[96:99]
    ds_read_b128 v[56:59], v7 offset:0
    s_add_u32 s37, s37, s38
    s_add_u32 m0, s33, 92160
    s_nop 0
    buffer_load_dwordx4 v2, s[12:15], s37 offen lds
    v_mfma_f32_16x16x32_bf16 v[100:103], v[36:39], v[16:19], v[100:103]
    ds_read_b128 v[60:63], v7 offset:2048
    v_mfma_f32_16x16x32_bf16 v[104:107], v[40:43], v[16:19], v[104:107]
    ds_read_b128 v[64:67], v8 offset:0
    v_mfma_f32_16x16x32_bf16 v[108:111], v[44:47], v[16:19], v[108:111]
    ds_read_b128 v[68:71], v8 offset:2048
    v_mfma_f32_16x16x32_bf16 v[112:115], v[48:51], v[16:19], v[112:115]
    ds_read_b64_tr_b16 v[72:73], v10 offset:21504
    v_mfma_f32_16x16x32_bf16 v[116:119], v[32:35], v[20:23], v[116:119]
    ds_read_b64_tr_b16 v[74:75], v10 offset:26880
    v_mfma_f32_16x16x32_bf16 v[120:123], v[36:39], v[20:23], v[120:123]
    ds_read_b64_tr_b16 v[76:77], v10 offset:21512
    v_mfma_f32_16x16x32_bf16 v[124:127], v[40:43], v[20:23], v[124:127]
    ds_read_b64_tr_b16 v[78:79], v10 offset:26888
    s_add_u32 m0, s34, 92160
    s_nop 0
    buffer_load_dwordx4 v3, s[12:15], s37 offen lds
    v_mfma_f32_16x16x32_bf16 v[128:131], v[44:47], v[20:23], v[128:131]
    ds_read_b64_tr_b16 v[80:81], v10 offset:21520
    v_mfma_f32_16x16x32_bf16 v[132:135], v[48:51], v[20:23], v[132:135]
    ds_read_b64_tr_b16 v[82:83], v10 offset:26896
    v_mfma_f32_16x16x32_bf16 v[136:139], v[32:35], v[24:27], v[136:139]
    ds_read_b64_tr_b16 v[84:85], v10 offset:21528
    v_mfma_f32_16x16x32_bf16 v[140:143], v[36:39], v[24:27], v[140:143]
    ds_read_b64_tr_b16 v[86:87], v10 offset:26904
    v_mfma_f32_16x16x32_bf16 v[144:147], v[40:43], v[24:27], v[144:147]
    ds_read_b64_tr_b16 v[88:89], v10 offset:21536
    v_mfma_f32_16x16x32_bf16 v[148:151], v[44:47], v[24:27], v[148:151]
    ds_read_b64_tr_b16 v[90:91], v10 offset:26912
    s_add_u32 m0, s35, 92160
    s_nop 0
    buffer_load_dwordx4 v4, s[12:15], s37 offen lds
    v_mfma_f32_16x16x32_bf16 v[152:155], v[48:51], v[24:27], v[152:155]
    v_mfma_f32_16x16x32_bf16 v[156:159], v[32:35], v[28:31], v[156:159]
    v_mfma_f32_16x16x32_bf16 v[160:163], v[36:39], v[28:31], v[160:163]
    v_mfma_f32_16x16x32_bf16 v[164:167], v[40:43], v[28:31], v[164:167]
    v_mfma_f32_16x16x32_bf16 v[168:171], v[44:47], v[28:31], v[168:171]
    v_mfma_f32_16x16x32_bf16 v[172:175], v[48:51], v[28:31], v[172:175]
    s_waitcnt vmcnt(13) lgkmcnt(0)
    s_barrier
    v_mfma_f32_16x16x32_bf16 v[96:99], v[72:75], v[56:59], v[96:99]
    ds_read_b128 v[16:19], v5 offset:16384
    s_add_u32 s37, s37, s38
    s_add_u32 m0, s33, 113664
    s_nop 0
    buffer_load_dwordx4 v2, s[12:15], s37 offen lds
    v_mfma_f32_16x16x32_bf16 v[100:103], v[76:79], v[56:59], v[100:103]
    ds_read_b128 v[20:23], v5 offset:18432
    v_mfma_f32_16x16x32_bf16 v[104:107], v[80:83], v[56:59], v[104:107]
    ds_read_b128 v[24:27], v6 offset:16384
    v_mfma_f32_16x16x32_bf16 v[108:111], v[84:87], v[56:59], v[108:111]
    ds_read_b128 v[28:31], v6 offset:18432
    v_mfma_f32_16x16x32_bf16 v[112:115], v[88:91], v[56:59], v[112:115]
    ds_read_b64_tr_b16 v[32:33], v10 offset:43008
    s_add_u32 m0, s34, 113664
    s_nop 0
    buffer_load_dwordx4 v3, s[12:15], s37 offen lds
    v_mfma_f32_16x16x32_bf16 v[116:119], v[72:75], v[60:63], v[116:119]
    ds_read_b64_tr_b16 v[34:35], v10 offset:48384
    v_mfma_f32_16x16x32_bf16 v[120:123], v[76:79], v[60:63], v[120:123]
    ds_read_b64_tr_b16 v[36:37], v10 offset:43016
    v_mfma_f32_16x16x32_bf16 v[124:127], v[80:83], v[60:63], v[124:127]
    ds_read_b64_tr_b16 v[38:39], v10 offset:48392
    v_mfma_f32_16x16x32_bf16 v[128:131], v[84:87], v[60:63], v[128:131]
    ds_read_b64_tr_b16 v[40:41], v10 offset:43024
    s_add_u32 m0, s35, 113664
    s_nop 0
    buffer_load_dwordx4 v4, s[12:15], s37 offen lds
    v_mfma_f32_16x16x32_bf16 v[132:135], v[88:91], v[60:63], v[132:135]
    ds_read_b64_tr_b16 v[42:43], v10 offset:48400
    v_mfma_f32_16x16x32_bf16 v[136:139], v[72:75], v[64:67], v[136:139]
    ds_read_b64_tr_b16 v[44:45], v10 offset:43032
    v_mfma_f32_16x16x32_bf16 v[140:143], v[76:79], v[64:67], v[140:143]
    ds_read_b64_tr_b16 v[46:47], v10 offset:48408
    v_mfma_f32_16x16x32_bf16 v[144:147], v[80:83], v[64:67], v[144:147]
    ds_read_b64_tr_b16 v[48:49], v10 offset:43040
    s_add_u32 m0, s32, 0
    s_mov_b32 s36, 1152
    buffer_load_dwordx4 v1, s[8:11], s36 offen lds
    v_mfma_f32_16x16x32_bf16 v[148:151], v[84:87], v[64:67], v[148:151]
    ds_read_b64_tr_b16 v[50:51], v10 offset:48416
    v_mfma_f32_16x16x32_bf16 v[152:155], v[88:91], v[64:67], v[152:155]
    v_mfma_f32_16x16x32_bf16 v[156:159], v[72:75], v[68:71], v[156:159]
    v_mfma_f32_16x16x32_bf16 v[160:163], v[76:79], v[68:71], v[160:163]
    s_add_u32 m0, s32, 8192
    s_mov_b32 s36, 83072
    buffer_load_dwordx4 v1, s[8:11], s36 offen lds
    v_mfma_f32_16x16x32_bf16 v[164:167], v[80:83], v[68:71], v[164:167]
    v_mfma_f32_16x16x32_bf16 v[168:171], v[84:87], v[68:71], v[168:171]
    v_mfma_f32_16x16x32_bf16 v[172:175], v[88:91], v[68:71], v[172:175]
    s_waitcnt vmcnt(15) lgkmcnt(0)
    s_barrier
    v_mfma_f32_16x16x32_bf16 v[96:99], v[32:35], v[16:19], v[96:99]
    ds_read_b128 v[56:59], v7 offset:16384
    s_add_u32 s37, s37, s38
    s_add_u32 m0, s33, 135168
    s_nop 0
    buffer_load_dwordx4 v2, s[12:15], s37 offen lds
    v_mfma_f32_16x16x32_bf16 v[100:103], v[36:39], v[16:19], v[100:103]
    ds_read_b128 v[60:63], v7 offset:18432
    v_mfma_f32_16x16x32_bf16 v[104:107], v[40:43], v[16:19], v[104:107]
    ds_read_b128 v[64:67], v8 offset:16384
    s_add_u32 m0, s34, 135168
    s_nop 0
    buffer_load_dwordx4 v3, s[12:15], s37 offen lds
    v_mfma_f32_16x16x32_bf16 v[108:111], v[44:47], v[16:19], v[108:111]
    ds_read_b128 v[68:71], v8 offset:18432
    s_add_u32 m0, s35, 135168
    s_nop 0
    buffer_load_dwordx4 v4, s[12:15], s37 offen lds
    v_mfma_f32_16x16x32_bf16 v[112:115], v[48:51], v[16:19], v[112:115]
    ds_read_b64_tr_b16 v[72:73], v9 offset:0
    v_mfma_f32_16x16x32_bf16 v[116:119], v[32:35], v[20:23], v[116:119]
    ds_read_b64_tr_b16 v[74:75], v9 offset:5376
    s_and_b32 s27, s21, 1
    s_lshl_b32 s27, s27, 2
    s_add_u32 s27, s27, s23
    v_mfma_f32_16x16x32_bf16 v[120:123], v[36:39], v[20:23], v[120:123]
    ds_read_b64_tr_b16 v[76:77], v9 offset:8
    s_lshl_b32 s27, s27, 8
    s_lshl_b32 s28, s20, 2
    s_add_u32 s27, s27, s28
    v_mfma_f32_16x16x32_bf16 v[124:127], v[40:43], v[20:23], v[124:127]
    ds_read_b64_tr_b16 v[78:79], v9 offset:5384
    v_mfma_f32_16x16x32_bf16 v[128:131], v[44:47], v[20:23], v[128:131]
    ds_read_b64_tr_b16 v[80:81], v9 offset:16
    s_lshl_b32 s28, s22, 1
    s_add_u32 s27, s27, s28
    v_and_b32 v221, 15, v0
    v_mfma_f32_16x16x32_bf16 v[132:135], v[48:51], v[20:23], v[132:135]
    ds_read_b64_tr_b16 v[82:83], v9 offset:5392
    v_lshrrev_b32 v222, 4, v0
    s_mov_b32 s24, 5242880
    s_mov_b32 s25, 1280
    v_mfma_f32_16x16x32_bf16 v[136:139], v[32:35], v[24:27], v[136:139]
    ds_read_b64_tr_b16 v[84:85], v9 offset:24
    v_mfma_f32_16x16x32_bf16 v[140:143], v[36:39], v[24:27], v[140:143]
    ds_read_b64_tr_b16 v[86:87], v9 offset:5400
    s_mov_b32 s42, 0x3ea52b5c
    s_cmp_ge_u32 s21, 12
    s_cselect_b32 s24, 0, s24
    s_cselect_b32 s25, 2560, s25
    s_cselect_b32 s29, 8, 16
    s_cselect_b32 s30, 8, 0
    s_cselect_b32 s42, 1.0, s42
    v_mfma_f32_16x16x32_bf16 v[144:147], v[40:43], v[24:27], v[144:147]
    ds_read_b64_tr_b16 v[88:89], v9 offset:32
    s_mov_b32 s43, s42
    v_and_b32 v223, s30, v221
    v_add_u32 v221, v221, v223
    v_mfma_f32_16x16x32_bf16 v[148:151], v[44:47], v[24:27], v[148:151]
    ds_read_b64_tr_b16 v[90:91], v9 offset:5408
    v_mfma_f32_16x16x32_bf16 v[152:155], v[48:51], v[24:27], v[152:155]
    s_mul_i32 s27, s27, s25
    s_add_u32 s24, s24, s27
    s_add_u32 s16, s4, s24
    s_addc_u32 s17, s5, 0
    v_mfma_f32_16x16x32_bf16 v[156:159], v[32:35], v[28:31], v[156:159]
    s_lshl_b32 s26, s25, 6
    s_lshl_b32 s18, s25, 8
    v_mul_u32_u24 v222, s26, v222
    v_mfma_f32_16x16x32_bf16 v[160:163], v[36:39], v[28:31], v[160:163]
    v_mfma_f32_16x16x32_bf16 v[164:167], v[40:43], v[28:31], v[164:167]
    v_add_u32 v223, s29, v221
    v_lshl_add_u32 v216, v221, 4, v222
    v_lshl_add_u32 v217, v223, 4, v222
    v_mfma_f32_16x16x32_bf16 v[168:171], v[44:47], v[28:31], v[168:171]
    v_lshl_add_u32 v218, v221, 3, v222
    v_lshl_add_u32 v219, v223, 3, v222
    v_mfma_f32_16x16x32_bf16 v[172:175], v[48:51], v[28:31], v[172:175]
    s_waitcnt vmcnt(11) lgkmcnt(0)
    s_barrier
    v_mfma_f32_16x16x32_bf16 v[96:99], v[72:75], v[56:59], v[96:99]
    ds_read_b128 v[16:19], v5 offset:32768
    v_mov_b32 v255, 0
    global_load_dword v255, v255, s[6:7] sc1
    v_mfma_f32_16x16x32_bf16 v[100:103], v[76:79], v[56:59], v[100:103]
    ds_read_b128 v[20:23], v5 offset:34816
    v_mfma_f32_16x16x32_bf16 v[104:107], v[80:83], v[56:59], v[104:107]
    ds_read_b128 v[24:27], v6 offset:32768
    v_mfma_f32_16x16x32_bf16 v[108:111], v[84:87], v[56:59], v[108:111]
    ds_read_b128 v[28:31], v6 offset:34816
    v_mfma_f32_16x16x32_bf16 v[112:115], v[88:91], v[56:59], v[112:115]
    ds_read_b64_tr_b16 v[32:33], v9 offset:21504
    v_mfma_f32_16x16x32_bf16 v[116:119], v[72:75], v[60:63], v[116:119]
    ds_read_b64_tr_b16 v[34:35], v9 offset:26880
    v_mfma_f32_16x16x32_bf16 v[120:123], v[76:79], v[60:63], v[120:123]
    ds_read_b64_tr_b16 v[36:37], v9 offset:21512
    v_mfma_f32_16x16x32_bf16 v[124:127], v[80:83], v[60:63], v[124:127]
    ds_read_b64_tr_b16 v[38:39], v9 offset:26888
    v_mfma_f32_16x16x32_bf16 v[128:131], v[84:87], v[60:63], v[128:131]
    ds_read_b64_tr_b16 v[40:41], v9 offset:21520
    v_mfma_f32_16x16x32_bf16 v[132:135], v[88:91], v[60:63], v[132:135]
    ds_read_b64_tr_b16 v[42:43], v9 offset:26896
    v_mfma_f32_16x16x32_bf16 v[136:139], v[72:75], v[64:67], v[136:139]
    ds_read_b64_tr_b16 v[44:45], v9 offset:21528
    v_mfma_f32_16x16x32_bf16 v[140:143], v[76:79], v[64:67], v[140:143]
    ds_read_b64_tr_b16 v[46:47], v9 offset:26904
    v_mfma_f32_16x16x32_bf16 v[144:147], v[80:83], v[64:67], v[144:147]
    ds_read_b64_tr_b16 v[48:49], v9 offset:21536
    v_mfma_f32_16x16x32_bf16 v[148:151], v[84:87], v[64:67], v[148:151]
    ds_read_b64_tr_b16 v[50:51], v9 offset:26912
    v_mfma_f32_16x16x32_bf16 v[152:155], v[88:91], v[64:67], v[152:155]
    v_mfma_f32_16x16x32_bf16 v[156:159], v[72:75], v[68:71], v[156:159]
    v_mfma_f32_16x16x32_bf16 v[160:163], v[76:79], v[68:71], v[160:163]
    v_mfma_f32_16x16x32_bf16 v[164:167], v[80:83], v[68:71], v[164:167]
    v_mfma_f32_16x16x32_bf16 v[168:171], v[84:87], v[68:71], v[168:171]
    v_mfma_f32_16x16x32_bf16 v[172:175], v[88:91], v[68:71], v[172:175]
    s_waitcnt vmcnt(4) lgkmcnt(0)
    s_barrier
    v_mfma_f32_16x16x32_bf16 v[96:99], v[32:35], v[16:19], v[96:99]
    ds_read_b128 v[56:59], v7 offset:32768
    ds_read_b128 v[60:63], v7 offset:34816
    v_mfma_f32_16x16x32_bf16 v[100:103], v[36:39], v[16:19], v[100:103]
    ds_read_b128 v[64:67], v8 offset:32768
    ds_read_b128 v[68:71], v8 offset:34816
    v_mfma_f32_16x16x32_bf16 v[104:107], v[40:43], v[16:19], v[104:107]
    ds_read_b64_tr_b16 v[72:73], v10 offset:0
    ds_read_b64_tr_b16 v[74:75], v10 offset:5376
    v_mfma_f32_16x16x32_bf16 v[108:111], v[44:47], v[16:19], v[108:111]
    ds_read_b64_tr_b16 v[76:77], v10 offset:8
    ds_read_b64_tr_b16 v[78:79], v10 offset:5384
    v_mfma_f32_16x16x32_bf16 v[112:115], v[48:51], v[16:19], v[112:115]
    ds_read_b64_tr_b16 v[80:81], v10 offset:16
    v_mfma_f32_16x16x32_bf16 v[116:119], v[32:35], v[20:23], v[116:119]
    ds_read_b64_tr_b16 v[82:83], v10 offset:5392
    v_mfma_f32_16x16x32_bf16 v[120:123], v[36:39], v[20:23], v[120:123]
    ds_read_b64_tr_b16 v[84:85], v10 offset:24
    v_mfma_f32_16x16x32_bf16 v[124:127], v[40:43], v[20:23], v[124:127]
    ds_read_b64_tr_b16 v[86:87], v10 offset:5400
    v_mfma_f32_16x16x32_bf16 v[128:131], v[44:47], v[20:23], v[128:131]
    ds_read_b64_tr_b16 v[88:89], v10 offset:32
    v_mfma_f32_16x16x32_bf16 v[132:135], v[48:51], v[20:23], v[132:135]
    ds_read_b64_tr_b16 v[90:91], v10 offset:5408
    v_mfma_f32_16x16x32_bf16 v[136:139], v[32:35], v[24:27], v[136:139]
    ds_read_b64_tr_b16 v[192:193], v10 offset:21504
    v_mfma_f32_16x16x32_bf16 v[140:143], v[36:39], v[24:27], v[140:143]
    ds_read_b64_tr_b16 v[194:195], v10 offset:26880
    v_mfma_f32_16x16x32_bf16 v[144:147], v[40:43], v[24:27], v[144:147]
    ds_read_b64_tr_b16 v[196:197], v10 offset:21512
    v_mfma_f32_16x16x32_bf16 v[148:151], v[44:47], v[24:27], v[148:151]
    ds_read_b64_tr_b16 v[198:199], v10 offset:26888
    v_mfma_f32_16x16x32_bf16 v[152:155], v[48:51], v[24:27], v[152:155]
    ds_read_b64_tr_b16 v[200:201], v10 offset:21520
    v_mfma_f32_16x16x32_bf16 v[156:159], v[32:35], v[28:31], v[156:159]
    ds_read_b64_tr_b16 v[202:203], v10 offset:26896
    v_mfma_f32_16x16x32_bf16 v[160:163], v[36:39], v[28:31], v[160:163]
    ds_read_b64_tr_b16 v[204:205], v10 offset:21528
    v_mfma_f32_16x16x32_bf16 v[164:167], v[40:43], v[28:31], v[164:167]
    ds_read_b64_tr_b16 v[206:207], v10 offset:26904
    v_mfma_f32_16x16x32_bf16 v[168:171], v[44:47], v[28:31], v[168:171]
    ds_read_b64_tr_b16 v[208:209], v10 offset:21536
    v_mfma_f32_16x16x32_bf16 v[172:175], v[48:51], v[28:31], v[172:175]
    ds_read_b64_tr_b16 v[210:211], v10 offset:26912
    s_waitcnt vmcnt(1) lgkmcnt(0)
    s_barrier
    s_cmp_ge_u32 s21, 12
    s_cbranch_scc1 L_skk_44
    v_mfma_f32_16x16x32_bf16 v[96:99], v[72:75], v[56:59], v[96:99]
    ds_read_b128 v[176:179], v5 offset:0
    ds_read_b128 v[180:183], v5 offset:2048
    v_mfma_f32_16x16x32_bf16 v[100:103], v[76:79], v[56:59], v[100:103]
    ds_read_b128 v[16:19], v7 offset:0
    ds_read_b128 v[20:23], v7 offset:2048
    v_mfma_f32_16x16x32_bf16 v[104:107], v[80:83], v[56:59], v[104:107]
    ds_read_b64_tr_b16 v[32:33], v10 offset:43008
    ds_read_b64_tr_b16 v[34:35], v10 offset:48384
    v_mfma_f32_16x16x32_bf16 v[108:111], v[84:87], v[56:59], v[108:111]
    ds_read_b64_tr_b16 v[36:37], v10 offset:43016
    ds_read_b64_tr_b16 v[38:39], v10 offset:48392
    v_mfma_f32_16x16x32_bf16 v[112:115], v[88:91], v[56:59], v[112:115]
    ds_read_b64_tr_b16 v[40:41], v10 offset:43024
    ds_read_b64_tr_b16 v[42:43], v10 offset:48400
    v_mfma_f32_16x16x32_bf16 v[116:119], v[72:75], v[60:63], v[116:119]
    ds_read_b64_tr_b16 v[44:45], v10 offset:43032
    ds_read_b64_tr_b16 v[46:47], v10 offset:48408
    v_mfma_f32_16x16x32_bf16 v[120:123], v[76:79], v[60:63], v[120:123]
    ds_read_b64_tr_b16 v[48:49], v10 offset:43040
    ds_read_b64_tr_b16 v[50:51], v10 offset:48416
    v_mfma_f32_16x16x32_bf16 v[124:127], v[80:83], v[60:63], v[124:127]
    ds_read_b128 v[184:187], v6 offset:0
    ds_read_b128 v[24:27], v8 offset:0
    v_mfma_f32_16x16x32_bf16 v[128:131], v[84:87], v[60:63], v[128:131]
    ds_read_b128 v[188:191], v6 offset:2048
    ds_read_b128 v[28:31], v8 offset:2048
    v_mfma_f32_16x16x32_bf16 v[132:135], v[88:91], v[60:63], v[132:135]
    s_waitcnt lgkmcnt(15)
    v_mfma_f32_16x16x32_bf16 v[96:99], v[192:195], v[176:179], v[96:99]
    s_waitcnt lgkmcnt(12)
    v_mfma_f32_16x16x32_bf16 v[96:99], v[32:35], v[16:19], v[96:99]
    v_mfma_f32_16x16x32_bf16 v[100:103], v[196:199], v[176:179], v[100:103]
    s_waitcnt lgkmcnt(10)
    v_mfma_f32_16x16x32_bf16 v[100:103], v[36:39], v[16:19], v[100:103]
    v_mfma_f32_16x16x32_bf16 v[104:107], v[200:203], v[176:179], v[104:107]
    s_waitcnt lgkmcnt(8)
    v_mfma_f32_16x16x32_bf16 v[104:107], v[40:43], v[16:19], v[104:107]
    v_mfma_f32_16x16x32_bf16 v[108:111], v[204:207], v[176:179], v[108:111]
    s_waitcnt lgkmcnt(6)
    v_mfma_f32_16x16x32_bf16 v[108:111], v[44:47], v[16:19], v[108:111]
    v_pk_mul_f32 v[96:97], v[96:97], s[42:43]
    v_pk_mul_f32 v[98:99], v[98:99], s[42:43]
    v_mfma_f32_16x16x32_bf16 v[112:115], v[208:211], v[176:179], v[112:115]
    v_cvt_pk_bf16_f32 v96, v96, v97
    v_cvt_pk_bf16_f32 v97, v98, v99
    s_waitcnt lgkmcnt(4)
    v_mfma_f32_16x16x32_bf16 v[112:115], v[48:51], v[16:19], v[112:115]
    v_pk_mul_f32 v[100:101], v[100:101], s[42:43]
    v_pk_mul_f32 v[102:103], v[102:103], s[42:43]
    v_mfma_f32_16x16x32_bf16 v[116:119], v[192:195], v[180:183], v[116:119]
    v_cvt_pk_bf16_f32 v98, v100, v101
    v_cvt_pk_bf16_f32 v99, v102, v103
    v_mfma_f32_16x16x32_bf16 v[116:119], v[32:35], v[20:23], v[116:119]
    buffer_store_dwordx4 v[96:99], v216, s[16:19], 0 offen offset:0 sc1
    v_pk_mul_f32 v[104:105], v[104:105], s[42:43]
    v_mfma_f32_16x16x32_bf16 v[120:123], v[196:199], v[180:183], v[120:123]
    v_pk_mul_f32 v[106:107], v[106:107], s[42:43]
    v_cvt_pk_bf16_f32 v104, v104, v105
    v_mfma_f32_16x16x32_bf16 v[120:123], v[36:39], v[20:23], v[120:123]
    v_cvt_pk_bf16_f32 v105, v106, v107
    v_pk_mul_f32 v[108:109], v[108:109], s[42:43]
    v_mfma_f32_16x16x32_bf16 v[124:127], v[200:203], v[180:183], v[124:127]
    v_pk_mul_f32 v[110:111], v[110:111], s[42:43]
    v_cvt_pk_bf16_f32 v106, v108, v109
    v_mfma_f32_16x16x32_bf16 v[124:127], v[40:43], v[20:23], v[124:127]
    v_cvt_pk_bf16_f32 v107, v110, v111
    buffer_store_dwordx4 v[104:107], v216, s[16:19], 0 offen offset:512 sc1
    v_mfma_f32_16x16x32_bf16 v[128:131], v[204:207], v[180:183], v[128:131]
    v_pk_mul_f32 v[112:113], v[112:113], s[42:43]
    v_pk_mul_f32 v[114:115], v[114:115], s[42:43]
    v_mfma_f32_16x16x32_bf16 v[128:131], v[44:47], v[20:23], v[128:131]
    v_cvt_pk_bf16_f32 v112, v112, v113
    v_cvt_pk_bf16_f32 v113, v114, v115
    v_mfma_f32_16x16x32_bf16 v[132:135], v[208:211], v[180:183], v[132:135]
    buffer_store_dwordx2 v[112:113], v218, s[16:19], 0 offen offset:1024 sc1
    v_pk_mul_f32 v[116:117], v[116:117], s[42:43]
    v_mfma_f32_16x16x32_bf16 v[132:135], v[48:51], v[20:23], v[132:135]
    v_pk_mul_f32 v[118:119], v[118:119], s[42:43]
    v_cvt_pk_bf16_f32 v116, v116, v117
    v_mfma_f32_16x16x32_bf16 v[136:139], v[72:75], v[64:67], v[136:139]
    v_cvt_pk_bf16_f32 v117, v118, v119
    v_pk_mul_f32 v[120:121], v[120:121], s[42:43]
    s_waitcnt lgkmcnt(3)
    v_mfma_f32_16x16x32_bf16 v[136:139], v[192:195], v[184:187], v[136:139]
    v_pk_mul_f32 v[122:123], v[122:123], s[42:43]
    v_cvt_pk_bf16_f32 v118, v120, v121
    s_waitcnt lgkmcnt(2)
    v_mfma_f32_16x16x32_bf16 v[136:139], v[32:35], v[24:27], v[136:139]
    v_cvt_pk_bf16_f32 v119, v122, v123
    buffer_store_dwordx4 v[116:119], v217, s[16:19], 0 offen offset:0 sc1
    v_mfma_f32_16x16x32_bf16 v[140:143], v[76:79], v[64:67], v[140:143]
    v_pk_mul_f32 v[124:125], v[124:125], s[42:43]
    v_pk_mul_f32 v[126:127], v[126:127], s[42:43]
    v_mfma_f32_16x16x32_bf16 v[140:143], v[196:199], v[184:187], v[140:143]
    v_cvt_pk_bf16_f32 v124, v124, v125
    v_cvt_pk_bf16_f32 v125, v126, v127
    v_mfma_f32_16x16x32_bf16 v[140:143], v[36:39], v[24:27], v[140:143]
    v_pk_mul_f32 v[128:129], v[128:129], s[42:43]
    v_pk_mul_f32 v[130:131], v[130:131], s[42:43]
    v_mfma_f32_16x16x32_bf16 v[144:147], v[80:83], v[64:67], v[144:147]
    v_cvt_pk_bf16_f32 v126, v128, v129
    v_cvt_pk_bf16_f32 v127, v130, v131
    v_mfma_f32_16x16x32_bf16 v[144:147], v[200:203], v[184:187], v[144:147]
    buffer_store_dwordx4 v[124:127], v217, s[16:19], 0 offen offset:512 sc1
    v_pk_mul_f32 v[132:133], v[132:133], s[42:43]
    v_mfma_f32_16x16x32_bf16 v[144:147], v[40:43], v[24:27], v[144:147]
    v_pk_mul_f32 v[134:135], v[134:135], s[42:43]
    v_cvt_pk_bf16_f32 v132, v132, v133
    v_mfma_f32_16x16x32_bf16 v[148:151], v[84:87], v[64:67], v[148:151]
    v_cvt_pk_bf16_f32 v133, v134, v135
    buffer_store_dwordx2 v[132:133], v219, s[16:19], 0 offen offset:1024 sc1
    v_mfma_f32_16x16x32_bf16 v[148:151], v[204:207], v[184:187], v[148:151]
    v_pk_mul_f32 v[136:137], v[136:137], s[42:43]
    v_pk_mul_f32 v[138:139], v[138:139], s[42:43]
    v_mfma_f32_16x16x32_bf16 v[148:151], v[44:47], v[24:27], v[148:151]
    v_cvt_pk_bf16_f32 v136, v136, v137
    v_cvt_pk_bf16_f32 v137, v138, v139
    v_mfma_f32_16x16x32_bf16 v[152:155], v[88:91], v[64:67], v[152:155]
    v_pk_mul_f32 v[140:141], v[140:141], s[42:43]
    v_pk_mul_f32 v[142:143], v[142:143], s[42:43]
    v_mfma_f32_16x16x32_bf16 v[152:155], v[208:211], v[184:187], v[152:155]
    v_cvt_pk_bf16_f32 v138, v140, v141
    v_cvt_pk_bf16_f32 v139, v142, v143
    v_mfma_f32_16x16x32_bf16 v[152:155], v[48:51], v[24:27], v[152:155]
    buffer_store_dwordx4 v[136:139], v216, s[16:19], s25 offen offset:0 sc1
    v_pk_mul_f32 v[144:145], v[144:145], s[42:43]
    v_mfma_f32_16x16x32_bf16 v[156:159], v[72:75], v[68:71], v[156:159]
    v_pk_mul_f32 v[146:147], v[146:147], s[42:43]
    v_cvt_pk_bf16_f32 v144, v144, v145
    s_waitcnt lgkmcnt(1)
    v_mfma_f32_16x16x32_bf16 v[156:159], v[192:195], v[188:191], v[156:159]
    v_cvt_pk_bf16_f32 v145, v146, v147
    v_pk_mul_f32 v[148:149], v[148:149], s[42:43]
    s_waitcnt lgkmcnt(0)
    v_mfma_f32_16x16x32_bf16 v[156:159], v[32:35], v[28:31], v[156:159]
    v_pk_mul_f32 v[150:151], v[150:151], s[42:43]
    v_cvt_pk_bf16_f32 v146, v148, v149
    v_mfma_f32_16x16x32_bf16 v[160:163], v[76:79], v[68:71], v[160:163]
    v_cvt_pk_bf16_f32 v147, v150, v151
    buffer_store_dwordx4 v[144:147], v216, s[16:19], s25 offen offset:512 sc1
    v_mfma_f32_16x16x32_bf16 v[160:163], v[196:199], v[188:191], v[160:163]
    v_pk_mul_f32 v[152:153], v[152:153], s[42:43]
    v_pk_mul_f32 v[154:155], v[154:155], s[42:43]
    v_mfma_f32_16x16x32_bf16 v[160:163], v[36:39], v[28:31], v[160:163]
    v_cvt_pk_bf16_f32 v152, v152, v153
    v_cvt_pk_bf16_f32 v153, v154, v155
    v_mfma_f32_16x16x32_bf16 v[164:167], v[80:83], v[68:71], v[164:167]
    buffer_store_dwordx2 v[152:153], v218, s[16:19], s25 offen offset:1024 sc1
    v_pk_mul_f32 v[156:157], v[156:157], s[42:43]
    v_mfma_f32_16x16x32_bf16 v[164:167], v[200:203], v[188:191], v[164:167]
    v_pk_mul_f32 v[158:159], v[158:159], s[42:43]
    v_cvt_pk_bf16_f32 v156, v156, v157
    v_mfma_f32_16x16x32_bf16 v[164:167], v[40:43], v[28:31], v[164:167]
    v_cvt_pk_bf16_f32 v157, v158, v159
    v_pk_mul_f32 v[160:161], v[160:161], s[42:43]
    v_mfma_f32_16x16x32_bf16 v[168:171], v[84:87], v[68:71], v[168:171]
    v_pk_mul_f32 v[162:163], v[162:163], s[42:43]
    v_cvt_pk_bf16_f32 v158, v160, v161
    v_mfma_f32_16x16x32_bf16 v[168:171], v[204:207], v[188:191], v[168:171]
    v_cvt_pk_bf16_f32 v159, v162, v163
    buffer_store_dwordx4 v[156:159], v217, s[16:19], s25 offen offset:0 sc1
    v_mfma_f32_16x16x32_bf16 v[168:171], v[44:47], v[28:31], v[168:171]
    v_pk_mul_f32 v[164:165], v[164:165], s[42:43]
    v_pk_mul_f32 v[166:167], v[166:167], s[42:43]
    v_mfma_f32_16x16x32_bf16 v[172:175], v[88:91], v[68:71], v[172:175]
    v_cvt_pk_bf16_f32 v164, v164, v165
    v_cvt_pk_bf16_f32 v165, v166, v167
    v_mfma_f32_16x16x32_bf16 v[172:175], v[208:211], v[188:191], v[172:175]
    v_mfma_f32_16x16x32_bf16 v[172:175], v[48:51], v[28:31], v[172:175]
    s_nop 0
    v_pk_mul_f32 v[168:169], v[168:169], s[42:43]
    v_pk_mul_f32 v[170:171], v[170:171], s[42:43]
    v_cvt_pk_bf16_f32 v166, v168, v169
    v_cvt_pk_bf16_f32 v167, v170, v171
    buffer_store_dwordx4 v[164:167], v217, s[16:19], s25 offen offset:512 sc1
    s_nop 1
    v_pk_mul_f32 v[172:173], v[172:173], s[42:43]
    v_pk_mul_f32 v[174:175], v[174:175], s[42:43]
    v_cvt_pk_bf16_f32 v172, v172, v173
    v_cvt_pk_bf16_f32 v173, v174, v175
    buffer_store_dwordx2 v[172:173], v219, s[16:19], s25 offen offset:1024 sc1
    s_branch L_skj_45
L_skk_44:
    v_mfma_f32_16x16x32_bf16 v[96:99], v[72:75], v[56:59], v[96:99]
    ds_read_b128 v[176:179], v5 offset:0
    ds_read_b128 v[180:183], v5 offset:2048
    v_mfma_f32_16x16x32_bf16 v[100:103], v[76:79], v[56:59], v[100:103]
    ds_read_b128 v[16:19], v7 offset:0
    ds_read_b128 v[20:23], v7 offset:2048
    v_mfma_f32_16x16x32_bf16 v[104:107], v[80:83], v[56:59], v[104:107]
    ds_read_b64_tr_b16 v[32:33], v10 offset:43008
    ds_read_b64_tr_b16 v[34:35], v10 offset:48384
    v_mfma_f32_16x16x32_bf16 v[108:111], v[84:87], v[56:59], v[108:111]
    ds_read_b64_tr_b16 v[36:37], v10 offset:43016
    ds_read_b64_tr_b16 v[38:39], v10 offset:48392
    v_mfma_f32_16x16x32_bf16 v[112:115], v[88:91], v[56:59], v[112:115]
    ds_read_b64_tr_b16 v[40:41], v10 offset:43024
    ds_read_b64_tr_b16 v[42:43], v10 offset:48400
    v_mfma_f32_16x16x32_bf16 v[116:119], v[72:75], v[60:63], v[116:119]
    ds_read_b64_tr_b16 v[44:45], v10 offset:43032
    ds_read_b64_tr_b16 v[46:47], v10 offset:48408
    v_mfma_f32_16x16x32_bf16 v[120:123], v[76:79], v[60:63], v[120:123]
    ds_read_b64_tr_b16 v[48:49], v10 offset:43040
    ds_read_b64_tr_b16 v[50:51], v10 offset:48416
    v_mfma_f32_16x16x32_bf16 v[124:127], v[80:83], v[60:63], v[124:127]
    ds_read_b128 v[184:187], v6 offset:0
    ds_read_b128 v[24:27], v8 offset:0
    v_mfma_f32_16x16x32_bf16 v[128:131], v[84:87], v[60:63], v[128:131]
    ds_read_b128 v[188:191], v6 offset:2048
    ds_read_b128 v[28:31], v8 offset:2048
    v_mfma_f32_16x16x32_bf16 v[132:135], v[88:91], v[60:63], v[132:135]
    s_waitcnt lgkmcnt(15)
    v_mfma_f32_16x16x32_bf16 v[96:99], v[192:195], v[176:179], v[96:99]
    s_waitcnt lgkmcnt(12)
    v_mfma_f32_16x16x32_bf16 v[96:99], v[32:35], v[16:19], v[96:99]
    v_mfma_f32_16x16x32_bf16 v[100:103], v[196:199], v[176:179], v[100:103]
    s_waitcnt lgkmcnt(10)
    v_mfma_f32_16x16x32_bf16 v[100:103], v[36:39], v[16:19], v[100:103]
    v_mfma_f32_16x16x32_bf16 v[104:107], v[200:203], v[176:179], v[104:107]
    s_waitcnt lgkmcnt(8)
    v_mfma_f32_16x16x32_bf16 v[104:107], v[40:43], v[16:19], v[104:107]
    v_mfma_f32_16x16x32_bf16 v[108:111], v[204:207], v[176:179], v[108:111]
    s_waitcnt lgkmcnt(6)
    v_mfma_f32_16x16x32_bf16 v[108:111], v[44:47], v[16:19], v[108:111]
    v_cvt_pk_bf16_f32 v96, v96, v97
    v_cvt_pk_bf16_f32 v97, v98, v99
    v_mfma_f32_16x16x32_bf16 v[112:115], v[208:211], v[176:179], v[112:115]
    v_cvt_pk_bf16_f32 v98, v100, v101
    v_cvt_pk_bf16_f32 v99, v102, v103
    s_waitcnt lgkmcnt(4)
    v_mfma_f32_16x16x32_bf16 v[112:115], v[48:51], v[16:19], v[112:115]
    buffer_store_dwordx4 v[96:99], v216, s[16:19], 0 offen offset:0 sc1
    v_cvt_pk_bf16_f32 v104, v104, v105
    v_mfma_f32_16x16x32_bf16 v[116:119], v[192:195], v[180:183], v[116:119]
    v_cvt_pk_bf16_f32 v105, v106, v107
    v_cvt_pk_bf16_f32 v106, v108, v109
    v_mfma_f32_16x16x32_bf16 v[116:119], v[32:35], v[20:23], v[116:119]
    v_cvt_pk_bf16_f32 v107, v110, v111
    buffer_store_dwordx4 v[104:107], v216, s[16:19], 0 offen offset:512 sc1
    v_mfma_f32_16x16x32_bf16 v[120:123], v[196:199], v[180:183], v[120:123]
    v_cvt_pk_bf16_f32 v112, v112, v113
    v_cvt_pk_bf16_f32 v113, v114, v115
    v_mfma_f32_16x16x32_bf16 v[120:123], v[36:39], v[20:23], v[120:123]
    buffer_store_dwordx2 v[112:113], v218, s[16:19], 0 offen offset:1024 sc1
    v_mfma_f32_16x16x32_bf16 v[124:127], v[200:203], v[180:183], v[124:127]
    v_cvt_pk_bf16_f32 v116, v116, v117
    v_cvt_pk_bf16_f32 v117, v118, v119
    v_mfma_f32_16x16x32_bf16 v[124:127], v[40:43], v[20:23], v[124:127]
    v_mfma_f32_16x16x32_bf16 v[128:131], v[204:207], v[180:183], v[128:131]
    v_mfma_f32_16x16x32_bf16 v[128:131], v[44:47], v[20:23], v[128:131]
    v_mfma_f32_16x16x32_bf16 v[132:135], v[208:211], v[180:183], v[132:135]
    v_cvt_pk_bf16_f32 v118, v120, v121
    v_cvt_pk_bf16_f32 v119, v122, v123
    v_mfma_f32_16x16x32_bf16 v[132:135], v[48:51], v[20:23], v[132:135]
    buffer_store_dwordx4 v[116:119], v217, s[16:19], 0 offen offset:0 sc1
    v_mfma_f32_16x16x32_bf16 v[136:139], v[72:75], v[64:67], v[136:139]
    v_cvt_pk_bf16_f32 v124, v124, v125
    v_cvt_pk_bf16_f32 v125, v126, v127
    s_waitcnt lgkmcnt(3)
    v_mfma_f32_16x16x32_bf16 v[136:139], v[192:195], v[184:187], v[136:139]
    v_cvt_pk_bf16_f32 v126, v128, v129
    v_cvt_pk_bf16_f32 v127, v130, v131
    s_waitcnt lgkmcnt(2)
    v_mfma_f32_16x16x32_bf16 v[136:139], v[32:35], v[24:27], v[136:139]
    buffer_store_dwordx4 v[124:127], v217, s[16:19], 0 offen offset:512 sc1
    v_cvt_pk_bf16_f32 v132, v132, v133
    v_mfma_f32_16x16x32_bf16 v[140:143], v[76:79], v[64:67], v[140:143]
    v_cvt_pk_bf16_f32 v133, v134, v135
    buffer_store_dwordx2 v[132:133], v219, s[16:19], 0 offen offset:1024 sc1
    v_mfma_f32_16x16x32_bf16 v[140:143], v[196:199], v[184:187], v[140:143]
    v_mfma_f32_16x16x32_bf16 v[140:143], v[36:39], v[24:27], v[140:143]
    v_mfma_f32_16x16x32_bf16 v[144:147], v[80:83], v[64:67], v[144:147]
    v_cvt_pk_bf16_f32 v136, v136, v137
    v_cvt_pk_bf16_f32 v137, v138, v139
    v_mfma_f32_16x16x32_bf16 v[144:147], v[200:203], v[184:187], v[144:147]
    v_mfma_f32_16x16x32_bf16 v[144:147], v[40:43], v[24:27], v[144:147]
    v_mfma_f32_16x16x32_bf16 v[148:151], v[84:87], v[64:67], v[148:151]
    v_mfma_f32_16x16x32_bf16 v[148:151], v[204:207], v[184:187], v[148:151]
    v_mfma_f32_16x16x32_bf16 v[148:151], v[44:47], v[24:27], v[148:151]
    v_cvt_pk_bf16_f32 v138, v140, v141
    v_cvt_pk_bf16_f32 v139, v142, v143
    v_mfma_f32_16x16x32_bf16 v[152:155], v[88:91], v[64:67], v[152:155]
    buffer_store_dwordx4 v[136:139], v216, s[16:19], s25 offen offset:0 sc1
    v_mfma_f32_16x16x32_bf16 v[152:155], v[208:211], v[184:187], v[152:155]
    v_cvt_pk_bf16_f32 v144, v144, v145
    v_cvt_pk_bf16_f32 v145, v146, v147
    v_mfma_f32_16x16x32_bf16 v[152:155], v[48:51], v[24:27], v[152:155]
    v_cvt_pk_bf16_f32 v146, v148, v149
    v_cvt_pk_bf16_f32 v147, v150, v151
    v_mfma_f32_16x16x32_bf16 v[156:159], v[72:75], v[68:71], v[156:159]
    buffer_store_dwordx4 v[144:147], v216, s[16:19], s25 offen offset:512 sc1
    s_waitcnt lgkmcnt(1)
    v_mfma_f32_16x16x32_bf16 v[156:159], v[192:195], v[188:191], v[156:159]
    s_waitcnt lgkmcnt(0)
    v_mfma_f32_16x16x32_bf16 v[156:159], v[32:35], v[28:31], v[156:159]
    v_cvt_pk_bf16_f32 v152, v152, v153
    v_cvt_pk_bf16_f32 v153, v154, v155
    v_mfma_f32_16x16x32_bf16 v[160:163], v[76:79], v[68:71], v[160:163]
    buffer_store_dwordx2 v[152:153], v218, s[16:19], s25 offen offset:1024 sc1
    v_mfma_f32_16x16x32_bf16 v[160:163], v[196:199], v[188:191], v[160:163]
    v_mfma_f32_16x16x32_bf16 v[160:163], v[36:39], v[28:31], v[160:163]
    v_mfma_f32_16x16x32_bf16 v[164:167], v[80:83], v[68:71], v[164:167]
    v_mfma_f32_16x16x32_bf16 v[164:167], v[200:203], v[188:191], v[164:167]
    v_cvt_pk_bf16_f32 v156, v156, v157
    v_cvt_pk_bf16_f32 v157, v158, v159
    v_mfma_f32_16x16x32_bf16 v[164:167], v[40:43], v[28:31], v[164:167]
    v_mfma_f32_16x16x32_bf16 v[168:171], v[84:87], v[68:71], v[168:171]
    v_mfma_f32_16x16x32_bf16 v[168:171], v[204:207], v[188:191], v[168:171]
    v_mfma_f32_16x16x32_bf16 v[168:171], v[44:47], v[28:31], v[168:171]
    v_cvt_pk_bf16_f32 v158, v160, v161
    v_cvt_pk_bf16_f32 v159, v162, v163
    v_mfma_f32_16x16x32_bf16 v[172:175], v[88:91], v[68:71], v[172:175]
    buffer_store_dwordx4 v[156:159], v217, s[16:19], s25 offen offset:0 sc1
    v_mfma_f32_16x16x32_bf16 v[172:175], v[208:211], v[188:191], v[172:175]
    v_cvt_pk_bf16_f32 v164, v164, v165
    v_cvt_pk_bf16_f32 v165, v166, v167
    v_mfma_f32_16x16x32_bf16 v[172:175], v[48:51], v[28:31], v[172:175]
    v_cvt_pk_bf16_f32 v166, v168, v169
    v_cvt_pk_bf16_f32 v167, v170, v171
    buffer_store_dwordx4 v[164:167], v217, s[16:19], s25 offen offset:512 sc1
    s_nop 4
    v_cvt_pk_bf16_f32 v172, v172, v173
    v_cvt_pk_bf16_f32 v173, v174, v175
    buffer_store_dwordx2 v[172:173], v219, s[16:19], s25 offen offset:1024 sc1
L_skj_45:
    s_branch K_pub
K_v:
    s_add_u32 s37, s37, s38
    s_add_u32 m0, s33, 70656
    s_nop 0
    buffer_load_dwordx4 v2, s[12:15], s37 offen lds
    s_add_u32 m0, s34, 70656
    s_nop 0
    buffer_load_dwordx4 v3, s[12:15], s37 offen lds
    s_add_u32 m0, s35, 70656
    s_nop 0
    buffer_load_dwordx4 v4, s[12:15], s37 offen lds
    v_and_b32 v13, 15, v0
    v_lshrrev_b32 v14, 4, v0
    v_lshrrev_b32 v15, 1, v13
    v_xor_b32 v15, v15, v14
    v_lshlrev_b32 v15, 4, v15
    v_lshl_add_u32 v15, v13, 7, v15
    s_lshl_b32 s24, s22, 13
    v_add_u32 v5, s24, v15
    v_xor_b32 v6, 4096, v5
    v_xor_b32 v7, 64, v5
    v_xor_b32 v8, 64, v6
    v_lshrrev_b32 v13, 2, v0
    v_and_b32 v15, 7, v13
    v_and_b32 v13, 8, v13
    v_lshl_or_b32 v15, v13, 1, v15
    v_mul_u32_u24 v15, 672, v15
    v_and_b32 v13, 3, v0
    v_mul_u32_u24 v13, 8, v13
    s_mul_i32 s24, s23, 160
    s_add_u32 s24, s24, 49152
    v_add3_u32 v9, v13, v15, s24
    v_add_u32 v10, 43008, v9
    buffer_load_dword v243, v241, s[8:11], 0 offen offset:256
    s_mul_i32 s25, s38, 4
    buffer_load_dword v242, v240, s[12:15], s25 offen
    s_getpc_b64 s[26:27]
L_pc_47:
    s_lshr_b32 s24, s2, 3
    s_lshl_b32 s24, s24, 3
    s_add_u32 s24, s24, s3
    s_lshl_b32 s24, s24, 8
    s_sub_u32 s26, s26, L_pc_47-gated_mix__softmax_full_mha__geglu_ffn__prompt_kernel
    s_subb_u32 s27, s27, 0
    v_min_u32 v246, 1, v0
    v_lshl_add_u32 v246, v246, 7, s24
    v_min_u32 v246, K_last-gated_mix__softmax_full_mha__geglu_ffn__prompt_kernel, v246
    v_mov_b32 v247, 0
    v_lshl_add_u64 v[246:247], v[246:247], 0, s[26:27]
    global_load_dword v242, v[246:247], off
    s_mov_b32 s96, s21
    s_mov_b32 s97, s22
    s_mov_b32 s98, s23
    s_and_b32 s25, s2, 7
    s_lshr_b32 s26, s2, 3
    s_lshl_b32 s21, s25, 2
    s_and_b32 s25, s26, 3
    s_add_u32 s21, s21, s25
    s_lshr_b32 s22, s26, 2
    s_and_b32 s23, s3, 3
    s_lshr_b32 s24, s3, 2
    s_lshl_b32 s30, s22, 2
    s_add_u32 s30, s30, s23
    s_mul_i32 s26, s30, 303104
    s_add_u32 s26, s26, 8388608
    s_add_u32 s56, s4, s26
    s_addc_u32 s57, s5, 0
    s_mov_b32 s58, 303104
    s_mov_b32 s59, 0x00020000
    s_lshr_b32 s25, s21, 1
    s_add_u32 s25, s25, 54
    s_lshl_b32 s25, s25, 1
    s_add_u32 s25, s25, s24
    s_lshl_b32 s25, s25, 2
    s_and_b32 s26, s21, 1
    s_add_u32 s25, s25, s26
    s_lshl_b32 s25, s25, 9
    v_and_b32 v13, 15, v0
    v_lshlrev_b32 v13, 4, v13
    v_and_b32 v14, 16, v0
    v_lshl_add_u32 v13, v14, 6, v13
    v_and_b32 v14, 32, v0
    v_lshl_add_u32 v252, v14, 3, v13
    v_add_u32 v252, s25, v252
    s_lshr_b32 s25, s21, 3
    s_add_u32 s25, s25, 70
    s_lshl_b32 s25, s25, 1
    s_add_u32 s25, s25, s24
    s_lshl_b32 s25, s25, 11
    s_lshl_b32 s26, s26, 3
    s_add_u32 s25, s25, s26
    s_and_b32 s26, s21, 6
    s_lshl_b32 s26, s26, 7
    s_add_u32 s25, s25, s26
    v_lshl_add_u32 v253, v14, 19, v13
    v_add_u32 v253, s25, v253
    s_mov_b32 s21, s96
    s_mov_b32 s22, s97
    s_mov_b32 s23, s98
    v_mov_b32 v248, -1
    v_mov_b32 v249, -1
    v_mov_b32 v250, -1
    v_mov_b32 v251, -1
    s_waitcnt vmcnt(6)
    s_barrier
    ds_read_b128 v[16:19], v5 offset:0
    ds_read_b128 v[20:23], v5 offset:2048
    ds_read_b128 v[24:27], v6 offset:0
    ds_read_b128 v[28:31], v6 offset:2048
    ds_read_b64_tr_b16 v[32:33], v9 offset:0
    ds_read_b64_tr_b16 v[34:35], v9 offset:5376
    ds_read_b64_tr_b16 v[36:37], v9 offset:32
    ds_read_b64_tr_b16 v[38:39], v9 offset:5408
    ds_read_b64_tr_b16 v[40:41], v9 offset:64
    ds_read_b64_tr_b16 v[42:43], v9 offset:5440
    ds_read_b64_tr_b16 v[44:45], v9 offset:96
    ds_read_b64_tr_b16 v[46:47], v9 offset:5472
    ds_read_b64_tr_b16 v[48:49], v9 offset:128
    ds_read_b64_tr_b16 v[50:51], v9 offset:5504
    s_add_u32 s37, s37, s38
    s_add_u32 m0, s33, 92160
    s_nop 0
    buffer_load_dwordx4 v2, s[12:15], s37 offen lds
    s_add_u32 m0, s34, 92160
    s_nop 0
    buffer_load_dwordx4 v3, s[12:15], s37 offen lds
    s_add_u32 m0, s35, 92160
    s_nop 0
    buffer_load_dwordx4 v4, s[12:15], s37 offen lds
    s_add_u32 m0, s32, 16384
    s_mov_b32 s36, 128
    buffer_load_dwordx4 v1, s[8:11], s36 offen lds
    s_add_u32 m0, s32, 24576
    s_mov_b32 s36, 82048
    buffer_load_dwordx4 v1, s[8:11], s36 offen lds
    s_waitcnt vmcnt(8) lgkmcnt(0)
    s_barrier
    v_mfma_f32_16x16x32_bf16 v[96:99], v[16:19], v[32:35], 0
    ds_read_b128 v[56:59], v7 offset:0
    s_add_u32 s37, s37, s38
    s_add_u32 m0, s33, 113664
    s_nop 0
    buffer_load_dwordx4 v2, s[12:15], s37 offen lds
    v_mfma_f32_16x16x32_bf16 v[100:103], v[16:19], v[36:39], 0
    ds_read_b128 v[60:63], v7 offset:2048
    v_mfma_f32_16x16x32_bf16 v[104:107], v[16:19], v[40:43], 0
    ds_read_b128 v[64:67], v8 offset:0
    v_mfma_f32_16x16x32_bf16 v[108:111], v[16:19], v[44:47], 0
    ds_read_b128 v[68:71], v8 offset:2048
    s_add_u32 m0, s34, 113664
    s_nop 0
    buffer_load_dwordx4 v3, s[12:15], s37 offen lds
    v_mfma_f32_16x16x32_bf16 v[112:115], v[16:19], v[48:51], 0
    ds_read_b64_tr_b16 v[72:73], v9 offset:21504
    v_mfma_f32_16x16x32_bf16 v[116:119], v[20:23], v[32:35], 0
    ds_read_b64_tr_b16 v[74:75], v9 offset:26880
    s_add_u32 m0, s35, 113664
    s_nop 0
    buffer_load_dwordx4 v4, s[12:15], s37 offen lds
    v_mfma_f32_16x16x32_bf16 v[120:123], v[20:23], v[36:39], 0
    ds_read_b64_tr_b16 v[76:77], v9 offset:21536
    v_mfma_f32_16x16x32_bf16 v[124:127], v[20:23], v[40:43], 0
    ds_read_b64_tr_b16 v[78:79], v9 offset:26912
    v_mfma_f32_16x16x32_bf16 v[128:131], v[20:23], v[44:47], 0
    ds_read_b64_tr_b16 v[80:81], v9 offset:21568
    s_add_u32 s37, s37, s38
    s_add_u32 m0, s33, 135168
    s_nop 0
    buffer_load_dwordx4 v2, s[12:15], s37 offen lds
    v_mfma_f32_16x16x32_bf16 v[132:135], v[20:23], v[48:51], 0
    ds_read_b64_tr_b16 v[82:83], v9 offset:26944
    v_mfma_f32_16x16x32_bf16 v[136:139], v[24:27], v[32:35], 0
    ds_read_b64_tr_b16 v[84:85], v9 offset:21600
    s_add_u32 m0, s34, 135168
    s_nop 0
    buffer_load_dwordx4 v3, s[12:15], s37 offen lds
    v_mfma_f32_16x16x32_bf16 v[140:143], v[24:27], v[36:39], 0
    ds_read_b64_tr_b16 v[86:87], v9 offset:26976
    v_mfma_f32_16x16x32_bf16 v[144:147], v[24:27], v[40:43], 0
    ds_read_b64_tr_b16 v[88:89], v9 offset:21632
    s_add_u32 m0, s35, 135168
    s_nop 0
    buffer_load_dwordx4 v4, s[12:15], s37 offen lds
    v_mfma_f32_16x16x32_bf16 v[148:151], v[24:27], v[44:47], 0
    ds_read_b64_tr_b16 v[90:91], v9 offset:27008
    v_mfma_f32_16x16x32_bf16 v[152:155], v[24:27], v[48:51], 0
    v_mfma_f32_16x16x32_bf16 v[156:159], v[28:31], v[32:35], 0
    s_add_u32 m0, s32, 32768
    s_mov_b32 s36, 256
    buffer_load_dwordx4 v1, s[8:11], s36 offen lds
    v_mfma_f32_16x16x32_bf16 v[160:163], v[28:31], v[36:39], 0
    v_mfma_f32_16x16x32_bf16 v[164:167], v[28:31], v[40:43], 0
    s_add_u32 m0, s32, 40960
    s_mov_b32 s36, 82176
    buffer_load_dwordx4 v1, s[8:11], s36 offen lds
    v_mfma_f32_16x16x32_bf16 v[168:171], v[28:31], v[44:47], 0
    v_mfma_f32_16x16x32_bf16 v[172:175], v[28:31], v[48:51], 0
    s_waitcnt vmcnt(8) lgkmcnt(0)
    s_barrier
    v_mfma_f32_16x16x32_bf16 v[96:99], v[56:59], v[72:75], v[96:99]
    ds_read_b128 v[16:19], v5 offset:16384
    s_add_u32 s37, s37, s38
    s_add_u32 m0, s33, 49152
    s_nop 0
    buffer_load_dwordx4 v2, s[12:15], s37 offen lds
    v_mfma_f32_16x16x32_bf16 v[100:103], v[56:59], v[76:79], v[100:103]
    ds_read_b128 v[20:23], v5 offset:18432
    v_mfma_f32_16x16x32_bf16 v[104:107], v[56:59], v[80:83], v[104:107]
    ds_read_b128 v[24:27], v6 offset:16384
    v_mfma_f32_16x16x32_bf16 v[108:111], v[56:59], v[84:87], v[108:111]
    ds_read_b128 v[28:31], v6 offset:18432
    s_add_u32 m0, s34, 49152
    s_nop 0
    buffer_load_dwordx4 v3, s[12:15], s37 offen lds
    v_mfma_f32_16x16x32_bf16 v[112:115], v[56:59], v[88:91], v[112:115]
    ds_read_b64_tr_b16 v[32:33], v10 offset:0
    v_mfma_f32_16x16x32_bf16 v[116:119], v[60:63], v[72:75], v[116:119]
    ds_read_b64_tr_b16 v[34:35], v10 offset:5376
    s_add_u32 m0, s35, 49152
    s_nop 0
    buffer_load_dwordx4 v4, s[12:15], s37 offen lds
    v_mfma_f32_16x16x32_bf16 v[120:123], v[60:63], v[76:79], v[120:123]
    ds_read_b64_tr_b16 v[36:37], v10 offset:32
    v_mfma_f32_16x16x32_bf16 v[124:127], v[60:63], v[80:83], v[124:127]
    ds_read_b64_tr_b16 v[38:39], v10 offset:5408
    s_add_u32 s37, s37, s38
    s_add_u32 m0, s33, 70656
    s_nop 0
    buffer_load_dwordx4 v2, s[12:15], s37 offen lds
    v_mfma_f32_16x16x32_bf16 v[128:131], v[60:63], v[84:87], v[128:131]
    ds_read_b64_tr_b16 v[40:41], v10 offset:64
    v_mfma_f32_16x16x32_bf16 v[132:135], v[60:63], v[88:91], v[132:135]
    ds_read_b64_tr_b16 v[42:43], v10 offset:5440
    s_add_u32 m0, s34, 70656
    s_nop 0
    buffer_load_dwordx4 v3, s[12:15], s37 offen lds
    v_mfma_f32_16x16x32_bf16 v[136:139], v[64:67], v[72:75], v[136:139]
    ds_read_b64_tr_b16 v[44:45], v10 offset:96
    v_mfma_f32_16x16x32_bf16 v[140:143], v[64:67], v[76:79], v[140:143]
    ds_read_b64_tr_b16 v[46:47], v10 offset:5472
    s_add_u32 m0, s35, 70656
    s_nop 0
    buffer_load_dwordx4 v4, s[12:15], s37 offen lds
    v_mfma_f32_16x16x32_bf16 v[144:147], v[64:67], v[80:83], v[144:147]
    ds_read_b64_tr_b16 v[48:49], v10 offset:128
    v_mfma_f32_16x16x32_bf16 v[148:151], v[64:67], v[84:87], v[148:151]
    ds_read_b64_tr_b16 v[50:51], v10 offset:5504
    s_add_u32 m0, s32, 0
    s_mov_b32 s36, 384
    buffer_load_dwordx4 v1, s[8:11], s36 offen lds
    v_mfma_f32_16x16x32_bf16 v[152:155], v[64:67], v[88:91], v[152:155]
    v_mfma_f32_16x16x32_bf16 v[156:159], v[68:71], v[72:75], v[156:159]
    s_add_u32 m0, s32, 8192
    s_mov_b32 s36, 82304
    buffer_load_dwordx4 v1, s[8:11], s36 offen lds
    v_mfma_f32_16x16x32_bf16 v[160:163], v[68:71], v[76:79], v[160:163]
    v_mfma_f32_16x16x32_bf16 v[164:167], v[68:71], v[80:83], v[164:167]
    s_or_b32 s24, s2, s3
    s_cbranch_scc1 L_noi_46
    v_mov_b32 v13, 0
    v_mov_b32 v14, 1
    s_mov_b64 exec, 1
    global_store_dword v13, v14, s[6:7] sc1
    s_mov_b64 exec, -1
L_noi_46:
    v_mfma_f32_16x16x32_bf16 v[168:171], v[68:71], v[84:87], v[168:171]
    v_mfma_f32_16x16x32_bf16 v[172:175], v[68:71], v[88:91], v[172:175]
    s_waitcnt vmcnt(13) lgkmcnt(0)
    s_barrier
    v_mfma_f32_16x16x32_bf16 v[96:99], v[16:19], v[32:35], v[96:99]
    ds_read_b128 v[56:59], v7 offset:16384
    s_add_u32 s37, s37, s38
    s_add_u32 m0, s33, 92160
    s_nop 0
    buffer_load_dwordx4 v2, s[12:15], s37 offen lds
    v_mfma_f32_16x16x32_bf16 v[100:103], v[16:19], v[36:39], v[100:103]
    ds_read_b128 v[60:63], v7 offset:18432
    v_mfma_f32_16x16x32_bf16 v[104:107], v[16:19], v[40:43], v[104:107]
    ds_read_b128 v[64:67], v8 offset:16384
    v_mfma_f32_16x16x32_bf16 v[108:111], v[16:19], v[44:47], v[108:111]
    ds_read_b128 v[68:71], v8 offset:18432
    v_mfma_f32_16x16x32_bf16 v[112:115], v[16:19], v[48:51], v[112:115]
    ds_read_b64_tr_b16 v[72:73], v10 offset:21504
    s_add_u32 m0, s34, 92160
    s_nop 0
    buffer_load_dwordx4 v3, s[12:15], s37 offen lds
    v_mfma_f32_16x16x32_bf16 v[116:119], v[20:23], v[32:35], v[116:119]
    ds_read_b64_tr_b16 v[74:75], v10 offset:26880
    v_mfma_f32_16x16x32_bf16 v[120:123], v[20:23], v[36:39], v[120:123]
    ds_read_b64_tr_b16 v[76:77], v10 offset:21536
    v_mfma_f32_16x16x32_bf16 v[124:127], v[20:23], v[40:43], v[124:127]
    ds_read_b64_tr_b16 v[78:79], v10 offset:26912
    v_mfma_f32_16x16x32_bf16 v[128:131], v[20:23], v[44:47], v[128:131]
    ds_read_b64_tr_b16 v[80:81], v10 offset:21568
    s_add_u32 m0, s35, 92160
    s_nop 0
    buffer_load_dwordx4 v4, s[12:15], s37 offen lds
    v_mfma_f32_16x16x32_bf16 v[132:135], v[20:23], v[48:51], v[132:135]
    ds_read_b64_tr_b16 v[82:83], v10 offset:26944
    v_mfma_f32_16x16x32_bf16 v[136:139], v[24:27], v[32:35], v[136:139]
    ds_read_b64_tr_b16 v[84:85], v10 offset:21600
    v_mfma_f32_16x16x32_bf16 v[140:143], v[24:27], v[36:39], v[140:143]
    ds_read_b64_tr_b16 v[86:87], v10 offset:26976
    v_mfma_f32_16x16x32_bf16 v[144:147], v[24:27], v[40:43], v[144:147]
    ds_read_b64_tr_b16 v[88:89], v10 offset:21632
    buffer_load_dword v243, v241, s[8:11], 0 offen offset:512
    v_mfma_f32_16x16x32_bf16 v[148:151], v[24:27], v[44:47], v[148:151]
    ds_read_b64_tr_b16 v[90:91], v10 offset:27008
    v_mfma_f32_16x16x32_bf16 v[152:155], v[24:27], v[48:51], v[152:155]
    v_mfma_f32_16x16x32_bf16 v[156:159], v[28:31], v[32:35], v[156:159]
    v_mfma_f32_16x16x32_bf16 v[160:163], v[28:31], v[36:39], v[160:163]
    s_mul_i32 s25, s38, 8
    buffer_load_dword v242, v240, s[12:15], s25 offen
    v_mfma_f32_16x16x32_bf16 v[164:167], v[28:31], v[40:43], v[164:167]
    v_mfma_f32_16x16x32_bf16 v[168:171], v[28:31], v[44:47], v[168:171]
    v_mfma_f32_16x16x32_bf16 v[172:175], v[28:31], v[48:51], v[172:175]
    s_waitcnt vmcnt(13) lgkmcnt(0)
    s_barrier
    v_mfma_f32_16x16x32_bf16 v[96:99], v[56:59], v[72:75], v[96:99]
    ds_read_b128 v[16:19], v5 offset:32768
    s_add_u32 s37, s37, s38
    s_add_u32 m0, s33, 113664
    s_nop 0
    buffer_load_dwordx4 v2, s[12:15], s37 offen lds
    v_mfma_f32_16x16x32_bf16 v[100:103], v[56:59], v[76:79], v[100:103]
    ds_read_b128 v[20:23], v5 offset:34816
    v_mfma_f32_16x16x32_bf16 v[104:107], v[56:59], v[80:83], v[104:107]
    ds_read_b128 v[24:27], v6 offset:32768
    v_mfma_f32_16x16x32_bf16 v[108:111], v[56:59], v[84:87], v[108:111]
    ds_read_b128 v[28:31], v6 offset:34816
    v_mfma_f32_16x16x32_bf16 v[112:115], v[56:59], v[88:91], v[112:115]
    ds_read_b64_tr_b16 v[32:33], v10 offset:43008
    s_add_u32 m0, s34, 113664
    s_nop 0
    buffer_load_dwordx4 v3, s[12:15], s37 offen lds
    v_mfma_f32_16x16x32_bf16 v[116:119], v[60:63], v[72:75], v[116:119]
    ds_read_b64_tr_b16 v[34:35], v10 offset:48384
    v_mfma_f32_16x16x32_bf16 v[120:123], v[60:63], v[76:79], v[120:123]
    ds_read_b64_tr_b16 v[36:37], v10 offset:43040
    v_mfma_f32_16x16x32_bf16 v[124:127], v[60:63], v[80:83], v[124:127]
    ds_read_b64_tr_b16 v[38:39], v10 offset:48416
    v_mfma_f32_16x16x32_bf16 v[128:131], v[60:63], v[84:87], v[128:131]
    ds_read_b64_tr_b16 v[40:41], v10 offset:43072
    s_add_u32 m0, s35, 113664
    s_nop 0
    buffer_load_dwordx4 v4, s[12:15], s37 offen lds
    v_mfma_f32_16x16x32_bf16 v[132:135], v[60:63], v[88:91], v[132:135]
    ds_read_b64_tr_b16 v[42:43], v10 offset:48448
    v_mfma_f32_16x16x32_bf16 v[136:139], v[64:67], v[72:75], v[136:139]
    ds_read_b64_tr_b16 v[44:45], v10 offset:43104
    v_mfma_f32_16x16x32_bf16 v[140:143], v[64:67], v[76:79], v[140:143]
    ds_read_b64_tr_b16 v[46:47], v10 offset:48480
    v_mfma_f32_16x16x32_bf16 v[144:147], v[64:67], v[80:83], v[144:147]
    ds_read_b64_tr_b16 v[48:49], v10 offset:43136
    s_add_u32 m0, s32, 16384
    s_mov_b32 s36, 512
    buffer_load_dwordx4 v1, s[8:11], s36 offen lds
    v_mfma_f32_16x16x32_bf16 v[148:151], v[64:67], v[84:87], v[148:151]
    ds_read_b64_tr_b16 v[50:51], v10 offset:48512
    v_mfma_f32_16x16x32_bf16 v[152:155], v[64:67], v[88:91], v[152:155]
    v_mfma_f32_16x16x32_bf16 v[156:159], v[68:71], v[72:75], v[156:159]
    v_mfma_f32_16x16x32_bf16 v[160:163], v[68:71], v[76:79], v[160:163]
    s_add_u32 m0, s32, 24576
    s_mov_b32 s36, 82432
    buffer_load_dwordx4 v1, s[8:11], s36 offen lds
    v_mfma_f32_16x16x32_bf16 v[164:167], v[68:71], v[80:83], v[164:167]
    v_mfma_f32_16x16x32_bf16 v[168:171], v[68:71], v[84:87], v[168:171]
    v_mfma_f32_16x16x32_bf16 v[172:175], v[68:71], v[88:91], v[172:175]
    s_waitcnt vmcnt(15) lgkmcnt(0)
    s_barrier
    v_mfma_f32_16x16x32_bf16 v[96:99], v[16:19], v[32:35], v[96:99]
    ds_read_b128 v[56:59], v7 offset:32768
    s_add_u32 s37, s37, s38
    s_add_u32 m0, s33, 135168
    s_nop 0
    buffer_load_dwordx4 v2, s[12:15], s37 offen lds
    v_mfma_f32_16x16x32_bf16 v[100:103], v[16:19], v[36:39], v[100:103]
    ds_read_b128 v[60:63], v7 offset:34816
    v_mfma_f32_16x16x32_bf16 v[104:107], v[16:19], v[40:43], v[104:107]
    ds_read_b128 v[64:67], v8 offset:32768
    v_mfma_f32_16x16x32_bf16 v[108:111], v[16:19], v[44:47], v[108:111]
    ds_read_b128 v[68:71], v8 offset:34816
    v_mfma_f32_16x16x32_bf16 v[112:115], v[16:19], v[48:51], v[112:115]
    ds_read_b64_tr_b16 v[72:73], v9 offset:0
    v_mfma_f32_16x16x32_bf16 v[116:119], v[20:23], v[32:35], v[116:119]
    ds_read_b64_tr_b16 v[74:75], v9 offset:5376
    v_mfma_f32_16x16x32_bf16 v[120:123], v[20:23], v[36:39], v[120:123]
    ds_read_b64_tr_b16 v[76:77], v9 offset:32
    v_mfma_f32_16x16x32_bf16 v[124:127], v[20:23], v[40:43], v[124:127]
    ds_read_b64_tr_b16 v[78:79], v9 offset:5408
    s_add_u32 m0, s34, 135168
    s_nop 0
    buffer_load_dwordx4 v3, s[12:15], s37 offen lds
    v_mfma_f32_16x16x32_bf16 v[128:131], v[20:23], v[44:47], v[128:131]
    ds_read_b64_tr_b16 v[80:81], v9 offset:64
    v_mfma_f32_16x16x32_bf16 v[132:135], v[20:23], v[48:51], v[132:135]
    ds_read_b64_tr_b16 v[82:83], v9 offset:5440
    v_mfma_f32_16x16x32_bf16 v[136:139], v[24:27], v[32:35], v[136:139]
    ds_read_b64_tr_b16 v[84:85], v9 offset:96
    v_mfma_f32_16x16x32_bf16 v[140:143], v[24:27], v[36:39], v[140:143]
    ds_read_b64_tr_b16 v[86:87], v9 offset:5472
    v_mfma_f32_16x16x32_bf16 v[144:147], v[24:27], v[40:43], v[144:147]
    ds_read_b64_tr_b16 v[88:89], v9 offset:128
    v_mfma_f32_16x16x32_bf16 v[148:151], v[24:27], v[44:47], v[148:151]
    ds_read_b64_tr_b16 v[90:91], v9 offset:5504
    s_add_u32 m0, s35, 135168
    s_nop 0
    buffer_load_dwordx4 v4, s[12:15], s37 offen lds
    v_mfma_f32_16x16x32_bf16 v[152:155], v[24:27], v[48:51], v[152:155]
    v_mfma_f32_16x16x32_bf16 v[156:159], v[28:31], v[32:35], v[156:159]
    v_mfma_f32_16x16x32_bf16 v[160:163], v[28:31], v[36:39], v[160:163]
    v_mfma_f32_16x16x32_bf16 v[164:167], v[28:31], v[40:43], v[164:167]
    v_mfma_f32_16x16x32_bf16 v[168:171], v[28:31], v[44:47], v[168:171]
    v_mfma_f32_16x16x32_bf16 v[172:175], v[28:31], v[48:51], v[172:175]
    s_waitcnt vmcnt(13) lgkmcnt(0)
    s_barrier
    v_mfma_f32_16x16x32_bf16 v[96:99], v[56:59], v[72:75], v[96:99]
    ds_read_b128 v[16:19], v5 offset:0
    s_add_u32 s37, s37, s38
    s_add_u32 m0, s33, 49152
    s_nop 0
    buffer_load_dwordx4 v2, s[12:15], s37 offen lds
    v_mfma_f32_16x16x32_bf16 v[100:103], v[56:59], v[76:79], v[100:103]
    ds_read_b128 v[20:23], v5 offset:2048
    v_mfma_f32_16x16x32_bf16 v[104:107], v[56:59], v[80:83], v[104:107]
    ds_read_b128 v[24:27], v6 offset:0
    v_mfma_f32_16x16x32_bf16 v[108:111], v[56:59], v[84:87], v[108:111]
    ds_read_b128 v[28:31], v6 offset:2048
    v_mfma_f32_16x16x32_bf16 v[112:115], v[56:59], v[88:91], v[112:115]
    ds_read_b64_tr_b16 v[32:33], v9 offset:21504
    s_add_u32 m0, s34, 49152
    s_nop 0
    buffer_load_dwordx4 v3, s[12:15], s37 offen lds
    v_mfma_f32_16x16x32_bf16 v[116:119], v[60:63], v[72:75], v[116:119]
    ds_read_b64_tr_b16 v[34:35], v9 offset:26880
    v_mfma_f32_16x16x32_bf16 v[120:123], v[60:63], v[76:79], v[120:123]
    ds_read_b64_tr_b16 v[36:37], v9 offset:21536
    v_mfma_f32_16x16x32_bf16 v[124:127], v[60:63], v[80:83], v[124:127]
    ds_read_b64_tr_b16 v[38:39], v9 offset:26912
    v_mfma_f32_16x16x32_bf16 v[128:131], v[60:63], v[84:87], v[128:131]
    ds_read_b64_tr_b16 v[40:41], v9 offset:21568
    s_add_u32 m0, s35, 49152
    s_nop 0
    buffer_load_dwordx4 v4, s[12:15], s37 offen lds
    v_mfma_f32_16x16x32_bf16 v[132:135], v[60:63], v[88:91], v[132:135]
    ds_read_b64_tr_b16 v[42:43], v9 offset:26944
    v_mfma_f32_16x16x32_bf16 v[136:139], v[64:67], v[72:75], v[136:139]
    ds_read_b64_tr_b16 v[44:45], v9 offset:21600
    v_mfma_f32_16x16x32_bf16 v[140:143], v[64:67], v[76:79], v[140:143]
    ds_read_b64_tr_b16 v[46:47], v9 offset:26976
    v_mfma_f32_16x16x32_bf16 v[144:147], v[64:67], v[80:83], v[144:147]
    ds_read_b64_tr_b16 v[48:49], v9 offset:21632
    s_add_u32 m0, s32, 32768
    s_mov_b32 s36, 640
    buffer_load_dwordx4 v1, s[8:11], s36 offen lds
    v_mfma_f32_16x16x32_bf16 v[148:151], v[64:67], v[84:87], v[148:151]
    ds_read_b64_tr_b16 v[50:51], v9 offset:27008
    v_mfma_f32_16x16x32_bf16 v[152:155], v[64:67], v[88:91], v[152:155]
    v_mfma_f32_16x16x32_bf16 v[156:159], v[68:71], v[72:75], v[156:159]
    v_mfma_f32_16x16x32_bf16 v[160:163], v[68:71], v[76:79], v[160:163]
    s_add_u32 m0, s32, 40960
    s_mov_b32 s36, 82560
    buffer_load_dwordx4 v1, s[8:11], s36 offen lds
    v_mfma_f32_16x16x32_bf16 v[164:167], v[68:71], v[80:83], v[164:167]
    v_mfma_f32_16x16x32_bf16 v[168:171], v[68:71], v[84:87], v[168:171]
    v_mfma_f32_16x16x32_bf16 v[172:175], v[68:71], v[88:91], v[172:175]
    s_waitcnt vmcnt(15) lgkmcnt(0)
    s_barrier
    v_mfma_f32_16x16x32_bf16 v[96:99], v[16:19], v[32:35], v[96:99]
    ds_read_b128 v[56:59], v7 offset:0
    s_add_u32 s37, s37, s38
    s_add_u32 m0, s33, 70656
    s_nop 0
    buffer_load_dwordx4 v2, s[12:15], s37 offen lds
    v_mfma_f32_16x16x32_bf16 v[100:103], v[16:19], v[36:39], v[100:103]
    ds_read_b128 v[60:63], v7 offset:2048
    v_mfma_f32_16x16x32_bf16 v[104:107], v[16:19], v[40:43], v[104:107]
    ds_read_b128 v[64:67], v8 offset:0
    v_mfma_f32_16x16x32_bf16 v[108:111], v[16:19], v[44:47], v[108:111]
    ds_read_b128 v[68:71], v8 offset:2048
    v_mfma_f32_16x16x32_bf16 v[112:115], v[16:19], v[48:51], v[112:115]
    ds_read_b64_tr_b16 v[72:73], v10 offset:0
    s_add_u32 m0, s34, 70656
    s_nop 0
    buffer_load_dwordx4 v3, s[12:15], s37 offen lds
    v_mfma_f32_16x16x32_bf16 v[116:119], v[20:23], v[32:35], v[116:119]
    ds_read_b64_tr_b16 v[74:75], v10 offset:5376
    v_mfma_f32_16x16x32_bf16 v[120:123], v[20:23], v[36:39], v[120:123]
    ds_read_b64_tr_b16 v[76:77], v10 offset:32
    v_mfma_f32_16x16x32_bf16 v[124:127], v[20:23], v[40:43], v[124:127]
    ds_read_b64_tr_b16 v[78:79], v10 offset:5408
    v_mfma_f32_16x16x32_bf16 v[128:131], v[20:23], v[44:47], v[128:131]
    ds_read_b64_tr_b16 v[80:81], v10 offset:64
    s_add_u32 m0, s35, 70656
    s_nop 0
    buffer_load_dwordx4 v4, s[12:15], s37 offen lds
    v_mfma_f32_16x16x32_bf16 v[132:135], v[20:23], v[48:51], v[132:135]
    ds_read_b64_tr_b16 v[82:83], v10 offset:5440
    v_mfma_f32_16x16x32_bf16 v[136:139], v[24:27], v[32:35], v[136:139]
    ds_read_b64_tr_b16 v[84:85], v10 offset:96
    v_mfma_f32_16x16x32_bf16 v[140:143], v[24:27], v[36:39], v[140:143]
    ds_read_b64_tr_b16 v[86:87], v10 offset:5472
    v_mfma_f32_16x16x32_bf16 v[144:147], v[24:27], v[40:43], v[144:147]
    ds_read_b64_tr_b16 v[88:89], v10 offset:128
    buffer_load_dword v243, v241, s[8:11], 0 offen offset:768
    v_mfma_f32_16x16x32_bf16 v[148:151], v[24:27], v[44:47], v[148:151]
    ds_read_b64_tr_b16 v[90:91], v10 offset:5504
    v_mfma_f32_16x16x32_bf16 v[152:155], v[24:27], v[48:51], v[152:155]
    v_mfma_f32_16x16x32_bf16 v[156:159], v[28:31], v[32:35], v[156:159]
    v_mfma_f32_16x16x32_bf16 v[160:163], v[28:31], v[36:39], v[160:163]
    s_mul_i32 s25, s38, 12
    buffer_load_dword v242, v240, s[12:15], s25 offen
    v_mfma_f32_16x16x32_bf16 v[164:167], v[28:31], v[40:43], v[164:167]
    v_mfma_f32_16x16x32_bf16 v[168:171], v[28:31], v[44:47], v[168:171]
    v_mfma_f32_16x16x32_bf16 v[172:175], v[28:31], v[48:51], v[172:175]
    s_waitcnt vmcnt(13) lgkmcnt(0)
    s_barrier
    v_mfma_f32_16x16x32_bf16 v[96:99], v[56:59], v[72:75], v[96:99]
    ds_read_b128 v[16:19], v5 offset:16384
    s_add_u32 s37, s37, s38
    s_add_u32 m0, s33, 92160
    s_nop 0
    buffer_load_dwordx4 v2, s[12:15], s37 offen lds
    v_mfma_f32_16x16x32_bf16 v[100:103], v[56:59], v[76:79], v[100:103]
    ds_read_b128 v[20:23], v5 offset:18432
    v_mfma_f32_16x16x32_bf16 v[104:107], v[56:59], v[80:83], v[104:107]
    ds_read_b128 v[24:27], v6 offset:16384
    v_mfma_f32_16x16x32_bf16 v[108:111], v[56:59], v[84:87], v[108:111]
    ds_read_b128 v[28:31], v6 offset:18432
    v_mfma_f32_16x16x32_bf16 v[112:115], v[56:59], v[88:91], v[112:115]
    ds_read_b64_tr_b16 v[32:33], v10 offset:21504
    s_add_u32 m0, s34, 92160
    s_nop 0
    buffer_load_dwordx4 v3, s[12:15], s37 offen lds
    v_mfma_f32_16x16x32_bf16 v[116:119], v[60:63], v[72:75], v[116:119]
    ds_read_b64_tr_b16 v[34:35], v10 offset:26880
    v_mfma_f32_16x16x32_bf16 v[120:123], v[60:63], v[76:79], v[120:123]
    ds_read_b64_tr_b16 v[36:37], v10 offset:21536
    v_mfma_f32_16x16x32_bf16 v[124:127], v[60:63], v[80:83], v[124:127]
    ds_read_b64_tr_b16 v[38:39], v10 offset:26912
    v_mfma_f32_16x16x32_bf16 v[128:131], v[60:63], v[84:87], v[128:131]
    ds_read_b64_tr_b16 v[40:41], v10 offset:21568
    s_add_u32 m0, s35, 92160
    s_nop 0
    buffer_load_dwordx4 v4, s[12:15], s37 offen lds
    v_mfma_f32_16x16x32_bf16 v[132:135], v[60:63], v[88:91], v[132:135]
    ds_read_b64_tr_b16 v[42:43], v10 offset:26944
    v_mfma_f32_16x16x32_bf16 v[136:139], v[64:67], v[72:75], v[136:139]
    ds_read_b64_tr_b16 v[44:45], v10 offset:21600
    v_mfma_f32_16x16x32_bf16 v[140:143], v[64:67], v[76:79], v[140:143]
    ds_read_b64_tr_b16 v[46:47], v10 offset:26976
    v_mfma_f32_16x16x32_bf16 v[144:147], v[64:67], v[80:83], v[144:147]
    ds_read_b64_tr_b16 v[48:49], v10 offset:21632
    s_add_u32 m0, s32, 0
    s_mov_b32 s36, 768
    buffer_load_dwordx4 v1, s[8:11], s36 offen lds
    v_mfma_f32_16x16x32_bf16 v[148:151], v[64:67], v[84:87], v[148:151]
    ds_read_b64_tr_b16 v[50:51], v10 offset:27008
    v_mfma_f32_16x16x32_bf16 v[152:155], v[64:67], v[88:91], v[152:155]
    v_mfma_f32_16x16x32_bf16 v[156:159], v[68:71], v[72:75], v[156:159]
    v_mfma_f32_16x16x32_bf16 v[160:163], v[68:71], v[76:79], v[160:163]
    s_add_u32 m0, s32, 8192
    s_mov_b32 s36, 82688
    buffer_load_dwordx4 v1, s[8:11], s36 offen lds
    v_mfma_f32_16x16x32_bf16 v[164:167], v[68:71], v[80:83], v[164:167]
    v_mfma_f32_16x16x32_bf16 v[168:171], v[68:71], v[84:87], v[168:171]
    v_mfma_f32_16x16x32_bf16 v[172:175], v[68:71], v[88:91], v[172:175]
    s_waitcnt vmcnt(15) lgkmcnt(0)
    s_barrier
    v_mfma_f32_16x16x32_bf16 v[96:99], v[16:19], v[32:35], v[96:99]
    ds_read_b128 v[56:59], v7 offset:16384
    s_add_u32 s37, s37, s38
    s_add_u32 m0, s33, 113664
    s_nop 0
    buffer_load_dwordx4 v2, s[12:15], s37 offen lds
    v_mfma_f32_16x16x32_bf16 v[100:103], v[16:19], v[36:39], v[100:103]
    ds_read_b128 v[60:63], v7 offset:18432
    v_mfma_f32_16x16x32_bf16 v[104:107], v[16:19], v[40:43], v[104:107]
    ds_read_b128 v[64:67], v8 offset:16384
    v_mfma_f32_16x16x32_bf16 v[108:111], v[16:19], v[44:47], v[108:111]
    ds_read_b128 v[68:71], v8 offset:18432
    v_mfma_f32_16x16x32_bf16 v[112:115], v[16:19], v[48:51], v[112:115]
    ds_read_b64_tr_b16 v[72:73], v10 offset:43008
    v_mfma_f32_16x16x32_bf16 v[116:119], v[20:23], v[32:35], v[116:119]
    ds_read_b64_tr_b16 v[74:75], v10 offset:48384
    v_mfma_f32_16x16x32_bf16 v[120:123], v[20:23], v[36:39], v[120:123]
    ds_read_b64_tr_b16 v[76:77], v10 offset:43040
    v_mfma_f32_16x16x32_bf16 v[124:127], v[20:23], v[40:43], v[124:127]
    ds_read_b64_tr_b16 v[78:79], v10 offset:48416
    s_add_u32 m0, s34, 113664
    s_nop 0
    buffer_load_dwordx4 v3, s[12:15], s37 offen lds
    v_mfma_f32_16x16x32_bf16 v[128:131], v[20:23], v[44:47], v[128:131]
    ds_read_b64_tr_b16 v[80:81], v10 offset:43072
    v_mfma_f32_16x16x32_bf16 v[132:135], v[20:23], v[48:51], v[132:135]
    ds_read_b64_tr_b16 v[82:83], v10 offset:48448
    v_mfma_f32_16x16x32_bf16 v[136:139], v[24:27], v[32:35], v[136:139]
    ds_read_b64_tr_b16 v[84:85], v10 offset:43104
    v_mfma_f32_16x16x32_bf16 v[140:143], v[24:27], v[36:39], v[140:143]
    ds_read_b64_tr_b16 v[86:87], v10 offset:48480
    v_mfma_f32_16x16x32_bf16 v[144:147], v[24:27], v[40:43], v[144:147]
    ds_read_b64_tr_b16 v[88:89], v10 offset:43136
    v_mfma_f32_16x16x32_bf16 v[148:151], v[24:27], v[44:47], v[148:151]
    ds_read_b64_tr_b16 v[90:91], v10 offset:48512
    s_add_u32 m0, s35, 113664
    s_nop 0
    buffer_load_dwordx4 v4, s[12:15], s37 offen lds
    v_mfma_f32_16x16x32_bf16 v[152:155], v[24:27], v[48:51], v[152:155]
    v_mfma_f32_16x16x32_bf16 v[156:159], v[28:31], v[32:35], v[156:159]
    v_mfma_f32_16x16x32_bf16 v[160:163], v[28:31], v[36:39], v[160:163]
    v_mfma_f32_16x16x32_bf16 v[164:167], v[28:31], v[40:43], v[164:167]
    v_mfma_f32_16x16x32_bf16 v[168:171], v[28:31], v[44:47], v[168:171]
    v_mfma_f32_16x16x32_bf16 v[172:175], v[28:31], v[48:51], v[172:175]
    s_waitcnt vmcnt(13) lgkmcnt(0)
    s_barrier
    v_mfma_f32_16x16x32_bf16 v[96:99], v[56:59], v[72:75], v[96:99]
    ds_read_b128 v[16:19], v5 offset:32768
    s_add_u32 s37, s37, s38
    s_add_u32 m0, s33, 135168
    s_nop 0
    buffer_load_dwordx4 v2, s[12:15], s37 offen lds
    v_mfma_f32_16x16x32_bf16 v[100:103], v[56:59], v[76:79], v[100:103]
    ds_read_b128 v[20:23], v5 offset:34816
    v_mfma_f32_16x16x32_bf16 v[104:107], v[56:59], v[80:83], v[104:107]
    ds_read_b128 v[24:27], v6 offset:32768
    v_mfma_f32_16x16x32_bf16 v[108:111], v[56:59], v[84:87], v[108:111]
    ds_read_b128 v[28:31], v6 offset:34816
    v_mfma_f32_16x16x32_bf16 v[112:115], v[56:59], v[88:91], v[112:115]
    ds_read_b64_tr_b16 v[32:33], v9 offset:0
    s_add_u32 m0, s34, 135168
    s_nop 0
    buffer_load_dwordx4 v3, s[12:15], s37 offen lds
    v_mfma_f32_16x16x32_bf16 v[116:119], v[60:63], v[72:75], v[116:119]
    ds_read_b64_tr_b16 v[34:35], v9 offset:5376
    v_mfma_f32_16x16x32_bf16 v[120:123], v[60:63], v[76:79], v[120:123]
    ds_read_b64_tr_b16 v[36:37], v9 offset:32
    v_mfma_f32_16x16x32_bf16 v[124:127], v[60:63], v[80:83], v[124:127]
    ds_read_b64_tr_b16 v[38:39], v9 offset:5408
    v_mfma_f32_16x16x32_bf16 v[128:131], v[60:63], v[84:87], v[128:131]
    ds_read_b64_tr_b16 v[40:41], v9 offset:64
    s_add_u32 m0, s35, 135168
    s_nop 0
    buffer_load_dwordx4 v4, s[12:15], s37 offen lds
    v_mfma_f32_16x16x32_bf16 v[132:135], v[60:63], v[88:91], v[132:135]
    ds_read_b64_tr_b16 v[42:43], v9 offset:5440
    v_mfma_f32_16x16x32_bf16 v[136:139], v[64:67], v[72:75], v[136:139]
    ds_read_b64_tr_b16 v[44:45], v9 offset:96
    v_mfma_f32_16x16x32_bf16 v[140:143], v[64:67], v[76:79], v[140:143]
    ds_read_b64_tr_b16 v[46:47], v9 offset:5472
    v_mfma_f32_16x16x32_bf16 v[144:147], v[64:67], v[80:83], v[144:147]
    ds_read_b64_tr_b16 v[48:49], v9 offset:128
    s_add_u32 m0, s32, 16384
    s_mov_b32 s36, 896
    buffer_load_dwordx4 v1, s[8:11], s36 offen lds
    v_mfma_f32_16x16x32_bf16 v[148:151], v[64:67], v[84:87], v[148:151]
    ds_read_b64_tr_b16 v[50:51], v9 offset:5504
    v_mfma_f32_16x16x32_bf16 v[152:155], v[64:67], v[88:91], v[152:155]
    v_mfma_f32_16x16x32_bf16 v[156:159], v[68:71], v[72:75], v[156:159]
    v_mfma_f32_16x16x32_bf16 v[160:163], v[68:71], v[76:79], v[160:163]
    s_add_u32 m0, s32, 24576
    s_mov_b32 s36, 82816
    buffer_load_dwordx4 v1, s[8:11], s36 offen lds
    v_mfma_f32_16x16x32_bf16 v[164:167], v[68:71], v[80:83], v[164:167]
    v_mfma_f32_16x16x32_bf16 v[168:171], v[68:71], v[84:87], v[168:171]
    v_mfma_f32_16x16x32_bf16 v[172:175], v[68:71], v[88:91], v[172:175]
    s_waitcnt vmcnt(15) lgkmcnt(0)
    s_barrier
    v_mfma_f32_16x16x32_bf16 v[96:99], v[16:19], v[32:35], v[96:99]
    ds_read_b128 v[56:59], v7 offset:32768
    s_add_u32 s37, s37, s38
    s_add_u32 m0, s33, 49152
    s_nop 0
    buffer_load_dwordx4 v2, s[12:15], s37 offen lds
    v_mfma_f32_16x16x32_bf16 v[100:103], v[16:19], v[36:39], v[100:103]
    ds_read_b128 v[60:63], v7 offset:34816
    v_mfma_f32_16x16x32_bf16 v[104:107], v[16:19], v[40:43], v[104:107]
    ds_read_b128 v[64:67], v8 offset:32768
    v_mfma_f32_16x16x32_bf16 v[108:111], v[16:19], v[44:47], v[108:111]
    ds_read_b128 v[68:71], v8 offset:34816
    v_mfma_f32_16x16x32_bf16 v[112:115], v[16:19], v[48:51], v[112:115]
    ds_read_b64_tr_b16 v[72:73], v9 offset:21504
    s_add_u32 m0, s34, 49152
    s_nop 0
    buffer_load_dwordx4 v3, s[12:15], s37 offen lds
    v_mfma_f32_16x16x32_bf16 v[116:119], v[20:23], v[32:35], v[116:119]
    ds_read_b64_tr_b16 v[74:75], v9 offset:26880
    v_mfma_f32_16x16x32_bf16 v[120:123], v[20:23], v[36:39], v[120:123]
    ds_read_b64_tr_b16 v[76:77], v9 offset:21536
    v_mfma_f32_16x16x32_bf16 v[124:127], v[20:23], v[40:43], v[124:127]
    ds_read_b64_tr_b16 v[78:79], v9 offset:26912
    v_mfma_f32_16x16x32_bf16 v[128:131], v[20:23], v[44:47], v[128:131]
    ds_read_b64_tr_b16 v[80:81], v9 offset:21568
    s_add_u32 m0, s35, 49152
    s_nop 0
    buffer_load_dwordx4 v4, s[12:15], s37 offen lds
    v_mfma_f32_16x16x32_bf16 v[132:135], v[20:23], v[48:51], v[132:135]
    ds_read_b64_tr_b16 v[82:83], v9 offset:26944
    v_mfma_f32_16x16x32_bf16 v[136:139], v[24:27], v[32:35], v[136:139]
    ds_read_b64_tr_b16 v[84:85], v9 offset:21600
    v_mfma_f32_16x16x32_bf16 v[140:143], v[24:27], v[36:39], v[140:143]
    ds_read_b64_tr_b16 v[86:87], v9 offset:26976
    v_mfma_f32_16x16x32_bf16 v[144:147], v[24:27], v[40:43], v[144:147]
    ds_read_b64_tr_b16 v[88:89], v9 offset:21632
    buffer_load_dword v243, v241, s[8:11], 0 offen offset:1024
    v_mfma_f32_16x16x32_bf16 v[148:151], v[24:27], v[44:47], v[148:151]
    ds_read_b64_tr_b16 v[90:91], v9 offset:27008
    v_mfma_f32_16x16x32_bf16 v[152:155], v[24:27], v[48:51], v[152:155]
    v_mfma_f32_16x16x32_bf16 v[156:159], v[28:31], v[32:35], v[156:159]
    v_mfma_f32_16x16x32_bf16 v[160:163], v[28:31], v[36:39], v[160:163]
    s_mul_i32 s25, s38, 16
    buffer_load_dword v242, v240, s[12:15], s25 offen
    v_mfma_f32_16x16x32_bf16 v[164:167], v[28:31], v[40:43], v[164:167]
    v_mfma_f32_16x16x32_bf16 v[168:171], v[28:31], v[44:47], v[168:171]
    v_mfma_f32_16x16x32_bf16 v[172:175], v[28:31], v[48:51], v[172:175]
    s_waitcnt vmcnt(13) lgkmcnt(0)
    s_barrier
    v_mfma_f32_16x16x32_bf16 v[96:99], v[56:59], v[72:75], v[96:99]
    ds_read_b128 v[16:19], v5 offset:0
    s_add_u32 s37, s37, s38
    s_add_u32 m0, s33, 70656
    s_nop 0
    buffer_load_dwordx4 v2, s[12:15], s37 offen lds
    v_mfma_f32_16x16x32_bf16 v[100:103], v[56:59], v[76:79], v[100:103]
    ds_read_b128 v[20:23], v5 offset:2048
    v_mfma_f32_16x16x32_bf16 v[104:107], v[56:59], v[80:83], v[104:107]
    ds_read_b128 v[24:27], v6 offset:0
    v_mfma_f32_16x16x32_bf16 v[108:111], v[56:59], v[84:87], v[108:111]
    ds_read_b128 v[28:31], v6 offset:2048
    v_mfma_f32_16x16x32_bf16 v[112:115], v[56:59], v[88:91], v[112:115]
    ds_read_b64_tr_b16 v[32:33], v10 offset:0
    s_add_u32 m0, s34, 70656
    s_nop 0
    buffer_load_dwordx4 v3, s[12:15], s37 offen lds
    v_mfma_f32_16x16x32_bf16 v[116:119], v[60:63], v[72:75], v[116:119]
    ds_read_b64_tr_b16 v[34:35], v10 offset:5376
    v_mfma_f32_16x16x32_bf16 v[120:123], v[60:63], v[76:79], v[120:123]
    ds_read_b64_tr_b16 v[36:37], v10 offset:32
    v_mfma_f32_16x16x32_bf16 v[124:127], v[60:63], v[80:83], v[124:127]
    ds_read_b64_tr_b16 v[38:39], v10 offset:5408
    v_mfma_f32_16x16x32_bf16 v[128:131], v[60:63], v[84:87], v[128:131]
    ds_read_b64_tr_b16 v[40:41], v10 offset:64
    s_add_u32 m0, s35, 70656
    s_nop 0
    buffer_load_dwordx4 v4, s[12:15], s37 offen lds
    v_mfma_f32_16x16x32_bf16 v[132:135], v[60:63], v[88:91], v[132:135]
    ds_read_b64_tr_b16 v[42:43], v10 offset:5440
    v_mfma_f32_16x16x32_bf16 v[136:139], v[64:67], v[72:75], v[136:139]
    ds_read_b64_tr_b16 v[44:45], v10 offset:96
    v_mfma_f32_16x16x32_bf16 v[140:143], v[64:67], v[76:79], v[140:143]
    ds_read_b64_tr_b16 v[46:47], v10 offset:5472
    v_mfma_f32_16x16x32_bf16 v[144:147], v[64:67], v[80:83], v[144:147]
    ds_read_b64_tr_b16 v[48:49], v10 offset:128
    s_add_u32 m0, s32, 32768
    s_mov_b32 s36, 1024
    buffer_load_dwordx4 v1, s[8:11], s36 offen lds
    v_mfma_f32_16x16x32_bf16 v[148:151], v[64:67], v[84:87], v[148:151]
    ds_read_b64_tr_b16 v[50:51], v10 offset:5504
    v_mfma_f32_16x16x32_bf16 v[152:155], v[64:67], v[88:91], v[152:155]
    v_mfma_f32_16x16x32_bf16 v[156:159], v[68:71], v[72:75], v[156:159]
    v_mfma_f32_16x16x32_bf16 v[160:163], v[68:71], v[76:79], v[160:163]
    s_add_u32 m0, s32, 40960
    s_mov_b32 s36, 82944
    buffer_load_dwordx4 v1, s[8:11], s36 offen lds
    v_mfma_f32_16x16x32_bf16 v[164:167], v[68:71], v[80:83], v[164:167]
    v_mfma_f32_16x16x32_bf16 v[168:171], v[68:71], v[84:87], v[168:171]
    v_mfma_f32_16x16x32_bf16 v[172:175], v[68:71], v[88:91], v[172:175]
    s_waitcnt vmcnt(15) lgkmcnt(0)
    s_barrier
    v_mfma_f32_16x16x32_bf16 v[96:99], v[16:19], v[32:35], v[96:99]
    ds_read_b128 v[56:59], v7 offset:0
    s_add_u32 s37, s37, s38
    s_add_u32 m0, s33, 92160
    s_nop 0
    buffer_load_dwordx4 v2, s[12:15], s37 offen lds
    v_mfma_f32_16x16x32_bf16 v[100:103], v[16:19], v[36:39], v[100:103]
    ds_read_b128 v[60:63], v7 offset:2048
    v_mfma_f32_16x16x32_bf16 v[104:107], v[16:19], v[40:43], v[104:107]
    ds_read_b128 v[64:67], v8 offset:0
    v_mfma_f32_16x16x32_bf16 v[108:111], v[16:19], v[44:47], v[108:111]
    ds_read_b128 v[68:71], v8 offset:2048
    v_mfma_f32_16x16x32_bf16 v[112:115], v[16:19], v[48:51], v[112:115]
    ds_read_b64_tr_b16 v[72:73], v10 offset:21504
    v_mfma_f32_16x16x32_bf16 v[116:119], v[20:23], v[32:35], v[116:119]
    ds_read_b64_tr_b16 v[74:75], v10 offset:26880
    v_mfma_f32_16x16x32_bf16 v[120:123], v[20:23], v[36:39], v[120:123]
    ds_read_b64_tr_b16 v[76:77], v10 offset:21536
    v_mfma_f32_16x16x32_bf16 v[124:127], v[20:23], v[40:43], v[124:127]
    ds_read_b64_tr_b16 v[78:79], v10 offset:26912
    s_add_u32 m0, s34, 92160
    s_nop 0
    buffer_load_dwordx4 v3, s[12:15], s37 offen lds
    v_mfma_f32_16x16x32_bf16 v[128:131], v[20:23], v[44:47], v[128:131]
    ds_read_b64_tr_b16 v[80:81], v10 offset:21568
    v_mfma_f32_16x16x32_bf16 v[132:135], v[20:23], v[48:51], v[132:135]
    ds_read_b64_tr_b16 v[82:83], v10 offset:26944
    v_mfma_f32_16x16x32_bf16 v[136:139], v[24:27], v[32:35], v[136:139]
    ds_read_b64_tr_b16 v[84:85], v10 offset:21600
    v_mfma_f32_16x16x32_bf16 v[140:143], v[24:27], v[36:39], v[140:143]
    ds_read_b64_tr_b16 v[86:87], v10 offset:26976
    v_mfma_f32_16x16x32_bf16 v[144:147], v[24:27], v[40:43], v[144:147]
    ds_read_b64_tr_b16 v[88:89], v10 offset:21632
    v_mfma_f32_16x16x32_bf16 v[148:151], v[24:27], v[44:47], v[148:151]
    ds_read_b64_tr_b16 v[90:91], v10 offset:27008
    s_add_u32 m0, s35, 92160
    s_nop 0
    buffer_load_dwordx4 v4, s[12:15], s37 offen lds
    v_mfma_f32_16x16x32_bf16 v[152:155], v[24:27], v[48:51], v[152:155]
    v_mfma_f32_16x16x32_bf16 v[156:159], v[28:31], v[32:35], v[156:159]
    v_mfma_f32_16x16x32_bf16 v[160:163], v[28:31], v[36:39], v[160:163]
    v_mfma_f32_16x16x32_bf16 v[164:167], v[28:31], v[40:43], v[164:167]
    v_mfma_f32_16x16x32_bf16 v[168:171], v[28:31], v[44:47], v[168:171]
    v_mfma_f32_16x16x32_bf16 v[172:175], v[28:31], v[48:51], v[172:175]
    s_waitcnt vmcnt(13) lgkmcnt(0)
    s_barrier
    v_mfma_f32_16x16x32_bf16 v[96:99], v[56:59], v[72:75], v[96:99]
    ds_read_b128 v[16:19], v5 offset:16384
    s_add_u32 s37, s37, s38
    s_add_u32 m0, s33, 113664
    s_nop 0
    buffer_load_dwordx4 v2, s[12:15], s37 offen lds
    v_mfma_f32_16x16x32_bf16 v[100:103], v[56:59], v[76:79], v[100:103]
    ds_read_b128 v[20:23], v5 offset:18432
    v_mfma_f32_16x16x32_bf16 v[104:107], v[56:59], v[80:83], v[104:107]
    ds_read_b128 v[24:27], v6 offset:16384
    v_mfma_f32_16x16x32_bf16 v[108:111], v[56:59], v[84:87], v[108:111]
    ds_read_b128 v[28:31], v6 offset:18432
    v_mfma_f32_16x16x32_bf16 v[112:115], v[56:59], v[88:91], v[112:115]
    ds_read_b64_tr_b16 v[32:33], v10 offset:43008
    s_add_u32 m0, s34, 113664
    s_nop 0
    buffer_load_dwordx4 v3, s[12:15], s37 offen lds
    v_mfma_f32_16x16x32_bf16 v[116:119], v[60:63], v[72:75], v[116:119]
    ds_read_b64_tr_b16 v[34:35], v10 offset:48384
    v_mfma_f32_16x16x32_bf16 v[120:123], v[60:63], v[76:79], v[120:123]
    ds_read_b64_tr_b16 v[36:37], v10 offset:43040
    v_mfma_f32_16x16x32_bf16 v[124:127], v[60:63], v[80:83], v[124:127]
    ds_read_b64_tr_b16 v[38:39], v10 offset:48416
    v_mfma_f32_16x16x32_bf16 v[128:131], v[60:63], v[84:87], v[128:131]
    ds_read_b64_tr_b16 v[40:41], v10 offset:43072
    s_add_u32 m0, s35, 113664
    s_nop 0
    buffer_load_dwordx4 v4, s[12:15], s37 offen lds
    v_mfma_f32_16x16x32_bf16 v[132:135], v[60:63], v[88:91], v[132:135]
    ds_read_b64_tr_b16 v[42:43], v10 offset:48448
    v_mfma_f32_16x16x32_bf16 v[136:139], v[64:67], v[72:75], v[136:139]
    ds_read_b64_tr_b16 v[44:45], v10 offset:43104
    v_mfma_f32_16x16x32_bf16 v[140:143], v[64:67], v[76:79], v[140:143]
    ds_read_b64_tr_b16 v[46:47], v10 offset:48480
    v_mfma_f32_16x16x32_bf16 v[144:147], v[64:67], v[80:83], v[144:147]
    ds_read_b64_tr_b16 v[48:49], v10 offset:43136
    s_add_u32 m0, s32, 0
    s_mov_b32 s36, 1152
    buffer_load_dwordx4 v1, s[8:11], s36 offen lds
    v_mfma_f32_16x16x32_bf16 v[148:151], v[64:67], v[84:87], v[148:151]
    ds_read_b64_tr_b16 v[50:51], v10 offset:48512
    v_mfma_f32_16x16x32_bf16 v[152:155], v[64:67], v[88:91], v[152:155]
    v_mfma_f32_16x16x32_bf16 v[156:159], v[68:71], v[72:75], v[156:159]
    v_mfma_f32_16x16x32_bf16 v[160:163], v[68:71], v[76:79], v[160:163]
    s_add_u32 m0, s32, 8192
    s_mov_b32 s36, 83072
    buffer_load_dwordx4 v1, s[8:11], s36 offen lds
    v_mfma_f32_16x16x32_bf16 v[164:167], v[68:71], v[80:83], v[164:167]
    v_mfma_f32_16x16x32_bf16 v[168:171], v[68:71], v[84:87], v[168:171]
    v_mfma_f32_16x16x32_bf16 v[172:175], v[68:71], v[88:91], v[172:175]
    s_waitcnt vmcnt(15) lgkmcnt(0)
    s_barrier
    v_mfma_f32_16x16x32_bf16 v[96:99], v[16:19], v[32:35], v[96:99]
    ds_read_b128 v[56:59], v7 offset:16384
    s_add_u32 s37, s37, s38
    s_add_u32 m0, s33, 135168
    s_nop 0
    buffer_load_dwordx4 v2, s[12:15], s37 offen lds
    v_mfma_f32_16x16x32_bf16 v[100:103], v[16:19], v[36:39], v[100:103]
    ds_read_b128 v[60:63], v7 offset:18432
    s_add_u32 m0, s34, 135168
    s_nop 0
    buffer_load_dwordx4 v3, s[12:15], s37 offen lds
    v_mfma_f32_16x16x32_bf16 v[104:107], v[16:19], v[40:43], v[104:107]
    ds_read_b128 v[64:67], v8 offset:16384
    s_add_u32 m0, s35, 135168
    s_nop 0
    buffer_load_dwordx4 v4, s[12:15], s37 offen lds
    v_mfma_f32_16x16x32_bf16 v[108:111], v[16:19], v[44:47], v[108:111]
    ds_read_b128 v[68:71], v8 offset:18432
    s_and_b32 s27, s21, 1
    s_lshl_b32 s27, s27, 2
    s_add_u32 s27, s27, s23
    v_mfma_f32_16x16x32_bf16 v[112:115], v[16:19], v[48:51], v[112:115]
    ds_read_b64_tr_b16 v[72:73], v9 offset:0
    s_lshl_b32 s27, s27, 8
    s_lshl_b32 s28, s20, 2
    s_add_u32 s27, s27, s28
    v_mfma_f32_16x16x32_bf16 v[116:119], v[20:23], v[32:35], v[116:119]
    ds_read_b64_tr_b16 v[74:75], v9 offset:5376
    s_lshl_b32 s28, s22, 1
    s_add_u32 s27, s27, s28
    s_mul_i32 s27, s27, 2560
    v_mfma_f32_16x16x32_bf16 v[120:123], v[20:23], v[36:39], v[120:123]
    ds_read_b64_tr_b16 v[76:77], v9 offset:32
    s_add_u32 s27, s27, 0
    s_add_u32 s16, s4, s27
    s_addc_u32 s17, s5, 0
    v_mfma_f32_16x16x32_bf16 v[124:127], v[20:23], v[40:43], v[124:127]
    ds_read_b64_tr_b16 v[78:79], v9 offset:5408
    s_mov_b32 s18, 655360
    s_mov_b32 s24, 163520
    v_lshrrev_b32 v222, 4, v0
    v_mfma_f32_16x16x32_bf16 v[128:131], v[20:23], v[44:47], v[128:131]
    ds_read_b64_tr_b16 v[80:81], v9 offset:64
    v_mul_u32_u24 v222, 320, v222
    v_and_b32 v221, 15, v0
    v_add_u32 v223, 0, v221
    v_mfma_f32_16x16x32_bf16 v[132:135], v[20:23], v[48:51], v[132:135]
    ds_read_b64_tr_b16 v[82:83], v9 offset:5440
    v_mul_u32_u24 v216, 3277, v223
    v_lshrrev_b32 v216, 16, v216
    v_mul_u32_u24 v216, s24, v216
    v_mfma_f32_16x16x32_bf16 v[136:139], v[24:27], v[32:35], v[136:139]
    ds_read_b64_tr_b16 v[84:85], v9 offset:96
    v_lshl_add_u32 v223, v223, 4, v222
    v_add_u32 v216, v216, v223
    v_add_u32 v223, 16, v221
    v_mfma_f32_16x16x32_bf16 v[140:143], v[24:27], v[36:39], v[140:143]
    ds_read_b64_tr_b16 v[86:87], v9 offset:5472
    v_mul_u32_u24 v217, 3277, v223
    v_lshrrev_b32 v217, 16, v217
    v_mul_u32_u24 v217, s24, v217
    v_mfma_f32_16x16x32_bf16 v[144:147], v[24:27], v[40:43], v[144:147]
    ds_read_b64_tr_b16 v[88:89], v9 offset:128
    v_lshl_add_u32 v223, v223, 4, v222
    v_add_u32 v217, v217, v223
    v_add_u32 v223, 32, v221
    v_mfma_f32_16x16x32_bf16 v[148:151], v[24:27], v[44:47], v[148:151]
    ds_read_b64_tr_b16 v[90:91], v9 offset:5504
    v_mul_u32_u24 v218, 3277, v223
    v_lshrrev_b32 v218, 16, v218
    v_mul_u32_u24 v218, s24, v218
    v_mfma_f32_16x16x32_bf16 v[152:155], v[24:27], v[48:51], v[152:155]
    v_lshl_add_u32 v223, v223, 4, v222
    v_add_u32 v218, v218, v223
    v_add_u32 v223, 48, v221
    v_mfma_f32_16x16x32_bf16 v[156:159], v[28:31], v[32:35], v[156:159]
    v_mul_u32_u24 v219, 3277, v223
    v_lshrrev_b32 v219, 16, v219
    v_mul_u32_u24 v219, s24, v219
    v_mfma_f32_16x16x32_bf16 v[160:163], v[28:31], v[36:39], v[160:163]
    v_lshl_add_u32 v223, v223, 4, v222
    v_add_u32 v219, v219, v223
    v_add_u32 v223, 64, v221
    v_mfma_f32_16x16x32_bf16 v[164:167], v[28:31], v[40:43], v[164:167]
    v_mul_u32_u24 v220, 3277, v223
    v_lshrrev_b32 v220, 16, v220
    v_mul_u32_u24 v220, s24, v220
    v_mfma_f32_16x16x32_bf16 v[168:171], v[28:31], v[44:47], v[168:171]
    v_lshl_add_u32 v223, v223, 4, v222
    v_add_u32 v220, v220, v223
    v_mfma_f32_16x16x32_bf16 v[172:175], v[28:31], v[48:51], v[172:175]
    s_waitcnt vmcnt(11) lgkmcnt(0)
    s_barrier
    v_mfma_f32_16x16x32_bf16 v[96:99], v[56:59], v[72:75], v[96:99]
    ds_read_b128 v[16:19], v5 offset:32768
    v_mov_b32 v255, 0
    global_load_dword v255, v255, s[6:7] sc1
    v_mfma_f32_16x16x32_bf16 v[100:103], v[56:59], v[76:79], v[100:103]
    ds_read_b128 v[20:23], v5 offset:34816
    v_mfma_f32_16x16x32_bf16 v[104:107], v[56:59], v[80:83], v[104:107]
    ds_read_b128 v[24:27], v6 offset:32768
    v_mfma_f32_16x16x32_bf16 v[108:111], v[56:59], v[84:87], v[108:111]
    ds_read_b128 v[28:31], v6 offset:34816
    v_mfma_f32_16x16x32_bf16 v[112:115], v[56:59], v[88:91], v[112:115]
    ds_read_b64_tr_b16 v[32:33], v9 offset:21504
    v_mfma_f32_16x16x32_bf16 v[116:119], v[60:63], v[72:75], v[116:119]
    ds_read_b64_tr_b16 v[34:35], v9 offset:26880
    v_mfma_f32_16x16x32_bf16 v[120:123], v[60:63], v[76:79], v[120:123]
    ds_read_b64_tr_b16 v[36:37], v9 offset:21536
    v_mfma_f32_16x16x32_bf16 v[124:127], v[60:63], v[80:83], v[124:127]
    ds_read_b64_tr_b16 v[38:39], v9 offset:26912
    v_mfma_f32_16x16x32_bf16 v[128:131], v[60:63], v[84:87], v[128:131]
    ds_read_b64_tr_b16 v[40:41], v9 offset:21568
    v_mfma_f32_16x16x32_bf16 v[132:135], v[60:63], v[88:91], v[132:135]
    ds_read_b64_tr_b16 v[42:43], v9 offset:26944
    v_mfma_f32_16x16x32_bf16 v[136:139], v[64:67], v[72:75], v[136:139]
    ds_read_b64_tr_b16 v[44:45], v9 offset:21600
    v_mfma_f32_16x16x32_bf16 v[140:143], v[64:67], v[76:79], v[140:143]
    ds_read_b64_tr_b16 v[46:47], v9 offset:26976
    v_mfma_f32_16x16x32_bf16 v[144:147], v[64:67], v[80:83], v[144:147]
    ds_read_b64_tr_b16 v[48:49], v9 offset:21632
    v_mfma_f32_16x16x32_bf16 v[148:151], v[64:67], v[84:87], v[148:151]
    ds_read_b64_tr_b16 v[50:51], v9 offset:27008
    v_mfma_f32_16x16x32_bf16 v[152:155], v[64:67], v[88:91], v[152:155]
    v_mfma_f32_16x16x32_bf16 v[156:159], v[68:71], v[72:75], v[156:159]
    v_mfma_f32_16x16x32_bf16 v[160:163], v[68:71], v[76:79], v[160:163]
    v_mfma_f32_16x16x32_bf16 v[164:167], v[68:71], v[80:83], v[164:167]
    v_mfma_f32_16x16x32_bf16 v[168:171], v[68:71], v[84:87], v[168:171]
    v_mfma_f32_16x16x32_bf16 v[172:175], v[68:71], v[88:91], v[172:175]
    s_waitcnt vmcnt(4) lgkmcnt(0)
    s_barrier
    v_mfma_f32_16x16x32_bf16 v[96:99], v[16:19], v[32:35], v[96:99]
    ds_read_b128 v[56:59], v7 offset:32768
    ds_read_b128 v[60:63], v7 offset:34816
    v_mfma_f32_16x16x32_bf16 v[100:103], v[16:19], v[36:39], v[100:103]
    ds_read_b128 v[64:67], v8 offset:32768
    ds_read_b128 v[68:71], v8 offset:34816
    v_mfma_f32_16x16x32_bf16 v[104:107], v[16:19], v[40:43], v[104:107]
    ds_read_b64_tr_b16 v[72:73], v10 offset:0
    ds_read_b64_tr_b16 v[74:75], v10 offset:5376
    v_mfma_f32_16x16x32_bf16 v[108:111], v[16:19], v[44:47], v[108:111]
    ds_read_b64_tr_b16 v[76:77], v10 offset:32
    ds_read_b64_tr_b16 v[78:79], v10 offset:5408
    v_mfma_f32_16x16x32_bf16 v[112:115], v[16:19], v[48:51], v[112:115]
    ds_read_b64_tr_b16 v[80:81], v10 offset:64
    v_mfma_f32_16x16x32_bf16 v[116:119], v[20:23], v[32:35], v[116:119]
    ds_read_b64_tr_b16 v[82:83], v10 offset:5440
    v_mfma_f32_16x16x32_bf16 v[120:123], v[20:23], v[36:39], v[120:123]
    ds_read_b64_tr_b16 v[84:85], v10 offset:96
    v_mfma_f32_16x16x32_bf16 v[124:127], v[20:23], v[40:43], v[124:127]
    ds_read_b64_tr_b16 v[86:87], v10 offset:5472
    v_mfma_f32_16x16x32_bf16 v[128:131], v[20:23], v[44:47], v[128:131]
    ds_read_b64_tr_b16 v[88:89], v10 offset:128
    v_mfma_f32_16x16x32_bf16 v[132:135], v[20:23], v[48:51], v[132:135]
    ds_read_b64_tr_b16 v[90:91], v10 offset:5504
    v_mfma_f32_16x16x32_bf16 v[136:139], v[24:27], v[32:35], v[136:139]
    ds_read_b64_tr_b16 v[192:193], v10 offset:21504
    v_mfma_f32_16x16x32_bf16 v[140:143], v[24:27], v[36:39], v[140:143]
    ds_read_b64_tr_b16 v[194:195], v10 offset:26880
    v_mfma_f32_16x16x32_bf16 v[144:147], v[24:27], v[40:43], v[144:147]
    ds_read_b64_tr_b16 v[196:197], v10 offset:21536
    v_mfma_f32_16x16x32_bf16 v[148:151], v[24:27], v[44:47], v[148:151]
    ds_read_b64_tr_b16 v[198:199], v10 offset:26912
    v_mfma_f32_16x16x32_bf16 v[152:155], v[24:27], v[48:51], v[152:155]
    ds_read_b64_tr_b16 v[200:201], v10 offset:21568
    v_mfma_f32_16x16x32_bf16 v[156:159], v[28:31], v[32:35], v[156:159]
    ds_read_b64_tr_b16 v[202:203], v10 offset:26944
    v_mfma_f32_16x16x32_bf16 v[160:163], v[28:31], v[36:39], v[160:163]
    ds_read_b64_tr_b16 v[204:205], v10 offset:21600
    v_mfma_f32_16x16x32_bf16 v[164:167], v[28:31], v[40:43], v[164:167]
    ds_read_b64_tr_b16 v[206:207], v10 offset:26976
    v_mfma_f32_16x16x32_bf16 v[168:171], v[28:31], v[44:47], v[168:171]
    ds_read_b64_tr_b16 v[208:209], v10 offset:21632
    v_mfma_f32_16x16x32_bf16 v[172:175], v[28:31], v[48:51], v[172:175]
    ds_read_b64_tr_b16 v[210:211], v10 offset:27008
    s_waitcnt vmcnt(1) lgkmcnt(0)
    s_barrier
    v_mfma_f32_16x16x32_bf16 v[96:99], v[56:59], v[72:75], v[96:99]
    ds_read_b128 v[176:179], v5 offset:0
    ds_read_b128 v[180:183], v5 offset:2048
    v_mfma_f32_16x16x32_bf16 v[100:103], v[56:59], v[76:79], v[100:103]
    ds_read_b128 v[16:19], v7 offset:0
    ds_read_b128 v[20:23], v7 offset:2048
    v_mfma_f32_16x16x32_bf16 v[104:107], v[56:59], v[80:83], v[104:107]
    ds_read_b64_tr_b16 v[32:33], v10 offset:43008
    ds_read_b64_tr_b16 v[34:35], v10 offset:48384
    v_mfma_f32_16x16x32_bf16 v[108:111], v[56:59], v[84:87], v[108:111]
    ds_read_b64_tr_b16 v[36:37], v10 offset:43040
    ds_read_b64_tr_b16 v[38:39], v10 offset:48416
    v_mfma_f32_16x16x32_bf16 v[112:115], v[56:59], v[88:91], v[112:115]
    ds_read_b64_tr_b16 v[40:41], v10 offset:43072
    ds_read_b64_tr_b16 v[42:43], v10 offset:48448
    v_mfma_f32_16x16x32_bf16 v[116:119], v[60:63], v[72:75], v[116:119]
    ds_read_b64_tr_b16 v[44:45], v10 offset:43104
    ds_read_b64_tr_b16 v[46:47], v10 offset:48480
    v_mfma_f32_16x16x32_bf16 v[120:123], v[60:63], v[76:79], v[120:123]
    ds_read_b64_tr_b16 v[48:49], v10 offset:43136
    ds_read_b64_tr_b16 v[50:51], v10 offset:48512
    v_mfma_f32_16x16x32_bf16 v[124:127], v[60:63], v[80:83], v[124:127]
    ds_read_b128 v[184:187], v6 offset:0
    ds_read_b128 v[24:27], v8 offset:0
    v_mfma_f32_16x16x32_bf16 v[128:131], v[60:63], v[84:87], v[128:131]
    ds_read_b128 v[188:191], v6 offset:2048
    ds_read_b128 v[28:31], v8 offset:2048
    v_mfma_f32_16x16x32_bf16 v[132:135], v[60:63], v[88:91], v[132:135]
    s_waitcnt lgkmcnt(15)
    v_mfma_f32_16x16x32_bf16 v[96:99], v[176:179], v[192:195], v[96:99]
    v_mfma_f32_16x16x32_bf16 v[116:119], v[180:183], v[192:195], v[116:119]
    s_waitcnt lgkmcnt(12)
    v_mfma_f32_16x16x32_bf16 v[96:99], v[16:19], v[32:35], v[96:99]
    v_mfma_f32_16x16x32_bf16 v[116:119], v[20:23], v[32:35], v[116:119]
    v_mfma_f32_16x16x32_bf16 v[100:103], v[176:179], v[196:199], v[100:103]
    v_mfma_f32_16x16x32_bf16 v[120:123], v[180:183], v[196:199], v[120:123]
    s_waitcnt lgkmcnt(10)
    v_mfma_f32_16x16x32_bf16 v[100:103], v[16:19], v[36:39], v[100:103]
    v_mfma_f32_16x16x32_bf16 v[120:123], v[20:23], v[36:39], v[120:123]
    v_mfma_f32_16x16x32_bf16 v[104:107], v[176:179], v[200:203], v[104:107]
    v_mfma_f32_16x16x32_bf16 v[124:127], v[180:183], v[200:203], v[124:127]
    v_cvt_pk_bf16_f32 v96, v96, v97
    v_cvt_pk_bf16_f32 v97, v98, v99
    s_waitcnt lgkmcnt(8)
    v_mfma_f32_16x16x32_bf16 v[104:107], v[16:19], v[40:43], v[104:107]
    v_cvt_pk_bf16_f32 v98, v116, v117
    v_cvt_pk_bf16_f32 v99, v118, v119
    v_mfma_f32_16x16x32_bf16 v[124:127], v[20:23], v[40:43], v[124:127]
    buffer_store_dwordx4 v[96:99], v216, s[16:19], 0 offen offset:1280 sc1
    v_cvt_pk_bf16_f32 v100, v100, v101
    v_mfma_f32_16x16x32_bf16 v[108:111], v[176:179], v[204:207], v[108:111]
    v_cvt_pk_bf16_f32 v101, v102, v103
    v_cvt_pk_bf16_f32 v102, v120, v121
    v_mfma_f32_16x16x32_bf16 v[128:131], v[180:183], v[204:207], v[128:131]
    v_cvt_pk_bf16_f32 v103, v122, v123
    buffer_store_dwordx4 v[100:103], v217, s[16:19], 0 offen offset:1280 sc1
    s_waitcnt lgkmcnt(6)
    v_mfma_f32_16x16x32_bf16 v[108:111], v[16:19], v[44:47], v[108:111]
    v_cvt_pk_bf16_f32 v104, v104, v105
    v_cvt_pk_bf16_f32 v105, v106, v107
    v_mfma_f32_16x16x32_bf16 v[128:131], v[20:23], v[44:47], v[128:131]
    v_cvt_pk_bf16_f32 v106, v124, v125
    v_cvt_pk_bf16_f32 v107, v126, v127
    v_mfma_f32_16x16x32_bf16 v[112:115], v[176:179], v[208:211], v[112:115]
    buffer_store_dwordx4 v[104:107], v218, s[16:19], 0 offen offset:1280 sc1
    v_mfma_f32_16x16x32_bf16 v[132:135], v[180:183], v[208:211], v[132:135]
    v_cvt_pk_bf16_f32 v108, v108, v109
    v_cvt_pk_bf16_f32 v109, v110, v111
    s_waitcnt lgkmcnt(4)
    v_mfma_f32_16x16x32_bf16 v[112:115], v[16:19], v[48:51], v[112:115]
    v_cvt_pk_bf16_f32 v110, v128, v129
    v_cvt_pk_bf16_f32 v111, v130, v131
    v_mfma_f32_16x16x32_bf16 v[132:135], v[20:23], v[48:51], v[132:135]
    buffer_store_dwordx4 v[108:111], v219, s[16:19], 0 offen offset:1280 sc1
    v_mfma_f32_16x16x32_bf16 v[136:139], v[64:67], v[72:75], v[136:139]
    v_mfma_f32_16x16x32_bf16 v[156:159], v[68:71], v[72:75], v[156:159]
    s_waitcnt lgkmcnt(3)
    v_mfma_f32_16x16x32_bf16 v[136:139], v[184:187], v[192:195], v[136:139]
    v_cvt_pk_bf16_f32 v112, v112, v113
    v_cvt_pk_bf16_f32 v113, v114, v115
    s_waitcnt lgkmcnt(1)
    v_mfma_f32_16x16x32_bf16 v[156:159], v[188:191], v[192:195], v[156:159]
    v_cvt_pk_bf16_f32 v114, v132, v133
    v_cvt_pk_bf16_f32 v115, v134, v135
    v_mfma_f32_16x16x32_bf16 v[136:139], v[24:27], v[32:35], v[136:139]
    buffer_store_dwordx4 v[112:115], v220, s[16:19], 0 offen offset:1280 sc1
    s_waitcnt lgkmcnt(0)
    v_mfma_f32_16x16x32_bf16 v[156:159], v[28:31], v[32:35], v[156:159]
    v_mfma_f32_16x16x32_bf16 v[140:143], v[64:67], v[76:79], v[140:143]
    v_mfma_f32_16x16x32_bf16 v[160:163], v[68:71], v[76:79], v[160:163]
    v_mfma_f32_16x16x32_bf16 v[140:143], v[184:187], v[196:199], v[140:143]
    v_mfma_f32_16x16x32_bf16 v[160:163], v[188:191], v[196:199], v[160:163]
    v_mfma_f32_16x16x32_bf16 v[140:143], v[24:27], v[36:39], v[140:143]
    v_cvt_pk_bf16_f32 v136, v136, v137
    v_cvt_pk_bf16_f32 v137, v138, v139
    v_mfma_f32_16x16x32_bf16 v[160:163], v[28:31], v[36:39], v[160:163]
    v_cvt_pk_bf16_f32 v138, v156, v157
    v_cvt_pk_bf16_f32 v139, v158, v159
    v_mfma_f32_16x16x32_bf16 v[144:147], v[64:67], v[80:83], v[144:147]
    buffer_store_dwordx4 v[136:139], v216, s[16:19], 0 offen offset:3840 sc1
    v_mfma_f32_16x16x32_bf16 v[164:167], v[68:71], v[80:83], v[164:167]
    v_cvt_pk_bf16_f32 v140, v140, v141
    v_cvt_pk_bf16_f32 v141, v142, v143
    v_mfma_f32_16x16x32_bf16 v[144:147], v[184:187], v[200:203], v[144:147]
    v_cvt_pk_bf16_f32 v142, v160, v161
    v_cvt_pk_bf16_f32 v143, v162, v163
    v_mfma_f32_16x16x32_bf16 v[164:167], v[188:191], v[200:203], v[164:167]
    buffer_store_dwordx4 v[140:143], v217, s[16:19], 0 offen offset:3840 sc1
    v_mfma_f32_16x16x32_bf16 v[144:147], v[24:27], v[40:43], v[144:147]
    v_mfma_f32_16x16x32_bf16 v[164:167], v[28:31], v[40:43], v[164:167]
    v_mfma_f32_16x16x32_bf16 v[148:151], v[64:67], v[84:87], v[148:151]
    v_mfma_f32_16x16x32_bf16 v[168:171], v[68:71], v[84:87], v[168:171]
    v_mfma_f32_16x16x32_bf16 v[148:151], v[184:187], v[204:207], v[148:151]
    v_mfma_f32_16x16x32_bf16 v[168:171], v[188:191], v[204:207], v[168:171]
    v_mfma_f32_16x16x32_bf16 v[148:151], v[24:27], v[44:47], v[148:151]
    v_mfma_f32_16x16x32_bf16 v[168:171], v[28:31], v[44:47], v[168:171]
    v_mfma_f32_16x16x32_bf16 v[152:155], v[64:67], v[88:91], v[152:155]
    v_cvt_pk_bf16_f32 v144, v144, v145
    v_cvt_pk_bf16_f32 v145, v146, v147
    v_mfma_f32_16x16x32_bf16 v[172:175], v[68:71], v[88:91], v[172:175]
    v_cvt_pk_bf16_f32 v146, v164, v165
    v_cvt_pk_bf16_f32 v147, v166, v167
    v_mfma_f32_16x16x32_bf16 v[152:155], v[184:187], v[208:211], v[152:155]
    buffer_store_dwordx4 v[144:147], v218, s[16:19], 0 offen offset:3840 sc1
    v_cvt_pk_bf16_f32 v148, v148, v149
    v_mfma_f32_16x16x32_bf16 v[172:175], v[188:191], v[208:211], v[172:175]
    v_cvt_pk_bf16_f32 v149, v150, v151
    v_cvt_pk_bf16_f32 v150, v168, v169
    v_mfma_f32_16x16x32_bf16 v[152:155], v[24:27], v[48:51], v[152:155]
    v_cvt_pk_bf16_f32 v151, v170, v171
    buffer_store_dwordx4 v[148:151], v219, s[16:19], 0 offen offset:3840 sc1
    v_mfma_f32_16x16x32_bf16 v[172:175], v[28:31], v[48:51], v[172:175]
    s_nop 4
    v_cvt_pk_bf16_f32 v152, v152, v153
    v_cvt_pk_bf16_f32 v153, v154, v155
    s_nop 0
    v_cvt_pk_bf16_f32 v154, v172, v173
    v_cvt_pk_bf16_f32 v155, v174, v175
    buffer_store_dwordx4 v[152:155], v220, s[16:19], 0 offen offset:3840 sc1
K_pub:
    s_sub_u32 s24, s21, 9
    s_mul_i32 s24, s24, 20480
    s_mul_i32 s25, s20, 1280
    s_add_u32 s24, s24, s25
    v_mov_b32 v11, s24
    v_mov_b32 v1, 1
    s_waitcnt vmcnt(0)
    v_cmp_ne_u32 vcc, 1, v255
    s_cbranch_vccnz L_ispin_49
L_iback_50:
    s_barrier
    s_cmp_lg_u32 s3, 0
    s_cbranch_scc1 L_noarr_48
    s_mov_b64 exec, 1
    global_store_dword v11, v1, s[100:101] offset:0 sc1
    s_mov_b64 exec, -1
L_noarr_48:
    s_mov_b32 s18, 0
    v_mov_b32 v216, 0x7fff0000
    v_mov_b32 v217, 0x7fff0000
    v_mov_b32 v218, 0x7fff0000
    s_and_b32 s25, s2, 7
    s_lshr_b32 s26, s2, 3
    s_lshl_b32 s21, s25, 2
    s_and_b32 s25, s26, 3
    s_add_u32 s21, s21, s25
    s_lshr_b32 s22, s26, 2
    s_and_b32 s23, s3, 3
    s_lshr_b32 s24, s3, 2
    s_lshl_b32 s30, s22, 2
    s_add_u32 s30, s30, s23
    v_lshlrev_b32 v14, 4, v0
    v_and_b32 v11, 31, v0
    v_lshlrev_b32 v3, 3, v11
    v_lshrrev_b32 v13, 5, v0
    v_mul_u32_u24 v4, 320, v13
    v_lshl_add_u32 v4, v11, 4, v4
    v_lshl_add_u32 v12, v13, 20, v3
    s_mul_i32 s25, s21, 163840
    s_lshl_b32 s26, s21, 5
    s_add_u32 s26, s26, s30
    s_mul_i32 s26, s26, 2560
    s_add_u32 s26, s26, 5242880
    s_mov_b32 s10, 163840
    s_mov_b32 s11, 0x00020000
    s_mov_b32 s14, 2560
    s_mov_b32 s15, 0x00020000
    s_add_u32 s8, s4, s25
    s_addc_u32 s9, s5, 0
    s_add_u32 s12, s4, s26
    s_addc_u32 s13, s5, 0
    s_mul_i32 s25, s24, 81920
    s_lshl_b32 s26, s23, 10
    s_add_u32 s27, s25, s26
    v_add_u32 v2, s25, v14
    v_add_u32 v3, s25, v3
    v_add_u32 v4, s25, v4
    s_mov_b32 s28, 0x000fffff
    s_mov_b32 s29, 0x000fffff
    v_and_b32 v10, 27, v0
    v_cmp_eq_u32 vcc, 24, v10
    v_mov_b32 v10, 0x3f803f80
    s_nop 0
    v_cndmask_b32 v112, 0, v10, vcc
    v_cndmask_b32 v113, 0, v10, vcc
    v_cndmask_b32 v114, 0, v10, vcc
    v_cndmask_b32 v115, 0, v10, vcc
    v_cndmask_b32 v116, 0, v10, vcc
    v_cndmask_b32 v117, 0, v10, vcc
    v_cndmask_b32 v118, 0, v10, vcc
    v_cndmask_b32 v119, 0, v10, vcc
    v_cndmask_b32 v120, 0, v10, vcc
    v_cndmask_b32 v121, 0, v10, vcc
    v_cndmask_b32 v122, 0, v10, vcc
    v_cndmask_b32 v123, 0, v10, vcc
    s_mov_b64 s[44:45], s[0:1]
    s_and_b32 s52, s2, 6
    s_lshl_b32 s52, s52, 2
    s_lshr_b32 s53, s2, 3
    s_and_b32 s48, s53, 7
    s_add_u32 s48, s48, s52
    s_and_b32 s52, s2, 1
    s_lshl_b32 s52, s52, 2
    s_lshr_b32 s49, s53, 3
    s_add_u32 s49, s49, s52
    s_mul_i32 s52, s48, 303104
    s_add_u32 s52, s52, 8388608
    s_add_u32 s36, s4, s52
    s_addc_u32 s37, s5, 0
    s_mov_b32 s38, 303104
    s_mov_b32 s39, 0x00020000
    s_mul_i32 s52, s49, 378880
    s_add_u32 s52, s52, 18874368
    s_add_u32 s40, s4, s52
    s_addc_u32 s41, s5, 0
    s_mov_b32 s42, 378880
    s_mov_b32 s43, 0x00020000
    s_lshr_b32 s52, s3, 2
    s_mul_i32 s52, s52, 81920
    s_and_b32 s53, s3, 3
    s_mul_i32 s54, s53, 15360
    s_add_u32 s54, s54, s52
    s_mul_i32 s55, s53, 5120
    s_add_u32 s55, s55, s52
    s_add_u32 s55, s55, 61440
    v_lshlrev_b32 v14, 4, v0
    v_add_u32 v15, 4096, v14
    s_and_b32 s52, s49, 3
    s_mul_i32 s52, s52, 2
    s_and_b32 s53, s48, 7
    s_mul_i32 s53, s53, 1
    s_add_u32 s52, s52, s53
    s_and_b32 s52, s52, 7
    s_mul_i32 s52, s52, 27
    s_lshr_b32 s52, s52, 2
    s_add_u32 s62, s52, s3
    s_lshr_b32 s25, s21, 4
    s_mul_i32 s25, s25, 4369
    s_add_u32 s25, s25, 4947
    s_lshl_b32 s26, s22, 1
    v_cmp_gt_u32 vcc, 48, v0
    v_lshrrev_b32 v1, 4, v0
    v_lshlrev_b32 v1, 2, v1
    v_bfe_u32 v1, s25, v1, 4
    v_and_b32 v11, 1, v0
    v_add_u32 v11, s26, v11
    v_and_b32 v13, 15, v0
    v_cndmask_b32 v11, v11, v13, vcc
    v_mul_u32_u24 v1, 20480, v1
    v_mul_u32_u24 v11, 1280, v11
    v_add_u32 v1, v1, v11
    s_mov_b32 s34, 65536
    s_cmp_ge_u32 s3, 1
    s_cbranch_scc1 L_qdone_52
L_qspin_51:
    s_sleep 8
    global_load_dword v6, v1, s[100:101] offset:0 sc1
    s_waitcnt vmcnt(0)
    v_cmp_ne_u32 vcc, 1, v6
    s_sub_u32 s34, s34, 1
    s_cbranch_scc1 L_qdone_52
    s_cbranch_vccnz L_qspin_51
L_qdone_52:
    s_barrier
    s_mul_i32 s26, s24, 1280
    s_sub_u32 s25, 1280, s26
    buffer_load_dwordx4 v[88:91], v14, s[12:15], s25 offen sc1
    buffer_load_dwordx2 v[92:93], v12, s[12:15], s25 offen offset:1024 sc1
    s_add_u32 m0, s27, 0
    s_nop 0
    buffer_load_dwordx4 v14, s[8:11], m0 offen sc1 lds
    buffer_load_dwordx4 v[94:97], v14, s[12:15], s26 offen offset:0 sc1
    buffer_load_dwordx2 v[98:99], v12, s[12:15], s26 offen offset:1024 sc1
    s_add_u32 m0, s27, 4096
    s_nop 0
    buffer_load_dwordx4 v14, s[8:11], m0 offen sc1 lds
    s_add_u32 m0, s27, 8192
    s_nop 0
    buffer_load_dwordx4 v14, s[8:11], m0 offen sc1 lds
    s_waitcnt vmcnt(1) lgkmcnt(0)
K_att:
    s_barrier
    ds_read_b128 v[100:103], v2 offset:0
    ds_read_b64 v[104:105], v3 offset:1024
    ds_read_b128 v[106:109], v2 offset:2560
    ds_read_b64 v[110:111], v3 offset:3584
    s_mov_b64 exec, s[28:29]
    ds_read_b128 v[112:115], v4 offset:1280
    ds_read_b128 v[116:119], v4 offset:1920
    s_mov_b64 exec, -1
    s_waitcnt lgkmcnt(4)
    v_mfma_f32_32x32x16_bf16 v[16:31], v[100:103], v[88:91], 0
    v_mfma_f32_32x32x8_bf16 v[16:31], v[104:105], v[92:93], v[16:31]
    s_nop 11
.p2align 3
    s_setprio 3
    s_nop 0
    v_mfma_f32_32x32x16_bf16 v[32:47], v[100:103], v[94:97], 0
    v_exp_f32 v16, v16
    v_exp_f32 v17, v17
    v_exp_f32 v18, v18
    v_exp_f32 v19, v19
    s_add_u32 m0, s27, 12288
    v_cvt_pk_bf16_f32 v80, v16, v17
    buffer_load_dwordx4 v14, s[8:11], m0 offen sc1 lds
    v_mfma_f32_32x32x8_bf16 v[32:47], v[104:105], v[98:99], v[32:47]
    v_exp_f32 v20, v20
    v_exp_f32 v21, v21
    v_cvt_pk_bf16_f32 v81, v18, v19
    v_exp_f32 v22, v22
    v_exp_f32 v23, v23
    v_cvt_pk_bf16_f32 v82, v20, v21
    s_nop 0
    s_nop 0
    v_exp_f32 v24, v24
    v_exp_f32 v25, v25
    v_cvt_pk_bf16_f32 v83, v22, v23
    v_exp_f32_e64 v26, v26
    v_exp_f32 v27, v27
    s_waitcnt lgkmcnt(0)
    s_add_u32 m0, s27, 16384
    v_cvt_pk_bf16_f32 v84, v24, v25
    buffer_load_dwordx4 v14, s[8:11], m0 offen sc1 lds
    v_mfma_f32_32x32x16_bf16 v[48:63], v[112:115], v[80:83], 0
    v_exp_f32 v28, v28
    v_exp_f32 v29, v29
    v_cvt_pk_bf16_f32 v85, v26, v27
    v_exp_f32 v30, v30
    v_exp_f32 v31, v31
    v_cvt_pk_bf16_f32 v86, v28, v29
    v_cvt_pk_bf16_f32 v87, v30, v31
    v_mfma_f32_32x32x16_bf16 v[16:31], v[106:109], v[88:91], 0
    v_exp_f32 v32, v32
    v_exp_f32 v33, v33
    v_exp_f32 v34, v34
    v_exp_f32 v35, v35
    v_cvt_pk_bf16_f32 v80, v32, v33
    v_mfma_f32_32x32x8_bf16 v[16:31], v[110:111], v[92:93], v[16:31]
    v_exp_f32 v36, v36
    v_exp_f32 v37, v37
    v_cvt_pk_bf16_f32 v81, v34, v35
    v_exp_f32 v38, v38
    v_exp_f32 v39, v39
    v_cvt_pk_bf16_f32 v82, v36, v37
    buffer_store_dwordx4 v[192:195], v216, s[16:19], 0 offen offset:0 sc1
    v_mfma_f32_32x32x16_bf16 v[48:63], v[116:119], v[84:87], v[48:63]
    v_exp_f32 v40, v40
    v_exp_f32 v41, v41
    v_cvt_pk_bf16_f32 v83, v38, v39
    v_exp_f32 v42, v42
    v_exp_f32 v43, v43
    v_cvt_pk_bf16_f32 v84, v40, v41
    v_mfma_f32_32x32x16_bf16 v[64:79], v[112:115], v[80:83], 0
    ds_read_b128 v[100:103], v2 offset:5120
    ds_read_b64 v[104:105], v3 offset:6144
    s_mov_b64 exec, s[28:29]
    ds_read_b128 v[112:115], v4 offset:3840
    ds_read_b128 v[120:123], v4 offset:4480
    s_mov_b64 exec, -1
    v_exp_f32 v44, v44
    v_exp_f32 v45, v45
    v_cvt_pk_bf16_f32 v85, v42, v43
    v_exp_f32 v46, v46
    v_exp_f32 v47, v47
    v_cvt_pk_bf16_f32 v86, v44, v45
    v_cvt_pk_bf16_f32 v87, v46, v47
    v_mfma_f32_32x32x16_bf16 v[32:47], v[106:109], v[94:97], 0
    v_exp_f32 v16, v16
    v_exp_f32 v17, v17
    v_exp_f32 v18, v18
    v_exp_f32 v19, v19
    s_add_u32 m0, s27, 20480
    v_cvt_pk_bf16_f32 v80, v16, v17
    buffer_load_dwordx4 v14, s[8:11], m0 offen sc1 lds
    v_mfma_f32_32x32x8_bf16 v[32:47], v[110:111], v[98:99], v[32:47]
    v_exp_f32 v20, v20
    v_exp_f32 v21, v21
    v_cvt_pk_bf16_f32 v81, v18, v19
    v_exp_f32 v22, v22
    v_exp_f32 v23, v23
    v_cvt_pk_bf16_f32 v82, v20, v21
    v_mfma_f32_32x32x16_bf16 v[64:79], v[116:119], v[84:87], v[64:79]
    v_exp_f32 v24, v24
    v_exp_f32 v25, v25
    v_cvt_pk_bf16_f32 v83, v22, v23
    v_exp_f32_e64 v26, v26
    v_exp_f32 v27, v27
    s_waitcnt lgkmcnt(0)
    s_add_u32 m0, s27, 24576
    v_cvt_pk_bf16_f32 v84, v24, v25
    buffer_load_dwordx4 v14, s[8:11], m0 offen sc1 lds
    v_mfma_f32_32x32x16_bf16 v[48:63], v[112:115], v[80:83], v[48:63]
    v_exp_f32 v28, v28
    v_exp_f32 v29, v29
    v_cvt_pk_bf16_f32 v85, v26, v27
    v_exp_f32 v30, v30
    v_exp_f32 v31, v31
    v_cvt_pk_bf16_f32 v86, v28, v29
    v_cvt_pk_bf16_f32 v87, v30, v31
    v_mfma_f32_32x32x16_bf16 v[16:31], v[100:103], v[88:91], 0
    v_exp_f32 v32, v32
    v_exp_f32 v33, v33
    v_exp_f32 v34, v34
    v_exp_f32 v35, v35
    v_cvt_pk_bf16_f32 v80, v32, v33
    v_mfma_f32_32x32x8_bf16 v[16:31], v[104:105], v[92:93], v[16:31]
    v_exp_f32 v36, v36
    v_exp_f32 v37, v37
    v_cvt_pk_bf16_f32 v81, v34, v35
    v_exp_f32 v38, v38
    v_exp_f32 v39, v39
    v_cvt_pk_bf16_f32 v82, v36, v37
    buffer_store_dwordx4 v[196:199], v216, s[16:19], 0 offen offset:1024 sc1
    v_mfma_f32_32x32x16_bf16 v[48:63], v[120:123], v[84:87], v[48:63]
    v_exp_f32 v40, v40
    v_exp_f32 v41, v41
    v_cvt_pk_bf16_f32 v83, v38, v39
    v_exp_f32 v42, v42
    v_exp_f32 v43, v43
    v_cvt_pk_bf16_f32 v84, v40, v41
    v_mfma_f32_32x32x16_bf16 v[64:79], v[112:115], v[80:83], v[64:79]
    s_waitcnt vmcnt(5)
    s_barrier
    ds_read_b128 v[106:109], v2 offset:7680
    ds_read_b64 v[110:111], v3 offset:8704
    s_mov_b64 exec, s[28:29]
    ds_read_b128 v[112:115], v4 offset:6400
    ds_read_b128 v[116:119], v4 offset:7040
    s_mov_b64 exec, -1
    v_exp_f32 v44, v44
    v_exp_f32 v45, v45
    v_cvt_pk_bf16_f32 v85, v42, v43
    v_exp_f32 v46, v46
    v_exp_f32 v47, v47
    v_cvt_pk_bf16_f32 v86, v44, v45
    v_cvt_pk_bf16_f32 v87, v46, v47
    v_mfma_f32_32x32x16_bf16 v[32:47], v[100:103], v[94:97], 0
    v_exp_f32 v16, v16
    v_exp_f32 v17, v17
    v_exp_f32 v18, v18
    v_exp_f32 v19, v19
    s_add_u32 m0, s27, 28672
    v_cvt_pk_bf16_f32 v80, v16, v17
    buffer_load_dwordx4 v14, s[8:11], m0 offen sc1 lds
    v_mfma_f32_32x32x8_bf16 v[32:47], v[104:105], v[98:99], v[32:47]
    v_exp_f32 v20, v20
    v_exp_f32 v21, v21
    v_cvt_pk_bf16_f32 v81, v18, v19
    v_exp_f32 v22, v22
    v_exp_f32 v23, v23
    v_cvt_pk_bf16_f32 v82, v20, v21
    v_mfma_f32_32x32x16_bf16 v[64:79], v[120:123], v[84:87], v[64:79]
    v_exp_f32 v24, v24
    v_exp_f32 v25, v25
    v_cvt_pk_bf16_f32 v83, v22, v23
    v_exp_f32_e64 v26, v26
    v_exp_f32 v27, v27
    s_waitcnt lgkmcnt(0)
    s_add_u32 m0, s27, 32768
    v_cvt_pk_bf16_f32 v84, v24, v25
    buffer_load_dwordx4 v14, s[8:11], m0 offen sc1 lds
    v_mfma_f32_32x32x16_bf16 v[48:63], v[112:115], v[80:83], v[48:63]
    v_exp_f32 v28, v28
    v_exp_f32 v29, v29
    v_cvt_pk_bf16_f32 v85, v26, v27
    v_exp_f32 v30, v30
    v_exp_f32 v31, v31
    v_cvt_pk_bf16_f32 v86, v28, v29
    v_cvt_pk_bf16_f32 v87, v30, v31
    v_mfma_f32_32x32x16_bf16 v[16:31], v[106:109], v[88:91], 0
    v_exp_f32 v32, v32
    v_exp_f32 v33, v33
    v_exp_f32 v34, v34
    v_exp_f32 v35, v35
    v_cvt_pk_bf16_f32 v80, v32, v33
    v_mfma_f32_32x32x8_bf16 v[16:31], v[110:111], v[92:93], v[16:31]
    v_exp_f32 v36, v36
    v_exp_f32 v37, v37
    v_cvt_pk_bf16_f32 v81, v34, v35
    v_exp_f32 v38, v38
    v_exp_f32 v39, v39
    v_cvt_pk_bf16_f32 v82, v36, v37
    buffer_store_dwordx4 v[200:203], v217, s[16:19], 0 offen offset:0 sc1
    v_mfma_f32_32x32x16_bf16 v[48:63], v[116:119], v[84:87], v[48:63]
    v_exp_f32 v40, v40
    v_exp_f32 v41, v41
    v_cvt_pk_bf16_f32 v83, v38, v39
    v_exp_f32 v42, v42
    v_exp_f32 v43, v43
    v_cvt_pk_bf16_f32 v84, v40, v41
    v_mfma_f32_32x32x16_bf16 v[64:79], v[112:115], v[80:83], v[64:79]
    ds_read_b128 v[100:103], v2 offset:10240
    ds_read_b64 v[104:105], v3 offset:11264
    s_mov_b64 exec, s[28:29]
    ds_read_b128 v[112:115], v4 offset:8960
    ds_read_b128 v[120:123], v4 offset:9600
    s_mov_b64 exec, -1
    v_exp_f32 v44, v44
    v_exp_f32 v45, v45
    v_cvt_pk_bf16_f32 v85, v42, v43
    v_exp_f32 v46, v46
    v_exp_f32 v47, v47
    v_cvt_pk_bf16_f32 v86, v44, v45
    v_cvt_pk_bf16_f32 v87, v46, v47
    v_mfma_f32_32x32x16_bf16 v[32:47], v[106:109], v[94:97], 0
    v_exp_f32 v16, v16
    v_exp_f32 v17, v17
    v_exp_f32 v18, v18
    v_exp_f32 v19, v19
    s_add_u32 m0, s27, 36864
    v_cvt_pk_bf16_f32 v80, v16, v17
    buffer_load_dwordx4 v14, s[8:11], m0 offen sc1 lds
    v_mfma_f32_32x32x8_bf16 v[32:47], v[110:111], v[98:99], v[32:47]
    v_exp_f32 v20, v20
    v_exp_f32 v21, v21
    v_cvt_pk_bf16_f32 v81, v18, v19
    v_exp_f32 v22, v22
    v_exp_f32 v23, v23
    v_cvt_pk_bf16_f32 v82, v20, v21
    v_mfma_f32_32x32x16_bf16 v[64:79], v[116:119], v[84:87], v[64:79]
    v_exp_f32 v24, v24
    v_exp_f32 v25, v25
    v_cvt_pk_bf16_f32 v83, v22, v23
    v_exp_f32_e64 v26, v26
    v_exp_f32 v27, v27
    s_waitcnt lgkmcnt(0)
    s_add_u32 m0, s27, 40960
    v_cvt_pk_bf16_f32 v84, v24, v25
    buffer_load_dwordx4 v14, s[8:11], m0 offen sc1 lds
    v_mfma_f32_32x32x16_bf16 v[48:63], v[112:115], v[80:83], v[48:63]
    v_exp_f32 v28, v28
    v_exp_f32 v29, v29
    v_cvt_pk_bf16_f32 v85, v26, v27
    v_exp_f32 v30, v30
    v_exp_f32 v31, v31
    v_cvt_pk_bf16_f32 v86, v28, v29
    v_cvt_pk_bf16_f32 v87, v30, v31
    v_mfma_f32_32x32x16_bf16 v[16:31], v[100:103], v[88:91], 0
    v_exp_f32 v32, v32
    v_exp_f32 v33, v33
    v_exp_f32 v34, v34
    v_exp_f32 v35, v35
    v_cvt_pk_bf16_f32 v80, v32, v33
    v_mfma_f32_32x32x8_bf16 v[16:31], v[104:105], v[92:93], v[16:31]
    v_exp_f32 v36, v36
    v_exp_f32 v37, v37
    v_cvt_pk_bf16_f32 v81, v34, v35
    v_exp_f32 v38, v38
    v_exp_f32 v39, v39
    v_cvt_pk_bf16_f32 v82, v36, v37
    buffer_store_dwordx4 v[204:207], v217, s[16:19], 0 offen offset:1024 sc1
    v_mfma_f32_32x32x16_bf16 v[48:63], v[120:123], v[84:87], v[48:63]
    v_exp_f32 v40, v40
    v_exp_f32 v41, v41
    v_cvt_pk_bf16_f32 v83, v38, v39
    v_exp_f32 v42, v42
    v_exp_f32 v43, v43
    v_cvt_pk_bf16_f32 v84, v40, v41
    v_mfma_f32_32x32x16_bf16 v[64:79], v[112:115], v[80:83], v[64:79]
    ds_read_b128 v[106:109], v2 offset:12800
    ds_read_b64 v[110:111], v3 offset:13824
    s_mov_b64 exec, s[28:29]
    ds_read_b128 v[112:115], v4 offset:11520
    ds_read_b128 v[116:119], v4 offset:12160
    s_mov_b64 exec, -1
    v_exp_f32 v44, v44
    v_exp_f32 v45, v45
    v_cvt_pk_bf16_f32 v85, v42, v43
    v_exp_f32 v46, v46
    v_exp_f32 v47, v47
    v_cvt_pk_bf16_f32 v86, v44, v45
    v_cvt_pk_bf16_f32 v87, v46, v47
    v_mfma_f32_32x32x16_bf16 v[32:47], v[100:103], v[94:97], 0
    v_exp_f32 v16, v16
    v_exp_f32 v17, v17
    v_exp_f32 v18, v18
    v_exp_f32 v19, v19
    s_add_u32 m0, s27, 45056
    v_cvt_pk_bf16_f32 v80, v16, v17
    buffer_load_dwordx4 v14, s[8:11], m0 offen sc1 lds
    v_mfma_f32_32x32x8_bf16 v[32:47], v[104:105], v[98:99], v[32:47]
    v_exp_f32 v20, v20
    v_exp_f32 v21, v21
    v_cvt_pk_bf16_f32 v81, v18, v19
    v_exp_f32 v22, v22
    v_exp_f32 v23, v23
    s_add_u32 m0, s27, 49152
    v_cvt_pk_bf16_f32 v82, v20, v21
    buffer_load_dwordx4 v14, s[8:11], m0 offen sc1 lds
    v_mfma_f32_32x32x16_bf16 v[64:79], v[120:123], v[84:87], v[64:79]
    v_exp_f32 v24, v24
    v_exp_f32 v25, v25
    v_cvt_pk_bf16_f32 v83, v22, v23
    v_exp_f32_e64 v26, v26
    v_exp_f32 v27, v27
    s_waitcnt lgkmcnt(0)
    v_cvt_pk_bf16_f32 v84, v24, v25
    v_mfma_f32_32x32x16_bf16 v[48:63], v[112:115], v[80:83], v[48:63]
    v_exp_f32 v28, v28
    v_exp_f32 v29, v29
    v_cvt_pk_bf16_f32 v85, v26, v27
    v_exp_f32 v30, v30
    v_exp_f32 v31, v31
    v_cvt_pk_bf16_f32 v86, v28, v29
    v_cvt_pk_bf16_f32 v87, v30, v31
    v_mfma_f32_32x32x16_bf16 v[16:31], v[106:109], v[88:91], 0
    v_exp_f32 v32, v32
    v_exp_f32 v33, v33
    v_exp_f32 v34, v34
    v_exp_f32 v35, v35
    v_cvt_pk_bf16_f32 v80, v32, v33
    buffer_store_dwordx4 v[208:211], v218, s[16:19], 0 offen offset:0 sc1
    v_mfma_f32_32x32x8_bf16 v[16:31], v[110:111], v[92:93], v[16:31]
    v_exp_f32 v36, v36
    v_exp_f32 v37, v37
    v_cvt_pk_bf16_f32 v81, v34, v35
    v_exp_f32 v38, v38
    v_exp_f32 v39, v39
    v_cvt_pk_bf16_f32 v82, v36, v37
    buffer_store_dwordx4 v[248:251], v252, s[56:59], 0 offen sc1
    v_mfma_f32_32x32x16_bf16 v[48:63], v[116:119], v[84:87], v[48:63]
    v_exp_f32 v40, v40
    v_exp_f32 v41, v41
    v_cvt_pk_bf16_f32 v83, v38, v39
    v_exp_f32 v42, v42
    v_exp_f32 v43, v43
    v_cvt_pk_bf16_f32 v84, v40, v41
    v_mfma_f32_32x32x16_bf16 v[64:79], v[112:115], v[80:83], v[64:79]
    s_waitcnt vmcnt(11)
    s_barrier
    ds_read_b128 v[100:103], v2 offset:15360
    ds_read_b64 v[104:105], v3 offset:16384
    s_mov_b64 exec, s[28:29]
    ds_read_b128 v[112:115], v4 offset:14080
    ds_read_b128 v[120:123], v4 offset:14720
    s_mov_b64 exec, -1
    v_exp_f32 v44, v44
    v_exp_f32 v45, v45
    v_cvt_pk_bf16_f32 v85, v42, v43
    v_exp_f32 v46, v46
    v_exp_f32 v47, v47
    v_cvt_pk_bf16_f32 v86, v44, v45
    v_cvt_pk_bf16_f32 v87, v46, v47
    v_mfma_f32_32x32x16_bf16 v[32:47], v[106:109], v[94:97], 0
    v_exp_f32 v16, v16
    v_exp_f32 v17, v17
    v_exp_f32 v18, v18
    v_exp_f32 v19, v19
    s_add_u32 m0, s27, 53248
    v_cvt_pk_bf16_f32 v80, v16, v17
    buffer_load_dwordx4 v14, s[8:11], m0 offen sc1 lds
    v_mfma_f32_32x32x8_bf16 v[32:47], v[110:111], v[98:99], v[32:47]
    v_exp_f32 v20, v20
    v_exp_f32 v21, v21
    v_cvt_pk_bf16_f32 v81, v18, v19
    v_exp_f32 v22, v22
    v_exp_f32 v23, v23
    s_add_u32 m0, s27, 57344
    v_cvt_pk_bf16_f32 v82, v20, v21
    buffer_load_dwordx4 v14, s[8:11], m0 offen sc1 lds
    v_mfma_f32_32x32x16_bf16 v[64:79], v[116:119], v[84:87], v[64:79]
    v_exp_f32 v24, v24
    v_exp_f32 v25, v25
    v_cvt_pk_bf16_f32 v83, v22, v23
    v_exp_f32_e64 v26, v26
    v_exp_f32 v27, v27
    s_waitcnt lgkmcnt(0)
    v_cvt_pk_bf16_f32 v84, v24, v25
    v_mfma_f32_32x32x16_bf16 v[48:63], v[112:115], v[80:83], v[48:63]
    v_exp_f32 v28, v28
    v_exp_f32 v29, v29
    v_cvt_pk_bf16_f32 v85, v26, v27
    v_exp_f32 v30, v30
    v_exp_f32 v31, v31
    v_cvt_pk_bf16_f32 v86, v28, v29
    v_cvt_pk_bf16_f32 v87, v30, v31
    v_mfma_f32_32x32x16_bf16 v[16:31], v[100:103], v[88:91], 0
    v_exp_f32 v32, v32
    v_exp_f32 v33, v33
    v_exp_f32 v34, v34
    v_exp_f32 v35, v35
    v_cvt_pk_bf16_f32 v80, v32, v33
    buffer_store_dwordx4 v[212:215], v218, s[16:19], 0 offen offset:2048 sc1
    v_mfma_f32_32x32x8_bf16 v[16:31], v[104:105], v[92:93], v[16:31]
    v_exp_f32 v36, v36
    v_exp_f32 v37, v37
    v_cvt_pk_bf16_f32 v81, v34, v35
    v_exp_f32 v38, v38
    v_exp_f32 v39, v39
    v_cvt_pk_bf16_f32 v82, v36, v37
    buffer_store_dwordx2 v[248:249], v253, s[56:59], 0 offen sc1
    v_mfma_f32_32x32x16_bf16 v[48:63], v[120:123], v[84:87], v[48:63]
    v_exp_f32 v40, v40
    v_exp_f32 v41, v41
    v_cvt_pk_bf16_f32 v83, v38, v39
    v_exp_f32 v42, v42
    v_exp_f32 v43, v43
    v_cvt_pk_bf16_f32 v84, v40, v41
    v_mfma_f32_32x32x16_bf16 v[64:79], v[112:115], v[80:83], v[64:79]
    ds_read_b128 v[106:109], v2 offset:17920
    ds_read_b64 v[110:111], v3 offset:18944
    s_mov_b64 exec, s[28:29]
    ds_read_b128 v[112:115], v4 offset:16640
    ds_read_b128 v[116:119], v4 offset:17280
    s_mov_b64 exec, -1
    v_exp_f32 v44, v44
    v_exp_f32 v45, v45
    v_cvt_pk_bf16_f32 v85, v42, v43
    v_exp_f32 v46, v46
    v_exp_f32 v47, v47
    v_cvt_pk_bf16_f32 v86, v44, v45
    v_cvt_pk_bf16_f32 v87, v46, v47
    v_mfma_f32_32x32x16_bf16 v[32:47], v[100:103], v[94:97], 0
    v_exp_f32 v16, v16
    v_exp_f32 v17, v17
    v_exp_f32 v18, v18
    v_exp_f32 v19, v19
    s_add_u32 m0, s27, 61440
    v_cvt_pk_bf16_f32 v80, v16, v17
    buffer_load_dwordx4 v14, s[8:11], m0 offen sc1 lds
    v_mfma_f32_32x32x8_bf16 v[32:47], v[104:105], v[98:99], v[32:47]
    v_exp_f32 v20, v20
    v_exp_f32 v21, v21
    v_cvt_pk_bf16_f32 v81, v18, v19
    v_exp_f32 v22, v22
    v_exp_f32 v23, v23
    v_cvt_pk_bf16_f32 v82, v20, v21
    v_mfma_f32_32x32x16_bf16 v[64:79], v[120:123], v[84:87], v[64:79]
    v_exp_f32 v24, v24
    v_exp_f32 v25, v25
    v_cvt_pk_bf16_f32 v83, v22, v23
    v_exp_f32_e64 v26, v26
    v_exp_f32 v27, v27
    s_waitcnt lgkmcnt(0)
    v_cvt_pk_bf16_f32 v84, v24, v25
    v_mfma_f32_32x32x16_bf16 v[48:63], v[112:115], v[80:83], v[48:63]
    v_exp_f32 v28, v28
    v_exp_f32 v29, v29
    v_cvt_pk_bf16_f32 v85, v26, v27
    v_exp_f32 v30, v30
    v_exp_f32 v31, v31
    v_cvt_pk_bf16_f32 v86, v28, v29
    v_cvt_pk_bf16_f32 v87, v30, v31
    v_mfma_f32_32x32x16_bf16 v[16:31], v[106:109], v[88:91], 0
    v_exp_f32 v32, v32
    v_exp_f32 v33, v33
    v_exp_f32 v34, v34
    v_exp_f32 v35, v35
    s_add_u32 m0, s27, 65536
    v_cvt_pk_bf16_f32 v80, v32, v33
    buffer_load_dwordx4 v14, s[8:11], m0 offen sc1 lds
    v_mfma_f32_32x32x8_bf16 v[16:31], v[110:111], v[92:93], v[16:31]
    v_exp_f32 v36, v36
    v_exp_f32 v37, v37
    v_cvt_pk_bf16_f32 v81, v34, v35
    v_exp_f32 v38, v38
    v_exp_f32 v39, v39
    v_cvt_pk_bf16_f32 v82, v36, v37
    v_mfma_f32_32x32x16_bf16 v[48:63], v[116:119], v[84:87], v[48:63]
    v_exp_f32 v40, v40
    v_exp_f32 v41, v41
    v_cvt_pk_bf16_f32 v83, v38, v39
    v_exp_f32 v42, v42
    v_exp_f32 v43, v43
    v_cvt_pk_bf16_f32 v84, v40, v41
    v_mfma_f32_32x32x16_bf16 v[64:79], v[112:115], v[80:83], v[64:79]
    ds_read_b128 v[100:103], v2 offset:20480
    ds_read_b64 v[104:105], v3 offset:21504
    s_mov_b64 exec, s[28:29]
    ds_read_b128 v[112:115], v4 offset:19200
    ds_read_b128 v[120:123], v4 offset:19840
    s_mov_b64 exec, -1
    v_exp_f32 v44, v44
    v_exp_f32 v45, v45
    v_cvt_pk_bf16_f32 v85, v42, v43
    v_exp_f32 v46, v46
    v_exp_f32 v47, v47
    v_cvt_pk_bf16_f32 v86, v44, v45
    v_cvt_pk_bf16_f32 v87, v46, v47
    v_mfma_f32_32x32x16_bf16 v[32:47], v[106:109], v[94:97], 0
    v_exp_f32 v16, v16
    v_exp_f32 v17, v17
    v_exp_f32 v18, v18
    v_exp_f32 v19, v19
    s_add_u32 m0, s27, 69632
    v_cvt_pk_bf16_f32 v80, v16, v17
    buffer_load_dwordx4 v14, s[8:11], m0 offen sc1 lds
    v_mfma_f32_32x32x8_bf16 v[32:47], v[110:111], v[98:99], v[32:47]
    v_exp_f32 v20, v20
    v_exp_f32 v21, v21
    v_cvt_pk_bf16_f32 v81, v18, v19
    v_exp_f32 v22, v22
    v_exp_f32 v23, v23
    v_cvt_pk_bf16_f32 v82, v20, v21
    v_mfma_f32_32x32x16_bf16 v[64:79], v[116:119], v[84:87], v[64:79]
    v_exp_f32 v24, v24
    v_exp_f32 v25, v25
    v_cvt_pk_bf16_f32 v83, v22, v23
    v_exp_f32_e64 v26, v26
    v_exp_f32 v27, v27
    s_waitcnt lgkmcnt(0)
    v_cvt_pk_bf16_f32 v84, v24, v25
    v_mfma_f32_32x32x16_bf16 v[48:63], v[112:115], v[80:83], v[48:63]
    v_exp_f32 v28, v28
    v_exp_f32 v29, v29
    v_cvt_pk_bf16_f32 v85, v26, v27
    v_exp_f32 v30, v30
    v_exp_f32 v31, v31
    v_cvt_pk_bf16_f32 v86, v28, v29
    v_cvt_pk_bf16_f32 v87, v30, v31
    v_mfma_f32_32x32x16_bf16 v[16:31], v[100:103], v[88:91], 0
    v_exp_f32 v32, v32
    v_exp_f32 v33, v33
    v_exp_f32 v34, v34
    v_exp_f32 v35, v35
    s_add_u32 m0, s27, 73728
    v_cvt_pk_bf16_f32 v80, v32, v33
    buffer_load_dwordx4 v14, s[8:11], m0 offen sc1 lds
    v_mfma_f32_32x32x8_bf16 v[16:31], v[104:105], v[92:93], v[16:31]
    v_exp_f32 v36, v36
    v_exp_f32 v37, v37
    v_cvt_pk_bf16_f32 v81, v34, v35
    v_exp_f32 v38, v38
    v_exp_f32 v39, v39
    v_cvt_pk_bf16_f32 v82, v36, v37
    v_mfma_f32_32x32x16_bf16 v[48:63], v[120:123], v[84:87], v[48:63]
    v_exp_f32 v40, v40
    v_exp_f32 v41, v41
    v_cvt_pk_bf16_f32 v83, v38, v39
    v_exp_f32 v42, v42
    v_exp_f32 v43, v43
    v_cvt_pk_bf16_f32 v84, v40, v41
    v_mfma_f32_32x32x16_bf16 v[64:79], v[112:115], v[80:83], v[64:79]
    ds_read_b128 v[106:109], v2 offset:23040
    ds_read_b64 v[110:111], v3 offset:24064
    s_mov_b64 exec, s[28:29]
    ds_read_b128 v[112:115], v4 offset:21760
    ds_read_b128 v[116:119], v4 offset:22400
    s_mov_b64 exec, -1
    v_exp_f32 v44, v44
    v_exp_f32 v45, v45
    v_cvt_pk_bf16_f32 v85, v42, v43
    v_exp_f32 v46, v46
    v_exp_f32 v47, v47
    v_cvt_pk_bf16_f32 v86, v44, v45
    v_cvt_pk_bf16_f32 v87, v46, v47
    v_mfma_f32_32x32x16_bf16 v[32:47], v[100:103], v[94:97], 0
    v_exp_f32 v16, v16
    v_exp_f32 v17, v17
    v_exp_f32 v18, v18
    v_exp_f32 v19, v19
    s_add_u32 m0, s27, 77824
    v_cvt_pk_bf16_f32 v80, v16, v17
    buffer_load_dwordx4 v14, s[8:11], m0 offen sc1 lds
    v_mfma_f32_32x32x8_bf16 v[32:47], v[104:105], v[98:99], v[32:47]
    v_exp_f32 v20, v20
    v_exp_f32 v21, v21
    v_cvt_pk_bf16_f32 v81, v18, v19
    v_exp_f32 v22, v22
    v_exp_f32 v23, v23
    v_cvt_pk_bf16_f32 v82, v20, v21
    v_mfma_f32_32x32x16_bf16 v[64:79], v[120:123], v[84:87], v[64:79]
    v_exp_f32 v24, v24
    v_exp_f32 v25, v25
    v_cvt_pk_bf16_f32 v83, v22, v23
    v_exp_f32_e64 v26, v26
    v_exp_f32 v27, v27
    s_waitcnt lgkmcnt(0)
    v_cvt_pk_bf16_f32 v84, v24, v25
    v_mfma_f32_32x32x16_bf16 v[48:63], v[112:115], v[80:83], v[48:63]
    v_exp_f32 v28, v28
    v_exp_f32 v29, v29
    v_cvt_pk_bf16_f32 v85, v26, v27
    v_exp_f32 v30, v30
    v_exp_f32 v31, v31
    v_cvt_pk_bf16_f32 v86, v28, v29
    v_cvt_pk_bf16_f32 v87, v30, v31
    v_mfma_f32_32x32x16_bf16 v[16:31], v[106:109], v[88:91], 0
    v_exp_f32 v32, v32
    v_exp_f32 v33, v33
    v_exp_f32 v34, v34
    v_exp_f32 v35, v35
    v_cvt_pk_bf16_f32 v80, v32, v33
    v_and_b32 v5, 15, v0
    v_mul_u32_u24 v5, 1280, v5
    global_load_dword v6, v5, s[100:101] sc1
    v_mfma_f32_32x32x8_bf16 v[16:31], v[110:111], v[92:93], v[16:31]
    v_exp_f32 v36, v36
    v_exp_f32 v37, v37
    v_cvt_pk_bf16_f32 v81, v34, v35
    v_exp_f32 v38, v38
    v_exp_f32 v39, v39
    v_cvt_pk_bf16_f32 v82, v36, v37
    v_mfma_f32_32x32x16_bf16 v[48:63], v[116:119], v[84:87], v[48:63]
    v_exp_f32 v40, v40
    v_exp_f32 v41, v41
    v_cvt_pk_bf16_f32 v83, v38, v39
    v_exp_f32 v42, v42
    v_exp_f32 v43, v43
    v_cvt_pk_bf16_f32 v84, v40, v41
    v_mfma_f32_32x32x16_bf16 v[64:79], v[112:115], v[80:83], v[64:79]
    ds_read_b128 v[100:103], v2 offset:25600
    ds_read_b64 v[104:105], v3 offset:26624
    s_mov_b64 exec, s[28:29]
    ds_read_b128 v[112:115], v4 offset:24320
    ds_read_b128 v[120:123], v4 offset:24960
    s_mov_b64 exec, -1
    v_exp_f32 v44, v44
    v_exp_f32 v45, v45
    v_cvt_pk_bf16_f32 v85, v42, v43
    v_exp_f32 v46, v46
    v_exp_f32 v47, v47
    v_cvt_pk_bf16_f32 v86, v44, v45
    v_cvt_pk_bf16_f32 v87, v46, v47
    v_mfma_f32_32x32x16_bf16 v[32:47], v[106:109], v[94:97], 0
    v_exp_f32 v16, v16
    v_exp_f32 v17, v17
    v_exp_f32 v18, v18
    v_exp_f32 v19, v19
    v_cvt_pk_bf16_f32 v80, v16, v17
    v_mfma_f32_32x32x8_bf16 v[32:47], v[110:111], v[98:99], v[32:47]
    v_exp_f32 v20, v20
    v_exp_f32 v21, v21
    v_cvt_pk_bf16_f32 v81, v18, v19
    v_exp_f32 v22, v22
    v_exp_f32 v23, v23
    v_cvt_pk_bf16_f32 v82, v20, v21
    v_mfma_f32_32x32x16_bf16 v[64:79], v[116:119], v[84:87], v[64:79]
    v_exp_f32 v24, v24
    v_exp_f32 v25, v25
    v_cvt_pk_bf16_f32 v83, v22, v23
    v_exp_f32_e64 v26, v26
    v_exp_f32 v27, v27
    s_waitcnt lgkmcnt(0)
    v_cvt_pk_bf16_f32 v84, v24, v25
    v_mfma_f32_32x32x16_bf16 v[48:63], v[112:115], v[80:83], v[48:63]
    v_exp_f32 v28, v28
    v_exp_f32 v29, v29
    v_cvt_pk_bf16_f32 v85, v26, v27
    v_exp_f32 v30, v30
    v_exp_f32 v31, v31
    v_cvt_pk_bf16_f32 v86, v28, v29
    v_cvt_pk_bf16_f32 v87, v30, v31
    v_mfma_f32_32x32x16_bf16 v[16:31], v[100:103], v[88:91], 0
    v_exp_f32 v32, v32
    v_exp_f32 v33, v33
    v_exp_f32 v34, v34
    v_exp_f32 v35, v35
    v_cvt_pk_bf16_f32 v80, v32, v33
    v_mfma_f32_32x32x8_bf16 v[16:31], v[104:105], v[92:93], v[16:31]
    v_exp_f32 v36, v36
    v_exp_f32 v37, v37
    v_cvt_pk_bf16_f32 v81, v34, v35
    v_exp_f32 v38, v38
    v_exp_f32 v39, v39
    v_cvt_pk_bf16_f32 v82, v36, v37
    v_mfma_f32_32x32x16_bf16 v[48:63], v[120:123], v[84:87], v[48:63]
    v_exp_f32 v40, v40
    v_exp_f32 v41, v41
    v_cvt_pk_bf16_f32 v83, v38, v39
    v_exp_f32 v42, v42
    v_exp_f32 v43, v43
    v_cvt_pk_bf16_f32 v84, v40, v41
    v_mfma_f32_32x32x16_bf16 v[64:79], v[112:115], v[80:83], v[64:79]
    s_waitcnt vmcnt(1)
    s_barrier
    s_cmp_lg_u32 s3, 0
    s_cbranch_scc1 L_nodone_53
    s_and_b32 s52, s2, 15
    s_add_u32 s52, s52, 112
    s_mul_i32 s52, s52, 1280
    v_mov_b32 v8, s52
    v_mov_b32 v10, 1
    s_mov_b64 exec, 1
    global_atomic_add v9, v8, v10, s[100:101] sc0 sc1
    s_mov_b64 exec, -1
L_nodone_53:
    ds_read_b128 v[106:109], v2 offset:28160
    ds_read_b64 v[110:111], v3 offset:29184
    s_mov_b64 exec, s[28:29]
    ds_read_b128 v[112:115], v4 offset:26880
    ds_read_b128 v[116:119], v4 offset:27520
    s_mov_b64 exec, -1
    v_exp_f32 v44, v44
    v_exp_f32 v45, v45
    v_cvt_pk_bf16_f32 v85, v42, v43
    v_exp_f32 v46, v46
    v_exp_f32 v47, v47
    v_cvt_pk_bf16_f32 v86, v44, v45
    v_cvt_pk_bf16_f32 v87, v46, v47
    v_mfma_f32_32x32x16_bf16 v[32:47], v[100:103], v[94:97], 0
    v_exp_f32 v16, v16
    v_exp_f32 v17, v17
    v_exp_f32 v18, v18
    v_exp_f32 v19, v19
    v_cvt_pk_bf16_f32 v80, v16, v17
    s_waitcnt vmcnt(0)
    v_cmp_ne_u32 vcc, 1, v6
    s_cbranch_vccnz L_sspin_57
L_sback_58:
    v_mfma_f32_32x32x8_bf16 v[32:47], v[104:105], v[98:99], v[32:47]
    v_exp_f32 v20, v20
    v_exp_f32 v21, v21
    v_cvt_pk_bf16_f32 v81, v18, v19
    v_exp_f32 v22, v22
    v_exp_f32 v23, v23
    v_cvt_pk_bf16_f32 v82, v20, v21
    s_add_u32 s51, s62, 0
    s_sub_u32 s63, s51, 54
    s_min_u32 s51, s51, s63
    s_mul_i32 s51, s51, 5120
    buffer_load_dwordx4 v[144:147], v14, s[40:43], s51 offen offset:0 sc1
    v_mfma_f32_32x32x16_bf16 v[64:79], v[120:123], v[84:87], v[64:79]
    v_exp_f32 v24, v24
    v_exp_f32 v25, v25
    v_cvt_pk_bf16_f32 v83, v22, v23
    v_exp_f32_e64 v26, v26
    v_exp_f32 v27, v27
    s_waitcnt lgkmcnt(0)
    v_cvt_pk_bf16_f32 v84, v24, v25
    v_mfma_f32_32x32x16_bf16 v[48:63], v[112:115], v[80:83], v[48:63]
    v_exp_f32 v28, v28
    v_exp_f32 v29, v29
    v_cvt_pk_bf16_f32 v85, v26, v27
    v_exp_f32 v30, v30
    v_exp_f32 v31, v31
    v_cvt_pk_bf16_f32 v86, v28, v29
    v_cvt_pk_bf16_f32 v87, v30, v31
    v_mfma_f32_32x32x16_bf16 v[16:31], v[106:109], v[88:91], 0
    v_exp_f32 v32, v32
    v_exp_f32 v33, v33
    v_exp_f32 v34, v34
    v_exp_f32 v35, v35
    v_cvt_pk_bf16_f32 v80, v32, v33
    buffer_load_dwordx4 v[148:151], v14, s[40:43], s51 offen offset:1024 sc1
    v_mfma_f32_32x32x8_bf16 v[16:31], v[110:111], v[92:93], v[16:31]
    v_exp_f32 v36, v36
    v_exp_f32 v37, v37
    v_cvt_pk_bf16_f32 v81, v34, v35
    v_exp_f32 v38, v38
    v_exp_f32 v39, v39
    v_cvt_pk_bf16_f32 v82, v36, v37
    buffer_load_dwordx4 v[152:155], v14, s[40:43], s51 offen offset:2048 sc1
    v_mfma_f32_32x32x16_bf16 v[48:63], v[116:119], v[84:87], v[48:63]
    v_exp_f32 v40, v40
    v_exp_f32 v41, v41
    v_cvt_pk_bf16_f32 v83, v38, v39
    v_exp_f32 v42, v42
    v_exp_f32 v43, v43
    v_cvt_pk_bf16_f32 v84, v40, v41
    v_mfma_f32_32x32x16_bf16 v[64:79], v[112:115], v[80:83], v[64:79]
    ds_read_b128 v[100:103], v2 offset:30720
    ds_read_b64 v[104:105], v3 offset:31744
    s_mov_b64 exec, s[28:29]
    ds_read_b128 v[112:115], v4 offset:29440
    ds_read_b128 v[120:123], v4 offset:30080
    s_mov_b64 exec, -1
    v_exp_f32 v44, v44
    v_exp_f32 v45, v45
    v_cvt_pk_bf16_f32 v85, v42, v43
    v_exp_f32 v46, v46
    v_exp_f32 v47, v47
    v_cvt_pk_bf16_f32 v86, v44, v45
    v_cvt_pk_bf16_f32 v87, v46, v47
    v_mfma_f32_32x32x16_bf16 v[32:47], v[106:109], v[94:97], 0
    v_exp_f32 v16, v16
    v_exp_f32 v17, v17
    v_exp_f32 v18, v18
    v_exp_f32 v19, v19
    v_cvt_pk_bf16_f32 v80, v16, v17
    buffer_load_dwordx4 v[156:159], v14, s[40:43], s51 offen offset:3072 sc1
    v_mfma_f32_32x32x8_bf16 v[32:47], v[110:111], v[98:99], v[32:47]
    v_exp_f32 v20, v20
    v_exp_f32 v21, v21
    v_cvt_pk_bf16_f32 v81, v18, v19
    v_exp_f32 v22, v22
    v_exp_f32 v23, v23
    v_cvt_pk_bf16_f32 v82, v20, v21
    v_mfma_f32_32x32x16_bf16 v[64:79], v[116:119], v[84:87], v[64:79]
    v_exp_f32 v24, v24
    v_exp_f32 v25, v25
    v_cvt_pk_bf16_f32 v83, v22, v23
    v_exp_f32_e64 v26, v26
    v_exp_f32 v27, v27
    s_waitcnt lgkmcnt(0)
    v_cvt_pk_bf16_f32 v84, v24, v25
    buffer_load_dwordx4 v[160:163], v15, s[40:43], s51 offen offset:0 sc1
    v_mfma_f32_32x32x16_bf16 v[48:63], v[112:115], v[80:83], v[48:63]
    v_exp_f32 v28, v28
    v_exp_f32 v29, v29
    v_cvt_pk_bf16_f32 v85, v26, v27
    v_exp_f32 v30, v30
    v_exp_f32 v31, v31
    v_cvt_pk_bf16_f32 v86, v28, v29
    v_cvt_pk_bf16_f32 v87, v30, v31
    v_mfma_f32_32x32x16_bf16 v[16:31], v[100:103], v[88:91], 0
    v_exp_f32 v32, v32
    v_exp_f32 v33, v33
    v_exp_f32 v34, v34
    v_exp_f32 v35, v35
    v_cvt_pk_bf16_f32 v80, v32, v33
    v_mfma_f32_32x32x8_bf16 v[16:31], v[104:105], v[92:93], v[16:31]
    v_exp_f32 v36, v36
    v_exp_f32 v37, v37
    v_cvt_pk_bf16_f32 v81, v34, v35
    v_exp_f32 v38, v38
    v_exp_f32 v39, v39
    v_cvt_pk_bf16_f32 v82, v36, v37
    s_add_u32 s51, s62, 8
    s_sub_u32 s63, s51, 54
    s_min_u32 s51, s51, s63
    s_mul_i32 s51, s51, 5120
    buffer_load_dwordx4 v[180:183], v14, s[40:43], s51 offen offset:0 sc1
    v_mfma_f32_32x32x16_bf16 v[48:63], v[120:123], v[84:87], v[48:63]
    v_exp_f32 v40, v40
    v_exp_f32 v41, v41
    v_cvt_pk_bf16_f32 v83, v38, v39
    v_exp_f32 v42, v42
    v_exp_f32 v43, v43
    v_cvt_pk_bf16_f32 v84, v40, v41
    v_mfma_f32_32x32x16_bf16 v[64:79], v[112:115], v[80:83], v[64:79]
    s_cmp_lg_u32 s3, 0
    s_cbranch_scc1 L_nolast_54
    s_mov_b64 exec, 1
    s_waitcnt vmcnt(6)
    v_cmp_eq_u32 vcc, 15, v9
    v_add_u32 v8, 20480, v8
    s_and_b64 exec, exec, vcc
    s_cbranch_execz L_nolast_54
    global_store_dword v8, v10, s[100:101] sc1
L_nolast_54:
    s_mov_b64 exec, -1
    ds_read_b128 v[106:109], v2 offset:33280
    ds_read_b64 v[110:111], v3 offset:34304
    s_mov_b64 exec, s[28:29]
    ds_read_b128 v[112:115], v4 offset:32000
    ds_read_b128 v[116:119], v4 offset:32640
    s_mov_b64 exec, -1
    v_exp_f32 v44, v44
    v_exp_f32 v45, v45
    v_cvt_pk_bf16_f32 v85, v42, v43
    v_exp_f32 v46, v46
    v_exp_f32 v47, v47
    v_cvt_pk_bf16_f32 v86, v44, v45
    v_cvt_pk_bf16_f32 v87, v46, v47
    v_mfma_f32_32x32x16_bf16 v[32:47], v[100:103], v[94:97], 0
    v_exp_f32 v16, v16
    v_exp_f32 v17, v17
    v_exp_f32 v18, v18
    v_exp_f32 v19, v19
    v_cvt_pk_bf16_f32 v80, v16, v17
    buffer_load_dwordx4 v[184:187], v14, s[40:43], s51 offen offset:1024 sc1
    v_mfma_f32_32x32x8_bf16 v[32:47], v[104:105], v[98:99], v[32:47]
    v_exp_f32 v20, v20
    v_exp_f32 v21, v21
    v_cvt_pk_bf16_f32 v81, v18, v19
    v_exp_f32 v22, v22
    v_exp_f32 v23, v23
    v_cvt_pk_bf16_f32 v82, v20, v21
    v_mfma_f32_32x32x16_bf16 v[64:79], v[120:123], v[84:87], v[64:79]
    v_exp_f32 v24, v24
    v_exp_f32 v25, v25
    v_cvt_pk_bf16_f32 v83, v22, v23
    v_exp_f32_e64 v26, v26
    v_exp_f32 v27, v27
    s_waitcnt lgkmcnt(0)
    v_cvt_pk_bf16_f32 v84, v24, v25
    buffer_load_dwordx4 v[188:191], v14, s[40:43], s51 offen offset:2048 sc1
    v_mfma_f32_32x32x16_bf16 v[48:63], v[112:115], v[80:83], v[48:63]
    v_exp_f32 v28, v28
    v_exp_f32 v29, v29
    v_cvt_pk_bf16_f32 v85, v26, v27
    v_exp_f32 v30, v30
    v_exp_f32 v31, v31
    v_cvt_pk_bf16_f32 v86, v28, v29
    v_cvt_pk_bf16_f32 v87, v30, v31
    v_mfma_f32_32x32x16_bf16 v[16:31], v[106:109], v[88:91], 0
    v_exp_f32 v32, v32
    v_exp_f32 v33, v33
    v_exp_f32 v34, v34
    v_exp_f32 v35, v35
    v_cvt_pk_bf16_f32 v80, v32, v33
    v_mfma_f32_32x32x8_bf16 v[16:31], v[110:111], v[92:93], v[16:31]
    v_exp_f32 v36, v36
    v_exp_f32 v37, v37
    v_cvt_pk_bf16_f32 v81, v34, v35
    v_exp_f32 v38, v38
    v_exp_f32 v39, v39
    v_cvt_pk_bf16_f32 v82, v36, v37
    buffer_load_dwordx4 v[192:195], v14, s[40:43], s51 offen offset:3072 sc1
    v_mfma_f32_32x32x16_bf16 v[48:63], v[116:119], v[84:87], v[48:63]
    v_exp_f32 v40, v40
    v_exp_f32 v41, v41
    v_cvt_pk_bf16_f32 v83, v38, v39
    v_exp_f32 v42, v42
    v_exp_f32 v43, v43
    v_cvt_pk_bf16_f32 v84, v40, v41
    v_mfma_f32_32x32x16_bf16 v[64:79], v[112:115], v[80:83], v[64:79]
    ds_read_b128 v[100:103], v2 offset:35840
    ds_read_b64 v[104:105], v3 offset:36864
    s_mov_b64 exec, s[28:29]
    ds_read_b128 v[112:115], v4 offset:34560
    ds_read_b128 v[120:123], v4 offset:35200
    s_mov_b64 exec, -1
    v_exp_f32 v44, v44
    v_exp_f32 v45, v45
    v_cvt_pk_bf16_f32 v85, v42, v43
    v_exp_f32 v46, v46
    v_exp_f32 v47, v47
    v_cvt_pk_bf16_f32 v86, v44, v45
    v_cvt_pk_bf16_f32 v87, v46, v47
    v_mfma_f32_32x32x16_bf16 v[32:47], v[106:109], v[94:97], 0
    v_exp_f32 v16, v16
    v_exp_f32 v17, v17
    v_exp_f32 v18, v18
    v_exp_f32 v19, v19
    v_cvt_pk_bf16_f32 v80, v16, v17
    v_mov_b32 v8, v252
    v_mov_b32 v9, v253
    v_mfma_f32_32x32x8_bf16 v[32:47], v[110:111], v[98:99], v[32:47]
    v_exp_f32 v20, v20
    v_exp_f32 v21, v21
    v_cvt_pk_bf16_f32 v81, v18, v19
    v_exp_f32 v22, v22
    v_exp_f32 v23, v23
    v_cvt_pk_bf16_f32 v82, v20, v21
    buffer_load_dwordx4 v[196:199], v15, s[40:43], s51 offen offset:0 sc1
    v_mfma_f32_32x32x16_bf16 v[64:79], v[116:119], v[84:87], v[64:79]
    v_exp_f32 v24, v24
    v_exp_f32 v25, v25
    v_cvt_pk_bf16_f32 v83, v22, v23
    v_exp_f32_e64 v26, v26
    v_exp_f32 v27, v27
    s_waitcnt lgkmcnt(0)
    v_cvt_pk_bf16_f32 v84, v24, v25
    v_mfma_f32_32x32x16_bf16 v[48:63], v[112:115], v[80:83], v[48:63]
    v_exp_f32 v28, v28
    v_exp_f32 v29, v29
    v_cvt_pk_bf16_f32 v85, v26, v27
    v_exp_f32 v30, v30
    v_exp_f32 v31, v31
    v_cvt_pk_bf16_f32 v86, v28, v29
    v_cvt_pk_bf16_f32 v87, v30, v31
    v_mfma_f32_32x32x16_bf16 v[16:31], v[100:103], v[88:91], 0
    v_exp_f32 v32, v32
    v_exp_f32 v33, v33
    v_exp_f32 v34, v34
    v_exp_f32 v35, v35
    v_cvt_pk_bf16_f32 v80, v32, v33
    s_add_u32 s51, s62, 16
    s_sub_u32 s63, s51, 54
    s_min_u32 s51, s51, s63
    s_mul_i32 s51, s51, 5120
    buffer_load_dwordx4 v[216:219], v14, s[40:43], s51 offen offset:0 sc1
    v_mfma_f32_32x32x8_bf16 v[16:31], v[104:105], v[92:93], v[16:31]
    v_exp_f32 v36, v36
    v_exp_f32 v37, v37
    v_cvt_pk_bf16_f32 v81, v34, v35
    v_exp_f32 v38, v38
    v_exp_f32 v39, v39
    v_cvt_pk_bf16_f32 v82, v36, v37
    buffer_load_dwordx4 v[220:223], v14, s[40:43], s51 offen offset:1024 sc1
    v_mfma_f32_32x32x16_bf16 v[48:63], v[120:123], v[84:87], v[48:63]
    v_exp_f32 v40, v40
    v_exp_f32 v41, v41
    v_cvt_pk_bf16_f32 v83, v38, v39
    v_exp_f32 v42, v42
    v_exp_f32 v43, v43
    v_cvt_pk_bf16_f32 v84, v40, v41
    v_mfma_f32_32x32x16_bf16 v[64:79], v[112:115], v[80:83], v[64:79]
    ds_read_b128 v[106:109], v2 offset:38400
    ds_read_b64 v[110:111], v3 offset:39424
    s_mov_b64 exec, s[28:29]
    ds_read_b128 v[112:115], v4 offset:37120
    ds_read_b128 v[116:119], v4 offset:37760
    s_mov_b64 exec, -1
    v_exp_f32 v44, v44
    v_exp_f32 v45, v45
    v_cvt_pk_bf16_f32 v85, v42, v43
    v_exp_f32 v46, v46
    v_exp_f32 v47, v47
    v_cvt_pk_bf16_f32 v86, v44, v45
    v_cvt_pk_bf16_f32 v87, v46, v47
    v_mfma_f32_32x32x16_bf16 v[32:47], v[100:103], v[94:97], 0
    v_exp_f32 v16, v16
    v_exp_f32 v17, v17
    v_exp_f32 v18, v18
    v_exp_f32 v19, v19
    v_cvt_pk_bf16_f32 v80, v16, v17
    buffer_load_dwordx4 v[224:227], v14, s[40:43], s51 offen offset:2048 sc1
    v_mfma_f32_32x32x8_bf16 v[32:47], v[104:105], v[98:99], v[32:47]
    v_exp_f32 v20, v20
    v_exp_f32 v21, v21
    v_cvt_pk_bf16_f32 v81, v18, v19
    v_exp_f32 v22, v22
    v_exp_f32 v23, v23
    v_cvt_pk_bf16_f32 v82, v20, v21
    v_mfma_f32_32x32x16_bf16 v[64:79], v[120:123], v[84:87], v[64:79]
    v_exp_f32 v24, v24
    v_exp_f32 v25, v25
    v_cvt_pk_bf16_f32 v83, v22, v23
    v_exp_f32_e64 v26, v26
    v_exp_f32 v27, v27
    s_waitcnt lgkmcnt(0)
    v_cvt_pk_bf16_f32 v84, v24, v25
    buffer_load_dwordx4 v[228:231], v14, s[40:43], s51 offen offset:3072 sc1
    v_mfma_f32_32x32x16_bf16 v[48:63], v[112:115], v[80:83], v[48:63]
    v_exp_f32 v28, v28
    v_exp_f32 v29, v29
    v_cvt_pk_bf16_f32 v85, v26, v27
    v_exp_f32 v30, v30
    v_exp_f32 v31, v31
    v_cvt_pk_bf16_f32 v86, v28, v29
    v_cvt_pk_bf16_f32 v87, v30, v31
    v_mfma_f32_32x32x16_bf16 v[16:31], v[106:109], v[88:91], 0
    v_exp_f32 v32, v32
    v_exp_f32 v33, v33
    v_exp_f32 v34, v34
    v_exp_f32 v35, v35
    v_cvt_pk_bf16_f32 v80, v32, v33
    v_mfma_f32_32x32x8_bf16 v[16:31], v[110:111], v[92:93], v[16:31]
    v_exp_f32 v36, v36
    v_exp_f32 v37, v37
    v_cvt_pk_bf16_f32 v81, v34, v35
    v_exp_f32 v38, v38
    v_exp_f32 v39, v39
    v_cvt_pk_bf16_f32 v82, v36, v37
    buffer_load_dwordx4 v[232:235], v15, s[40:43], s51 offen offset:0 sc1
    v_mfma_f32_32x32x16_bf16 v[48:63], v[116:119], v[84:87], v[48:63]
    v_exp_f32 v40, v40
    v_exp_f32 v41, v41
    v_cvt_pk_bf16_f32 v83, v38, v39
    v_exp_f32 v42, v42
    v_exp_f32 v43, v43
    v_cvt_pk_bf16_f32 v84, v40, v41
    v_mfma_f32_32x32x16_bf16 v[64:79], v[112:115], v[80:83], v[64:79]
    ds_read_b128 v[100:103], v2 offset:40960
    ds_read_b64 v[104:105], v3 offset:41984
    s_mov_b64 exec, s[28:29]
    ds_read_b128 v[112:115], v4 offset:39680
    ds_read_b128 v[120:123], v4 offset:40320
    s_mov_b64 exec, -1
    v_exp_f32 v44, v44
    v_exp_f32 v45, v45
    v_cvt_pk_bf16_f32 v85, v42, v43
    v_exp_f32 v46, v46
    v_exp_f32 v47, v47
    v_cvt_pk_bf16_f32 v86, v44, v45
    v_cvt_pk_bf16_f32 v87, v46, v47
    v_mfma_f32_32x32x16_bf16 v[32:47], v[106:109], v[94:97], 0
    v_exp_f32 v16, v16
    v_exp_f32 v17, v17
    v_exp_f32 v18, v18
    v_exp_f32 v19, v19
    v_cvt_pk_bf16_f32 v80, v16, v17
    v_and_b32 v5, 15, v0
    v_add_u32 v5, 128, v5
    v_mul_u32_u24 v5, 1280, v5
    global_load_dword v6, v5, s[100:101] sc1
    v_mfma_f32_32x32x8_bf16 v[32:47], v[110:111], v[98:99], v[32:47]
    v_exp_f32 v20, v20
    v_exp_f32 v21, v21
    v_cvt_pk_bf16_f32 v81, v18, v19
    v_exp_f32 v22, v22
    v_exp_f32 v23, v23
    v_cvt_pk_bf16_f32 v82, v20, v21
    s_add_u32 s51, s62, 24
    s_sub_u32 s63, s51, 54
    s_min_u32 s51, s51, s63
    s_mul_i32 s51, s51, 5120
    buffer_load_dwordx4 v[236:239], v14, s[40:43], s51 offen offset:0 sc1
    v_mfma_f32_32x32x16_bf16 v[64:79], v[116:119], v[84:87], v[64:79]
    v_exp_f32 v24, v24
    v_exp_f32 v25, v25
    v_cvt_pk_bf16_f32 v83, v22, v23
    v_exp_f32_e64 v26, v26
    v_exp_f32 v27, v27
    s_waitcnt lgkmcnt(0)
    v_cvt_pk_bf16_f32 v84, v24, v25
    v_mfma_f32_32x32x16_bf16 v[48:63], v[112:115], v[80:83], v[48:63]
    v_exp_f32 v28, v28
    v_exp_f32 v29, v29
    v_cvt_pk_bf16_f32 v85, v26, v27
    v_exp_f32 v30, v30
    v_exp_f32 v31, v31
    v_cvt_pk_bf16_f32 v86, v28, v29
    v_cvt_pk_bf16_f32 v87, v30, v31
    v_mfma_f32_32x32x16_bf16 v[16:31], v[100:103], v[88:91], 0
    v_exp_f32 v32, v32
    v_exp_f32 v33, v33
    v_exp_f32 v34, v34
    v_exp_f32 v35, v35
    v_cvt_pk_bf16_f32 v80, v32, v33
    buffer_load_dwordx4 v[240:243], v14, s[40:43], s51 offen offset:1024 sc1
    v_mfma_f32_32x32x8_bf16 v[16:31], v[104:105], v[92:93], v[16:31]
    v_exp_f32 v36, v36
    v_exp_f32 v37, v37
    v_cvt_pk_bf16_f32 v81, v34, v35
    v_exp_f32 v38, v38
    v_exp_f32 v39, v39
    v_cvt_pk_bf16_f32 v82, v36, v37
    buffer_load_dwordx4 v[244:247], v14, s[40:43], s51 offen offset:2048 sc1
    v_mfma_f32_32x32x16_bf16 v[48:63], v[120:123], v[84:87], v[48:63]
    v_exp_f32 v40, v40
    v_exp_f32 v41, v41
    v_cvt_pk_bf16_f32 v83, v38, v39
    v_exp_f32 v42, v42
    v_exp_f32 v43, v43
    v_cvt_pk_bf16_f32 v84, v40, v41
    v_mfma_f32_32x32x16_bf16 v[64:79], v[112:115], v[80:83], v[64:79]
    ds_read_b128 v[106:109], v2 offset:43520
    ds_read_b64 v[110:111], v3 offset:44544
    s_mov_b64 exec, s[28:29]
    ds_read_b128 v[112:115], v4 offset:42240
    ds_read_b128 v[116:119], v4 offset:42880
    s_mov_b64 exec, -1
    v_exp_f32 v44, v44
    v_exp_f32 v45, v45
    v_cvt_pk_bf16_f32 v85, v42, v43
    v_exp_f32 v46, v46
    v_exp_f32 v47, v47
    v_cvt_pk_bf16_f32 v86, v44, v45
    v_cvt_pk_bf16_f32 v87, v46, v47
    v_add_u32 v2, 40960, v2
    v_add_u32 v3, 40960, v3
    v_add_u32 v4, 40960, v4
    v_mfma_f32_32x32x16_bf16 v[32:47], v[100:103], v[94:97], 0
    v_exp_f32 v16, v16
    v_exp_f32 v17, v17
    v_exp_f32 v18, v18
    v_exp_f32 v19, v19
    v_cvt_pk_bf16_f32 v80, v16, v17
    buffer_load_dwordx4 v[248:251], v14, s[40:43], s51 offen offset:3072 sc1
    v_mfma_f32_32x32x8_bf16 v[32:47], v[104:105], v[98:99], v[32:47]
    v_exp_f32 v20, v20
    v_exp_f32 v21, v21
    v_cvt_pk_bf16_f32 v81, v18, v19
    v_exp_f32 v22, v22
    v_exp_f32 v23, v23
    v_cvt_pk_bf16_f32 v82, v20, v21
    v_mfma_f32_32x32x16_bf16 v[64:79], v[120:123], v[84:87], v[64:79]
    v_exp_f32 v24, v24
    v_exp_f32 v25, v25
    v_cvt_pk_bf16_f32 v83, v22, v23
    v_exp_f32_e64 v26, v26
    v_exp_f32 v27, v27
    s_waitcnt lgkmcnt(0)
    v_cvt_pk_bf16_f32 v84, v24, v25
    v_mfma_f32_32x32x16_bf16 v[48:63], v[112:115], v[80:83], v[48:63]
    v_exp_f32 v28, v28
    v_exp_f32 v29, v29
    v_cvt_pk_bf16_f32 v85, v26, v27
    v_exp_f32 v30, v30
    v_exp_f32 v31, v31
    v_cvt_pk_bf16_f32 v86, v28, v29
    v_cvt_pk_bf16_f32 v87, v30, v31
    v_mfma_f32_32x32x16_bf16 v[16:31], v[106:109], v[88:91], 0
    v_exp_f32 v32, v32
    v_exp_f32 v33, v33
    v_exp_f32 v34, v34
    v_exp_f32 v35, v35
    v_cvt_pk_bf16_f32 v80, v32, v33
    buffer_load_dwordx4 v[252:255], v15, s[40:43], s51 offen offset:0 sc1
    v_mfma_f32_32x32x8_bf16 v[16:31], v[110:111], v[92:93], v[16:31]
    v_exp_f32 v36, v36
    v_exp_f32 v37, v37
    v_cvt_pk_bf16_f32 v81, v34, v35
    v_exp_f32 v38, v38
    v_exp_f32 v39, v39
    v_cvt_pk_bf16_f32 v82, v36, v37
    v_mfma_f32_32x32x16_bf16 v[48:63], v[116:119], v[84:87], v[48:63]
    v_exp_f32 v40, v40
    v_exp_f32 v41, v41
    v_cvt_pk_bf16_f32 v83, v38, v39
    v_exp_f32 v42, v42
    v_exp_f32 v43, v43
    v_cvt_pk_bf16_f32 v84, v40, v41
    v_mfma_f32_32x32x16_bf16 v[64:79], v[112:115], v[80:83], v[64:79]
    ds_read_b128 v[100:103], v2 offset:5120
    ds_read_b64 v[104:105], v3 offset:6144
    s_mov_b64 exec, s[28:29]
    ds_read_b128 v[112:115], v4 offset:3840
    ds_read_b128 v[120:123], v4 offset:4480
    s_mov_b64 exec, -1
    v_exp_f32 v44, v44
    v_exp_f32 v45, v45
    v_cvt_pk_bf16_f32 v85, v42, v43
    v_exp_f32 v46, v46
    v_exp_f32 v47, v47
    v_cvt_pk_bf16_f32 v86, v44, v45
    v_cvt_pk_bf16_f32 v87, v46, v47
    v_mfma_f32_32x32x16_bf16 v[32:47], v[106:109], v[94:97], 0
    v_exp_f32 v16, v16
    v_exp_f32 v17, v17
    v_exp_f32 v18, v18
    v_exp_f32 v19, v19
    v_cvt_pk_bf16_f32 v80, v16, v17
    s_waitcnt vmcnt(5)
    v_cmp_ne_u32 vcc, 1, v6
    s_cbranch_vccnz L_pspin_55
L_pback_56:
    v_mfma_f32_32x32x8_bf16 v[32:47], v[110:111], v[98:99], v[32:47]
    v_exp_f32 v20, v20
    v_exp_f32 v21, v21
    v_cvt_pk_bf16_f32 v81, v18, v19
    v_exp_f32 v22, v22
    v_exp_f32 v23, v23
    v_cvt_pk_bf16_f32 v82, v20, v21
    v_mfma_f32_32x32x16_bf16 v[64:79], v[116:119], v[84:87], v[64:79]
    v_exp_f32 v24, v24
    v_exp_f32 v25, v25
    v_cvt_pk_bf16_f32 v83, v22, v23
    v_exp_f32_e64 v26, v26
    v_exp_f32 v27, v27
    s_waitcnt lgkmcnt(0)
    v_cvt_pk_bf16_f32 v84, v24, v25
    v_mfma_f32_32x32x16_bf16 v[48:63], v[112:115], v[80:83], v[48:63]
    v_exp_f32 v28, v28
    v_exp_f32 v29, v29
    v_cvt_pk_bf16_f32 v85, v26, v27
    v_exp_f32 v30, v30
    v_exp_f32 v31, v31
    v_cvt_pk_bf16_f32 v86, v28, v29
    v_cvt_pk_bf16_f32 v87, v30, v31
    v_mfma_f32_32x32x16_bf16 v[16:31], v[100:103], v[88:91], 0
    v_exp_f32 v32, v32
    v_exp_f32 v33, v33
    v_exp_f32 v34, v34
    v_exp_f32 v35, v35
    v_cvt_pk_bf16_f32 v80, v32, v33
    v_mfma_f32_32x32x8_bf16 v[16:31], v[104:105], v[92:93], v[16:31]
    v_exp_f32 v36, v36
    v_exp_f32 v37, v37
    v_cvt_pk_bf16_f32 v81, v34, v35
    v_exp_f32 v38, v38
    v_exp_f32 v39, v39
    v_cvt_pk_bf16_f32 v82, v36, v37
    v_mfma_f32_32x32x16_bf16 v[48:63], v[120:123], v[84:87], v[48:63]
    v_exp_f32 v40, v40
    v_exp_f32 v41, v41
    v_cvt_pk_bf16_f32 v83, v38, v39
    v_exp_f32 v42, v42
    v_exp_f32 v43, v43
    v_cvt_pk_bf16_f32 v84, v40, v41
    v_mfma_f32_32x32x16_bf16 v[64:79], v[112:115], v[80:83], v[64:79]
    ds_read_b128 v[106:109], v2 offset:7680
    ds_read_b64 v[110:111], v3 offset:8704
    s_mov_b64 exec, s[28:29]
    ds_read_b128 v[112:115], v4 offset:6400
    ds_read_b128 v[116:119], v4 offset:7040
    s_mov_b64 exec, -1
    v_exp_f32 v44, v44
    v_exp_f32 v45, v45
    v_cvt_pk_bf16_f32 v85, v42, v43
    v_exp_f32 v46, v46
    v_exp_f32 v47, v47
    v_cvt_pk_bf16_f32 v86, v44, v45
    v_cvt_pk_bf16_f32 v87, v46, v47
    s_setprio 2
    s_nop 0
    v_mfma_f32_32x32x16_bf16 v[32:47], v[100:103], v[94:97], 0
    v_exp_f32 v16, v16
    v_exp_f32 v17, v17
    v_exp_f32 v18, v18
    v_exp_f32 v19, v19
    v_cvt_pk_bf16_f32 v80, v16, v17
    s_add_u32 s50, s62, 0
    s_sub_u32 s63, s50, 54
    s_min_u32 s50, s50, s63
    s_lshl_b32 s50, s50, 12
    buffer_load_dwordx4 v[128:131], v14, s[36:39], s50 offen offset:0 sc1
    v_mfma_f32_32x32x8_bf16 v[32:47], v[104:105], v[98:99], v[32:47]
    v_exp_f32 v20, v20
    v_exp_f32 v21, v21
    v_cvt_pk_bf16_f32 v81, v18, v19
    v_exp_f32 v22, v22
    v_exp_f32 v23, v23
    v_cvt_pk_bf16_f32 v82, v20, v21
    v_mfma_f32_32x32x16_bf16 v[64:79], v[120:123], v[84:87], v[64:79]
    v_exp_f32 v24, v24
    v_exp_f32 v25, v25
    v_cvt_pk_bf16_f32 v83, v22, v23
    v_exp_f32_e64 v26, v26
    v_exp_f32 v27, v27
    s_waitcnt lgkmcnt(0)
    v_cvt_pk_bf16_f32 v84, v24, v25
    v_mfma_f32_32x32x16_bf16 v[48:63], v[112:115], v[80:83], v[48:63]
    v_exp_f32 v28, v28
    v_exp_f32 v29, v29
    v_cvt_pk_bf16_f32 v85, v26, v27
    v_exp_f32 v30, v30
    v_exp_f32 v31, v31
    v_cvt_pk_bf16_f32 v86, v28, v29
    v_cvt_pk_bf16_f32 v87, v30, v31
    v_mfma_f32_32x32x16_bf16 v[16:31], v[106:109], v[88:91], 0
    v_exp_f32 v32, v32
    v_exp_f32 v33, v33
    v_exp_f32 v34, v34
    v_exp_f32 v35, v35
    v_cvt_pk_bf16_f32 v80, v32, v33
    buffer_load_dwordx4 v[132:135], v14, s[36:39], s50 offen offset:1024 sc1
    v_mfma_f32_32x32x8_bf16 v[16:31], v[110:111], v[92:93], v[16:31]
    v_exp_f32 v36, v36
    v_exp_f32 v37, v37
    v_cvt_pk_bf16_f32 v81, v34, v35
    v_exp_f32 v38, v38
    v_exp_f32 v39, v39
    v_cvt_pk_bf16_f32 v82, v36, v37
    v_mfma_f32_32x32x16_bf16 v[48:63], v[116:119], v[84:87], v[48:63]
    v_exp_f32 v40, v40
    v_exp_f32 v41, v41
    v_cvt_pk_bf16_f32 v83, v38, v39
    v_exp_f32 v42, v42
    v_exp_f32 v43, v43
    v_cvt_pk_bf16_f32 v84, v40, v41
    v_mfma_f32_32x32x16_bf16 v[64:79], v[112:115], v[80:83], v[64:79]
    ds_read_b128 v[100:103], v2 offset:10240
    ds_read_b64 v[104:105], v3 offset:11264
    s_mov_b64 exec, s[28:29]
    ds_read_b128 v[112:115], v4 offset:8960
    ds_read_b128 v[120:123], v4 offset:9600
    s_mov_b64 exec, -1
    v_exp_f32 v44, v44
    v_exp_f32 v45, v45
    v_cvt_pk_bf16_f32 v85, v42, v43
    v_exp_f32 v46, v46
    v_exp_f32 v47, v47
    v_cvt_pk_bf16_f32 v86, v44, v45
    v_cvt_pk_bf16_f32 v87, v46, v47
    v_mfma_f32_32x32x16_bf16 v[32:47], v[106:109], v[94:97], 0
    v_exp_f32 v16, v16
    v_exp_f32 v17, v17
    v_exp_f32 v18, v18
    v_exp_f32 v19, v19
    v_cvt_pk_bf16_f32 v80, v16, v17
    buffer_load_dwordx4 v[136:139], v14, s[36:39], s50 offen offset:2048 sc1
    v_mfma_f32_32x32x8_bf16 v[32:47], v[110:111], v[98:99], v[32:47]
    v_exp_f32 v20, v20
    v_exp_f32 v21, v21
    v_cvt_pk_bf16_f32 v81, v18, v19
    v_exp_f32 v22, v22
    v_exp_f32 v23, v23
    v_cvt_pk_bf16_f32 v82, v20, v21
    v_mfma_f32_32x32x16_bf16 v[64:79], v[116:119], v[84:87], v[64:79]
    v_exp_f32 v24, v24
    v_exp_f32 v25, v25
    v_cvt_pk_bf16_f32 v83, v22, v23
    v_exp_f32_e64 v26, v26
    v_exp_f32 v27, v27
    s_waitcnt lgkmcnt(0)
    v_cvt_pk_bf16_f32 v84, v24, v25
    v_mfma_f32_32x32x16_bf16 v[48:63], v[112:115], v[80:83], v[48:63]
    v_exp_f32 v28, v28
    v_exp_f32 v29, v29
    v_cvt_pk_bf16_f32 v85, v26, v27
    v_exp_f32 v30, v30
    v_exp_f32 v31, v31
    v_cvt_pk_bf16_f32 v86, v28, v29
    v_cvt_pk_bf16_f32 v87, v30, v31
    v_mfma_f32_32x32x16_bf16 v[16:31], v[100:103], v[88:91], 0
    v_exp_f32 v32, v32
    v_exp_f32 v33, v33
    v_exp_f32 v34, v34
    v_exp_f32 v35, v35
    v_cvt_pk_bf16_f32 v80, v32, v33
    buffer_load_dwordx4 v[140:143], v14, s[36:39], s50 offen offset:3072 sc1
    v_mfma_f32_32x32x8_bf16 v[16:31], v[104:105], v[92:93], v[16:31]
    v_exp_f32 v36, v36
    v_exp_f32 v37, v37
    v_cvt_pk_bf16_f32 v81, v34, v35
    v_exp_f32 v38, v38
    v_exp_f32 v39, v39
    v_cvt_pk_bf16_f32 v82, v36, v37
    v_mfma_f32_32x32x16_bf16 v[48:63], v[120:123], v[84:87], v[48:63]
    v_exp_f32 v40, v40
    v_exp_f32 v41, v41
    v_cvt_pk_bf16_f32 v83, v38, v39
    v_exp_f32 v42, v42
    v_exp_f32 v43, v43
    v_cvt_pk_bf16_f32 v84, v40, v41
    v_mfma_f32_32x32x16_bf16 v[64:79], v[112:115], v[80:83], v[64:79]
    ds_read_b128 v[106:109], v2 offset:12800
    ds_read_b64 v[110:111], v3 offset:13824
    s_mov_b64 exec, s[28:29]
    ds_read_b128 v[112:115], v4 offset:11520
    ds_read_b128 v[116:119], v4 offset:12160
    s_mov_b64 exec, -1
    v_exp_f32 v44, v44
    v_exp_f32 v45, v45
    v_cvt_pk_bf16_f32 v85, v42, v43
    v_exp_f32 v46, v46
    v_exp_f32 v47, v47
    v_cvt_pk_bf16_f32 v86, v44, v45
    v_cvt_pk_bf16_f32 v87, v46, v47
    v_mfma_f32_32x32x16_bf16 v[32:47], v[100:103], v[94:97], 0
    v_exp_f32 v16, v16
    v_exp_f32 v17, v17
    v_exp_f32 v18, v18
    v_exp_f32 v19, v19
    v_cvt_pk_bf16_f32 v80, v16, v17
    s_add_u32 s50, s62, 8
    s_sub_u32 s63, s50, 54
    s_min_u32 s50, s50, s63
    s_lshl_b32 s50, s50, 12
    buffer_load_dwordx4 v[164:167], v14, s[36:39], s50 offen offset:0 sc1
    v_mfma_f32_32x32x8_bf16 v[32:47], v[104:105], v[98:99], v[32:47]
    v_exp_f32 v20, v20
    v_exp_f32 v21, v21
    v_cvt_pk_bf16_f32 v81, v18, v19
    v_exp_f32 v22, v22
    v_exp_f32 v23, v23
    v_cvt_pk_bf16_f32 v82, v20, v21
    v_mfma_f32_32x32x16_bf16 v[64:79], v[120:123], v[84:87], v[64:79]
    v_exp_f32 v24, v24
    v_exp_f32 v25, v25
    v_cvt_pk_bf16_f32 v83, v22, v23
    v_exp_f32_e64 v26, v26
    v_exp_f32 v27, v27
    s_waitcnt lgkmcnt(0)
    v_cvt_pk_bf16_f32 v84, v24, v25
    v_mfma_f32_32x32x16_bf16 v[48:63], v[112:115], v[80:83], v[48:63]
    v_exp_f32 v28, v28
    v_exp_f32 v29, v29
    v_cvt_pk_bf16_f32 v85, v26, v27
    v_exp_f32 v30, v30
    v_exp_f32 v31, v31
    v_cvt_pk_bf16_f32 v86, v28, v29
    v_cvt_pk_bf16_f32 v87, v30, v31
    v_mfma_f32_32x32x16_bf16 v[16:31], v[106:109], v[88:91], 0
    v_exp_f32 v32, v32
    v_exp_f32 v33, v33
    v_exp_f32 v34, v34
    v_exp_f32 v35, v35
    v_cvt_pk_bf16_f32 v80, v32, v33
    buffer_load_dwordx4 v[168:171], v14, s[36:39], s50 offen offset:1024 sc1
    v_mfma_f32_32x32x8_bf16 v[16:31], v[110:111], v[92:93], v[16:31]
    v_exp_f32 v36, v36
    v_exp_f32 v37, v37
    v_cvt_pk_bf16_f32 v81, v34, v35
    v_exp_f32 v38, v38
    v_exp_f32 v39, v39
    v_cvt_pk_bf16_f32 v82, v36, v37
    v_mfma_f32_32x32x16_bf16 v[48:63], v[116:119], v[84:87], v[48:63]
    v_exp_f32 v40, v40
    v_exp_f32 v41, v41
    v_cvt_pk_bf16_f32 v83, v38, v39
    v_exp_f32 v42, v42
    v_exp_f32 v43, v43
    v_cvt_pk_bf16_f32 v84, v40, v41
    v_mfma_f32_32x32x16_bf16 v[64:79], v[112:115], v[80:83], v[64:79]
    ds_read_b128 v[100:103], v2 offset:15360
    ds_read_b64 v[104:105], v3 offset:16384
    s_mov_b64 exec, s[28:29]
    ds_read_b128 v[112:115], v4 offset:14080
    ds_read_b128 v[120:123], v4 offset:14720
    s_mov_b64 exec, -1
    v_exp_f32 v44, v44
    v_exp_f32 v45, v45
    v_cvt_pk_bf16_f32 v85, v42, v43
    v_exp_f32 v46, v46
    v_exp_f32 v47, v47
    v_cvt_pk_bf16_f32 v86, v44, v45
    v_cvt_pk_bf16_f32 v87, v46, v47
    v_mfma_f32_32x32x16_bf16 v[32:47], v[106:109], v[94:97], 0
    v_exp_f32 v16, v16
    v_exp_f32 v17, v17
    v_exp_f32 v18, v18
    v_exp_f32 v19, v19
    v_cvt_pk_bf16_f32 v80, v16, v17
    buffer_load_dwordx4 v[172:175], v14, s[36:39], s50 offen offset:2048 sc1
    v_mfma_f32_32x32x8_bf16 v[32:47], v[110:111], v[98:99], v[32:47]
    v_exp_f32 v20, v20
    v_exp_f32 v21, v21
    v_cvt_pk_bf16_f32 v81, v18, v19
    v_exp_f32 v22, v22
    v_exp_f32 v23, v23
    v_cvt_pk_bf16_f32 v82, v20, v21
    v_mfma_f32_32x32x16_bf16 v[64:79], v[116:119], v[84:87], v[64:79]
    v_exp_f32 v24, v24
    v_exp_f32 v25, v25
    v_cvt_pk_bf16_f32 v83, v22, v23
    v_exp_f32_e64 v26, v26
    v_exp_f32 v27, v27
    s_waitcnt lgkmcnt(0)
    v_cvt_pk_bf16_f32 v84, v24, v25
    v_mfma_f32_32x32x16_bf16 v[48:63], v[112:115], v[80:83], v[48:63]
    v_exp_f32 v28, v28
    v_exp_f32 v29, v29
    v_cvt_pk_bf16_f32 v85, v26, v27
    v_exp_f32 v30, v30
    v_exp_f32 v31, v31
    v_cvt_pk_bf16_f32 v86, v28, v29
    v_cvt_pk_bf16_f32 v87, v30, v31
    v_mfma_f32_32x32x16_bf16 v[16:31], v[100:103], v[88:91], 0
    v_exp_f32 v32, v32
    v_exp_f32 v33, v33
    v_exp_f32 v34, v34
    v_exp_f32 v35, v35
    v_cvt_pk_bf16_f32 v80, v32, v33
    buffer_load_dwordx4 v[176:179], v14, s[36:39], s50 offen offset:3072 sc1
    v_mfma_f32_32x32x8_bf16 v[16:31], v[104:105], v[92:93], v[16:31]
    v_exp_f32 v36, v36
    v_exp_f32 v37, v37
    v_cvt_pk_bf16_f32 v81, v34, v35
    v_exp_f32 v38, v38
    v_exp_f32 v39, v39
    v_cvt_pk_bf16_f32 v82, v36, v37
    v_mfma_f32_32x32x16_bf16 v[48:63], v[120:123], v[84:87], v[48:63]
    v_exp_f32 v40, v40
    v_exp_f32 v41, v41
    v_cvt_pk_bf16_f32 v83, v38, v39
    v_exp_f32 v42, v42
    v_exp_f32 v43, v43
    v_cvt_pk_bf16_f32 v84, v40, v41
    v_mfma_f32_32x32x16_bf16 v[64:79], v[112:115], v[80:83], v[64:79]
    ds_read_b128 v[106:109], v2 offset:17920
    ds_read_b64 v[110:111], v3 offset:18944
    s_mov_b64 exec, s[28:29]
    ds_read_b128 v[112:115], v4 offset:16640
    ds_read_b128 v[116:119], v4 offset:17280
    s_mov_b64 exec, -1
    v_exp_f32 v44, v44
    v_exp_f32 v45, v45
    v_cvt_pk_bf16_f32 v85, v42, v43
    v_exp_f32 v46, v46
    v_exp_f32 v47, v47
    v_cvt_pk_bf16_f32 v86, v44, v45
    v_cvt_pk_bf16_f32 v87, v46, v47
    v_mfma_f32_32x32x16_bf16 v[32:47], v[100:103], v[94:97], 0
    v_exp_f32 v16, v16
    v_exp_f32 v17, v17
    v_exp_f32 v18, v18
    v_exp_f32 v19, v19
    v_cvt_pk_bf16_f32 v80, v16, v17
    s_add_u32 s50, s62, 16
    s_sub_u32 s63, s50, 54
    s_min_u32 s50, s50, s63
    s_lshl_b32 s50, s50, 12
    buffer_load_dwordx4 v[200:203], v14, s[36:39], s50 offen offset:0 sc1
    v_mfma_f32_32x32x8_bf16 v[32:47], v[104:105], v[98:99], v[32:47]
    v_exp_f32 v20, v20
    v_exp_f32 v21, v21
    v_cvt_pk_bf16_f32 v81, v18, v19
    v_exp_f32 v22, v22
    v_exp_f32 v23, v23
    v_cvt_pk_bf16_f32 v82, v20, v21
    v_mfma_f32_32x32x16_bf16 v[64:79], v[120:123], v[84:87], v[64:79]
    v_exp_f32 v24, v24
    v_exp_f32 v25, v25
    v_cvt_pk_bf16_f32 v83, v22, v23
    v_exp_f32_e64 v26, v26
    v_exp_f32 v27, v27
    s_waitcnt lgkmcnt(0)
    v_cvt_pk_bf16_f32 v84, v24, v25
    v_mfma_f32_32x32x16_bf16 v[48:63], v[112:115], v[80:83], v[48:63]
    v_exp_f32 v28, v28
    v_exp_f32 v29, v29
    v_cvt_pk_bf16_f32 v85, v26, v27
    v_exp_f32 v30, v30
    v_exp_f32 v31, v31
    v_cvt_pk_bf16_f32 v86, v28, v29
    v_cvt_pk_bf16_f32 v87, v30, v31
    v_mfma_f32_32x32x16_bf16 v[16:31], v[106:109], v[88:91], 0
    v_exp_f32 v32, v32
    v_exp_f32 v33, v33
    v_exp_f32 v34, v34
    v_exp_f32 v35, v35
    v_cvt_pk_bf16_f32 v80, v32, v33
    buffer_load_dwordx4 v[204:207], v14, s[36:39], s50 offen offset:1024 sc1
    v_mfma_f32_32x32x8_bf16 v[16:31], v[110:111], v[92:93], v[16:31]
    v_exp_f32 v36, v36
    v_exp_f32 v37, v37
    v_cvt_pk_bf16_f32 v81, v34, v35
    v_exp_f32 v38, v38
    v_exp_f32 v39, v39
    v_cvt_pk_bf16_f32 v82, v36, v37
    v_mfma_f32_32x32x16_bf16 v[48:63], v[116:119], v[84:87], v[48:63]
    v_exp_f32 v40, v40
    v_exp_f32 v41, v41
    v_cvt_pk_bf16_f32 v83, v38, v39
    v_exp_f32 v42, v42
    v_exp_f32 v43, v43
    v_cvt_pk_bf16_f32 v84, v40, v41
    v_mfma_f32_32x32x16_bf16 v[64:79], v[112:115], v[80:83], v[64:79]
    ds_read_b128 v[100:103], v2 offset:20480
    ds_read_b64 v[104:105], v3 offset:21504
    s_mov_b64 exec, s[28:29]
    ds_read_b128 v[112:115], v4 offset:19200
    ds_read_b128 v[120:123], v4 offset:19840
    s_mov_b64 exec, -1
    v_exp_f32 v44, v44
    v_exp_f32 v45, v45
    v_cvt_pk_bf16_f32 v85, v42, v43
    v_exp_f32 v46, v46
    v_exp_f32 v47, v47
    v_cvt_pk_bf16_f32 v86, v44, v45
    v_cvt_pk_bf16_f32 v87, v46, v47
    v_mfma_f32_32x32x16_bf16 v[32:47], v[106:109], v[94:97], 0
    v_exp_f32 v16, v16
    v_exp_f32 v17, v17
    v_exp_f32 v18, v18
    v_exp_f32 v19, v19
    v_cvt_pk_bf16_f32 v80, v16, v17
    buffer_load_dwordx4 v[208:211], v14, s[36:39], s50 offen offset:2048 sc1
    v_mfma_f32_32x32x8_bf16 v[32:47], v[110:111], v[98:99], v[32:47]
    v_exp_f32 v20, v20
    v_exp_f32 v21, v21
    v_cvt_pk_bf16_f32 v81, v18, v19
    v_exp_f32 v22, v22
    v_exp_f32 v23, v23
    v_cvt_pk_bf16_f32 v82, v20, v21
    v_mfma_f32_32x32x16_bf16 v[64:79], v[116:119], v[84:87], v[64:79]
    v_exp_f32 v24, v24
    v_exp_f32 v25, v25
    v_cvt_pk_bf16_f32 v83, v22, v23
    v_exp_f32_e64 v26, v26
    v_exp_f32 v27, v27
    s_waitcnt lgkmcnt(0)
    v_cvt_pk_bf16_f32 v84, v24, v25
    v_mfma_f32_32x32x16_bf16 v[48:63], v[112:115], v[80:83], v[48:63]
    v_exp_f32 v28, v28
    v_exp_f32 v29, v29
    v_cvt_pk_bf16_f32 v85, v26, v27
    v_exp_f32 v30, v30
    v_exp_f32 v31, v31
    v_cvt_pk_bf16_f32 v86, v28, v29
    v_cvt_pk_bf16_f32 v87, v30, v31
    v_mfma_f32_32x32x16_bf16 v[16:31], v[100:103], v[88:91], 0
    v_exp_f32 v32, v32
    v_exp_f32 v33, v33
    v_exp_f32 v34, v34
    v_exp_f32 v35, v35
    v_cvt_pk_bf16_f32 v80, v32, v33
    buffer_load_dwordx4 v[212:215], v14, s[36:39], s50 offen offset:3072 sc1
    v_mfma_f32_32x32x8_bf16 v[16:31], v[104:105], v[92:93], v[16:31]
    v_exp_f32 v36, v36
    v_exp_f32 v37, v37
    v_cvt_pk_bf16_f32 v81, v34, v35
    v_exp_f32 v38, v38
    v_exp_f32 v39, v39
    v_cvt_pk_bf16_f32 v82, v36, v37
    v_mfma_f32_32x32x16_bf16 v[48:63], v[120:123], v[84:87], v[48:63]
    v_exp_f32 v40, v40
    v_exp_f32 v41, v41
    v_cvt_pk_bf16_f32 v83, v38, v39
    v_exp_f32 v42, v42
    v_exp_f32 v43, v43
    v_cvt_pk_bf16_f32 v84, v40, v41
    v_mfma_f32_32x32x16_bf16 v[64:79], v[112:115], v[80:83], v[64:79]
    ds_read_b128 v[106:109], v2 offset:23040
    ds_read_b64 v[110:111], v3 offset:24064
    s_mov_b64 exec, s[28:29]
    ds_read_b128 v[112:115], v4 offset:21760
    ds_read_b128 v[116:119], v4 offset:22400
    s_mov_b64 exec, -1
    v_exp_f32 v44, v44
    v_exp_f32 v45, v45
    v_cvt_pk_bf16_f32 v85, v42, v43
    v_exp_f32 v46, v46
    v_exp_f32 v47, v47
    v_cvt_pk_bf16_f32 v86, v44, v45
    v_cvt_pk_bf16_f32 v87, v46, v47
    v_mfma_f32_32x32x16_bf16 v[32:47], v[100:103], v[94:97], 0
    v_exp_f32 v16, v16
    v_exp_f32 v17, v17
    v_exp_f32 v18, v18
    v_exp_f32 v19, v19
    v_cvt_pk_bf16_f32 v80, v16, v17
    s_lshr_b32 s52, s3, 1
    s_lshl_b32 s52, s52, 3
    s_and_b32 s53, s3, 1
    s_add_u32 s52, s52, s53
    s_lshl_b32 s52, s52, 1
    s_and_b32 s53, s3, 3
    s_lshl_b32 s53, s53, 4
    v_and_b32 v5, 3, v0
    v_cmp_gt_u32 vcc, 2, v5
    v_add_u32 v5, s52, v5
    v_lshrrev_b32 v7, 4, v0
    v_add_u32 v7, s53, v7
    v_cndmask_b32 v7, v7, v5, vcc
    v_and_b32 v5, 12, v0
    v_add_lshl_u32 v7, v7, v5, 2
    s_lshl_b32 s52, s48, 8
    s_add_u32 s52, s52, 23068672
    s_add_u32 s52, s4, s52
    s_addc_u32 s53, s5, 0
    global_load_dword v7, v7, s[52:53] sc1
    v_mfma_f32_32x32x8_bf16 v[32:47], v[104:105], v[98:99], v[32:47]
    v_exp_f32 v20, v20
    v_exp_f32 v21, v21
    v_cvt_pk_bf16_f32 v81, v18, v19
    v_exp_f32 v22, v22
    v_exp_f32 v23, v23
    v_cvt_pk_bf16_f32 v82, v20, v21
    v_mfma_f32_32x32x16_bf16 v[64:79], v[120:123], v[84:87], v[64:79]
    v_exp_f32 v24, v24
    v_exp_f32 v25, v25
    v_cvt_pk_bf16_f32 v83, v22, v23
    v_exp_f32_e64 v26, v26
    v_exp_f32 v27, v27
    s_waitcnt lgkmcnt(0)
    v_cvt_pk_bf16_f32 v84, v24, v25
    v_mfma_f32_32x32x16_bf16 v[48:63], v[112:115], v[80:83], v[48:63]
    v_exp_f32 v28, v28
    v_exp_f32 v29, v29
    v_cvt_pk_bf16_f32 v85, v26, v27
    v_exp_f32 v30, v30
    v_exp_f32 v31, v31
    v_cvt_pk_bf16_f32 v86, v28, v29
    v_cvt_pk_bf16_f32 v87, v30, v31
    v_mfma_f32_32x32x16_bf16 v[16:31], v[106:109], v[88:91], 0
    v_exp_f32 v32, v32
    v_exp_f32 v33, v33
    v_exp_f32 v34, v34
    v_exp_f32 v35, v35
    v_cvt_pk_bf16_f32 v80, v32, v33
    s_lshl_b32 s25, s30, 8
    s_lshl_b32 s26, s24, 7
    s_add_u32 s25, s25, s26
    s_add_u32 s25, s25, 23068672
    s_add_u32 s12, s4, s25
    s_addc_u32 s13, s5, 0
    s_mov_b32 s14, 128
    v_and_b32 v1, 31, v0
    v_lshlrev_b32 v1, 2, v1
    buffer_load_dword v1, v1, s[12:15], 0 offen sc1
    v_mfma_f32_32x32x8_bf16 v[16:31], v[110:111], v[92:93], v[16:31]
    v_exp_f32 v36, v36
    v_exp_f32 v37, v37
    v_cvt_pk_bf16_f32 v81, v34, v35
    v_exp_f32 v38, v38
    v_exp_f32 v39, v39
    v_cvt_pk_bf16_f32 v82, v36, v37
    v_mfma_f32_32x32x16_bf16 v[48:63], v[116:119], v[84:87], v[48:63]
    v_exp_f32 v40, v40
    v_exp_f32 v41, v41
    v_cvt_pk_bf16_f32 v83, v38, v39
    v_exp_f32 v42, v42
    v_exp_f32 v43, v43
    v_cvt_pk_bf16_f32 v84, v40, v41
    v_mfma_f32_32x32x16_bf16 v[64:79], v[112:115], v[80:83], v[64:79]
    ds_read_b128 v[100:103], v2 offset:25600
    ds_read_b64 v[104:105], v3 offset:26624
    s_mov_b64 exec, s[28:29]
    ds_read_b128 v[112:115], v4 offset:24320
    ds_read_b128 v[120:123], v4 offset:24960
    s_mov_b64 exec, -1
    v_exp_f32 v44, v44
    v_exp_f32 v45, v45
    v_cvt_pk_bf16_f32 v85, v42, v43
    v_exp_f32 v46, v46
    v_exp_f32 v47, v47
    v_cvt_pk_bf16_f32 v86, v44, v45
    v_cvt_pk_bf16_f32 v87, v46, v47
    s_setprio 1
    s_nop 0
    v_mfma_f32_32x32x16_bf16 v[32:47], v[106:109], v[94:97], 0
    v_exp_f32 v16, v16
    v_exp_f32 v17, v17
    v_exp_f32 v18, v18
    v_exp_f32 v19, v19
    v_cvt_pk_bf16_f32 v80, v16, v17
    s_add_u32 s50, s62, 32
    s_sub_u32 s63, s50, 54
    s_min_u32 s50, s50, s63
    s_lshl_b32 s50, s50, 12
    buffer_load_dwordx4 v[124:127], v14, s[36:39], s50 offen offset:3072 sc1
    v_mfma_f32_32x32x8_bf16 v[32:47], v[110:111], v[98:99], v[32:47]
    v_exp_f32 v20, v20
    v_exp_f32 v21, v21
    v_cvt_pk_bf16_f32 v81, v18, v19
    v_exp_f32 v22, v22
    v_exp_f32 v23, v23
    v_cvt_pk_bf16_f32 v82, v20, v21
    v_mfma_f32_32x32x16_bf16 v[64:79], v[116:119], v[84:87], v[64:79]
    v_exp_f32 v24, v24
    v_exp_f32 v25, v25
    v_cvt_pk_bf16_f32 v83, v22, v23
    v_exp_f32_e64 v26, v26
    v_exp_f32 v27, v27
    s_waitcnt lgkmcnt(0)
    v_cvt_pk_bf16_f32 v84, v24, v25
    v_mfma_f32_32x32x16_bf16 v[48:63], v[112:115], v[80:83], v[48:63]
    v_exp_f32 v28, v28
    v_exp_f32 v29, v29
    v_cvt_pk_bf16_f32 v85, v26, v27
    v_exp_f32 v30, v30
    v_exp_f32 v31, v31
    v_cvt_pk_bf16_f32 v86, v28, v29
    v_cvt_pk_bf16_f32 v87, v30, v31
    v_mfma_f32_32x32x16_bf16 v[16:31], v[100:103], v[88:91], 0
    v_exp_f32 v32, v32
    v_exp_f32 v33, v33
    v_exp_f32 v34, v34
    v_exp_f32 v35, v35
    v_cvt_pk_bf16_f32 v80, v32, v33
    v_mfma_f32_32x32x8_bf16 v[16:31], v[104:105], v[92:93], v[16:31]
    v_exp_f32 v36, v36
    v_exp_f32 v37, v37
    v_cvt_pk_bf16_f32 v81, v34, v35
    v_exp_f32 v38, v38
    v_exp_f32 v39, v39
    v_cvt_pk_bf16_f32 v82, v36, v37
    v_mfma_f32_32x32x16_bf16 v[48:63], v[120:123], v[84:87], v[48:63]
    v_exp_f32 v40, v40
    v_exp_f32 v41, v41
    v_cvt_pk_bf16_f32 v83, v38, v39
    v_exp_f32 v42, v42
    v_exp_f32 v43, v43
    v_cvt_pk_bf16_f32 v84, v40, v41
    v_mfma_f32_32x32x16_bf16 v[64:79], v[112:115], v[80:83], v[64:79]
    s_barrier
    s_nop 0
    ds_read_b128 v[106:109], v2 offset:28160
    ds_read_b64 v[110:111], v3 offset:29184
    s_mov_b64 exec, s[28:29]
    ds_read_b128 v[112:115], v4 offset:26880
    ds_read_b128 v[116:119], v4 offset:27520
    s_mov_b64 exec, -1
    v_exp_f32 v44, v44
    v_exp_f32 v45, v45
    v_cvt_pk_bf16_f32 v85, v42, v43
    v_exp_f32 v46, v46
    v_exp_f32 v47, v47
    v_cvt_pk_bf16_f32 v86, v44, v45
    v_cvt_pk_bf16_f32 v87, v46, v47
    v_mfma_f32_32x32x16_bf16 v[32:47], v[100:103], v[94:97], 0
    v_exp_f32 v16, v16
    v_exp_f32 v17, v17
    v_exp_f32 v18, v18
    v_exp_f32 v19, v19
    v_cvt_pk_bf16_f32 v80, v16, v17
    s_add_u32 s51, s3, 54
    s_add_u32 m0, s54, 0
    s_mul_i32 s51, s51, 5120
    buffer_load_dwordx4 v14, s[40:43], s51 offen offset:0 sc1 lds
    v_mfma_f32_32x32x8_bf16 v[32:47], v[104:105], v[98:99], v[32:47]
    v_exp_f32 v20, v20
    v_exp_f32 v21, v21
    v_cvt_pk_bf16_f32 v81, v18, v19
    v_exp_f32 v22, v22
    v_exp_f32 v23, v23
    v_cvt_pk_bf16_f32 v82, v20, v21
    v_mfma_f32_32x32x16_bf16 v[64:79], v[120:123], v[84:87], v[64:79]
    v_exp_f32 v24, v24
    v_exp_f32 v25, v25
    v_cvt_pk_bf16_f32 v83, v22, v23
    v_exp_f32_e64 v26, v26
    v_exp_f32 v27, v27
    s_waitcnt lgkmcnt(0)
    v_cvt_pk_bf16_f32 v84, v24, v25
    buffer_load_dwordx4 v14, s[40:43], s51 offen offset:1024 sc1 lds
    v_mfma_f32_32x32x16_bf16 v[48:63], v[112:115], v[80:83], v[48:63]
    v_exp_f32 v28, v28
    v_exp_f32 v29, v29
    v_cvt_pk_bf16_f32 v85, v26, v27
    v_exp_f32 v30, v30
    v_exp_f32 v31, v31
    v_cvt_pk_bf16_f32 v86, v28, v29
    v_cvt_pk_bf16_f32 v87, v30, v31
    v_mfma_f32_32x32x16_bf16 v[16:31], v[106:109], v[88:91], 0
    v_exp_f32 v32, v32
    v_exp_f32 v33, v33
    v_exp_f32 v34, v34
    v_exp_f32 v35, v35
    v_cvt_pk_bf16_f32 v80, v32, v33
    v_mfma_f32_32x32x8_bf16 v[16:31], v[110:111], v[92:93], v[16:31]
    v_exp_f32 v36, v36
    v_exp_f32 v37, v37
    v_cvt_pk_bf16_f32 v81, v34, v35
    v_exp_f32 v38, v38
    v_exp_f32 v39, v39
    v_cvt_pk_bf16_f32 v82, v36, v37
    buffer_load_dwordx4 v14, s[40:43], s51 offen offset:2048 sc1 lds
    v_mfma_f32_32x32x16_bf16 v[48:63], v[116:119], v[84:87], v[48:63]
    v_exp_f32 v40, v40
    v_exp_f32 v41, v41
    v_cvt_pk_bf16_f32 v83, v38, v39
    v_exp_f32 v42, v42
    v_exp_f32 v43, v43
    v_cvt_pk_bf16_f32 v84, v40, v41
    v_mfma_f32_32x32x16_bf16 v[64:79], v[112:115], v[80:83], v[64:79]
    ds_read_b128 v[100:103], v2 offset:30720
    ds_read_b64 v[104:105], v3 offset:31744
    s_mov_b64 exec, s[28:29]
    ds_read_b128 v[112:115], v4 offset:29440
    ds_read_b128 v[120:123], v4 offset:30080
    s_mov_b64 exec, -1
    v_exp_f32 v44, v44
    v_exp_f32 v45, v45
    v_cvt_pk_bf16_f32 v85, v42, v43
    v_exp_f32 v46, v46
    v_exp_f32 v47, v47
    v_cvt_pk_bf16_f32 v86, v44, v45
    v_cvt_pk_bf16_f32 v87, v46, v47
    v_mfma_f32_32x32x16_bf16 v[32:47], v[106:109], v[94:97], 0
    v_exp_f32 v16, v16
    v_exp_f32 v17, v17
    v_exp_f32 v18, v18
    v_exp_f32 v19, v19
    v_cvt_pk_bf16_f32 v80, v16, v17
    buffer_load_dwordx4 v14, s[40:43], s51 offen offset:3072 sc1 lds
    v_mfma_f32_32x32x8_bf16 v[32:47], v[110:111], v[98:99], v[32:47]
    v_exp_f32 v20, v20
    v_exp_f32 v21, v21
    v_cvt_pk_bf16_f32 v81, v18, v19
    v_exp_f32 v22, v22
    v_exp_f32 v23, v23
    v_cvt_pk_bf16_f32 v82, v20, v21
    v_mfma_f32_32x32x16_bf16 v[64:79], v[116:119], v[84:87], v[64:79]
    v_exp_f32 v24, v24
    v_exp_f32 v25, v25
    v_cvt_pk_bf16_f32 v83, v22, v23
    v_exp_f32_e64 v26, v26
    v_exp_f32 v27, v27
    s_waitcnt lgkmcnt(0)
    s_add_u32 m0, s54, 4096
    v_cvt_pk_bf16_f32 v84, v24, v25
    buffer_load_dwordx4 v15, s[40:43], s51 offen offset:0 sc1 lds
    v_mfma_f32_32x32x16_bf16 v[48:63], v[112:115], v[80:83], v[48:63]
    v_exp_f32 v28, v28
    v_exp_f32 v29, v29
    v_cvt_pk_bf16_f32 v85, v26, v27
    v_exp_f32 v30, v30
    v_exp_f32 v31, v31
    v_cvt_pk_bf16_f32 v86, v28, v29
    v_cvt_pk_bf16_f32 v87, v30, v31
    v_mfma_f32_32x32x16_bf16 v[16:31], v[100:103], v[88:91], 0
    v_exp_f32 v32, v32
    v_exp_f32 v33, v33
    v_exp_f32 v34, v34
    v_exp_f32 v35, v35
    v_cvt_pk_bf16_f32 v80, v32, v33
    v_mfma_f32_32x32x8_bf16 v[16:31], v[104:105], v[92:93], v[16:31]
    v_exp_f32 v36, v36
    v_exp_f32 v37, v37
    v_cvt_pk_bf16_f32 v81, v34, v35
    v_exp_f32 v38, v38
    v_exp_f32 v39, v39
    v_cvt_pk_bf16_f32 v82, v36, v37
    s_add_u32 s51, s3, 62
    s_add_u32 m0, s54, 5120
    s_mul_i32 s51, s51, 5120
    buffer_load_dwordx4 v14, s[40:43], s51 offen offset:0 sc1 lds
    v_mfma_f32_32x32x16_bf16 v[48:63], v[120:123], v[84:87], v[48:63]
    v_exp_f32 v40, v40
    v_exp_f32 v41, v41
    v_cvt_pk_bf16_f32 v83, v38, v39
    v_exp_f32 v42, v42
    v_exp_f32 v43, v43
    v_cvt_pk_bf16_f32 v84, v40, v41
    v_mfma_f32_32x32x16_bf16 v[64:79], v[112:115], v[80:83], v[64:79]
    ds_read_b128 v[106:109], v2 offset:33280
    ds_read_b64 v[110:111], v3 offset:34304
    s_mov_b64 exec, s[28:29]
    ds_read_b128 v[112:115], v4 offset:32000
    ds_read_b128 v[116:119], v4 offset:32640
    s_mov_b64 exec, -1
    v_exp_f32 v44, v44
    v_exp_f32 v45, v45
    v_cvt_pk_bf16_f32 v85, v42, v43
    v_exp_f32 v46, v46
    v_exp_f32 v47, v47
    v_cvt_pk_bf16_f32 v86, v44, v45
    v_cvt_pk_bf16_f32 v87, v46, v47
    v_mfma_f32_32x32x16_bf16 v[32:47], v[100:103], v[94:97], 0
    v_exp_f32 v16, v16
    v_exp_f32 v17, v17
    v_exp_f32 v18, v18
    v_exp_f32 v19, v19
    v_cvt_pk_bf16_f32 v80, v16, v17
    buffer_load_dwordx4 v14, s[40:43], s51 offen offset:1024 sc1 lds
    v_mfma_f32_32x32x8_bf16 v[32:47], v[104:105], v[98:99], v[32:47]
    v_exp_f32 v20, v20
    v_exp_f32 v21, v21
    v_cvt_pk_bf16_f32 v81, v18, v19
    v_exp_f32 v22, v22
    v_exp_f32 v23, v23
    v_cvt_pk_bf16_f32 v82, v20, v21
    v_mfma_f32_32x32x16_bf16 v[64:79], v[120:123], v[84:87], v[64:79]
    v_exp_f32 v24, v24
    v_exp_f32 v25, v25
    v_cvt_pk_bf16_f32 v83, v22, v23
    v_exp_f32_e64 v26, v26
    v_exp_f32 v27, v27
    s_waitcnt lgkmcnt(0)
    v_cvt_pk_bf16_f32 v84, v24, v25
    buffer_load_dwordx4 v14, s[40:43], s51 offen offset:2048 sc1 lds
    v_mfma_f32_32x32x16_bf16 v[48:63], v[112:115], v[80:83], v[48:63]
    v_exp_f32 v28, v28
    v_exp_f32 v29, v29
    v_cvt_pk_bf16_f32 v85, v26, v27
    v_exp_f32 v30, v30
    v_exp_f32 v31, v31
    v_cvt_pk_bf16_f32 v86, v28, v29
    v_cvt_pk_bf16_f32 v87, v30, v31
    v_mfma_f32_32x32x16_bf16 v[16:31], v[106:109], v[88:91], 0
    v_exp_f32 v32, v32
    v_exp_f32 v33, v33
    v_exp_f32 v34, v34
    v_exp_f32 v35, v35
    v_cvt_pk_bf16_f32 v80, v32, v33
    v_mfma_f32_32x32x8_bf16 v[16:31], v[110:111], v[92:93], v[16:31]
    v_exp_f32 v36, v36
    v_exp_f32 v37, v37
    v_cvt_pk_bf16_f32 v81, v34, v35
    v_exp_f32 v38, v38
    v_exp_f32 v39, v39
    v_cvt_pk_bf16_f32 v82, v36, v37
    buffer_load_dwordx4 v14, s[40:43], s51 offen offset:3072 sc1 lds
    v_mfma_f32_32x32x16_bf16 v[48:63], v[116:119], v[84:87], v[48:63]
    v_exp_f32 v40, v40
    v_exp_f32 v41, v41
    v_cvt_pk_bf16_f32 v83, v38, v39
    v_exp_f32 v42, v42
    v_exp_f32 v43, v43
    v_cvt_pk_bf16_f32 v84, v40, v41
    v_mfma_f32_32x32x16_bf16 v[64:79], v[112:115], v[80:83], v[64:79]
    ds_read_b128 v[100:103], v2 offset:35840
    ds_read_b64 v[104:105], v3 offset:36864
    s_mov_b64 exec, s[28:29]
    ds_read_b128 v[112:115], v4 offset:34560
    ds_read_b128 v[120:123], v4 offset:35200
    s_mov_b64 exec, -1
    v_exp_f32 v44, v44
    v_exp_f32 v45, v45
    v_cvt_pk_bf16_f32 v85, v42, v43
    v_exp_f32 v46, v46
    v_exp_f32 v47, v47
    v_cvt_pk_bf16_f32 v86, v44, v45
    v_cvt_pk_bf16_f32 v87, v46, v47
    v_mfma_f32_32x32x16_bf16 v[32:47], v[106:109], v[94:97], 0
    v_exp_f32 v16, v16
    v_exp_f32 v17, v17
    v_exp_f32 v18, v18
    v_exp_f32 v19, v19
    s_add_u32 m0, s54, 9216
    v_cvt_pk_bf16_f32 v80, v16, v17
    buffer_load_dwordx4 v15, s[40:43], s51 offen offset:0 sc1 lds
    v_mfma_f32_32x32x8_bf16 v[32:47], v[110:111], v[98:99], v[32:47]
    v_exp_f32 v20, v20
    v_exp_f32 v21, v21
    v_cvt_pk_bf16_f32 v81, v18, v19
    v_exp_f32 v22, v22
    v_exp_f32 v23, v23
    v_cvt_pk_bf16_f32 v82, v20, v21
    v_mfma_f32_32x32x16_bf16 v[64:79], v[116:119], v[84:87], v[64:79]
    v_exp_f32 v24, v24
    v_exp_f32 v25, v25
    v_cvt_pk_bf16_f32 v83, v22, v23
    v_exp_f32_e64 v26, v26
    v_exp_f32 v27, v27
    s_waitcnt lgkmcnt(0)
    v_cvt_pk_bf16_f32 v84, v24, v25
    s_add_u32 s51, s62, 48
    s_sub_u32 s63, s51, 54
    s_min_u32 s51, s51, s63
    s_add_u32 s52, s3, 66
    s_cmp_lt_u32 s3, 4
    s_cselect_b32 s51, s51, s52
    s_add_u32 m0, s54, 10240
    s_mul_i32 s51, s51, 5120
    buffer_load_dwordx4 v14, s[40:43], s51 offen offset:0 sc1 lds
    v_mfma_f32_32x32x16_bf16 v[48:63], v[112:115], v[80:83], v[48:63]
    v_exp_f32 v28, v28
    v_exp_f32 v29, v29
    v_cvt_pk_bf16_f32 v85, v26, v27
    v_exp_f32 v30, v30
    v_exp_f32 v31, v31
    v_cvt_pk_bf16_f32 v86, v28, v29
    v_cvt_pk_bf16_f32 v87, v30, v31
    v_mfma_f32_32x32x16_bf16 v[16:31], v[100:103], v[88:91], 0
    v_exp_f32 v32, v32
    v_exp_f32 v33, v33
    v_exp_f32 v34, v34
    v_exp_f32 v35, v35
    v_cvt_pk_bf16_f32 v80, v32, v33
    v_mfma_f32_32x32x8_bf16 v[16:31], v[104:105], v[92:93], v[16:31]
    v_exp_f32 v36, v36
    v_exp_f32 v37, v37
    v_cvt_pk_bf16_f32 v81, v34, v35
    v_exp_f32 v38, v38
    v_exp_f32 v39, v39
    v_cvt_pk_bf16_f32 v82, v36, v37
    buffer_load_dwordx4 v14, s[40:43], s51 offen offset:1024 sc1 lds
    v_mfma_f32_32x32x16_bf16 v[48:63], v[120:123], v[84:87], v[48:63]
    v_exp_f32 v40, v40
    v_exp_f32 v41, v41
    v_cvt_pk_bf16_f32 v83, v38, v39
    v_exp_f32 v42, v42
    v_exp_f32 v43, v43
    v_cvt_pk_bf16_f32 v84, v40, v41
    v_mfma_f32_32x32x16_bf16 v[64:79], v[112:115], v[80:83], v[64:79]
    ds_read_b128 v[106:109], v2 offset:38400
    ds_read_b64 v[110:111], v3 offset:39424
    s_mov_b64 exec, s[28:29]
    ds_read_b128 v[112:115], v4 offset:37120
    ds_read_b128 v[116:119], v4 offset:37760
    s_mov_b64 exec, -1
    v_exp_f32 v44, v44
    v_exp_f32 v45, v45
    v_cvt_pk_bf16_f32 v85, v42, v43
    v_exp_f32 v46, v46
    v_exp_f32 v47, v47
    v_cvt_pk_bf16_f32 v86, v44, v45
    v_cvt_pk_bf16_f32 v87, v46, v47
    s_setprio 0
    s_nop 0
    v_mfma_f32_32x32x16_bf16 v[32:47], v[100:103], v[94:97], 0
    v_exp_f32 v16, v16
    v_exp_f32 v17, v17
    v_exp_f32 v18, v18
    v_exp_f32 v19, v19
    v_cvt_pk_bf16_f32 v80, v16, v17
    buffer_load_dwordx4 v14, s[40:43], s51 offen offset:2048 sc1 lds
    v_mfma_f32_32x32x8_bf16 v[32:47], v[104:105], v[98:99], v[32:47]
    v_exp_f32 v20, v20
    v_exp_f32 v21, v21
    v_cvt_pk_bf16_f32 v81, v18, v19
    v_exp_f32 v22, v22
    v_exp_f32 v23, v23
    v_cvt_pk_bf16_f32 v82, v20, v21
    buffer_load_dwordx4 v14, s[40:43], s51 offen offset:3072 sc1 lds
    v_mfma_f32_32x32x16_bf16 v[64:79], v[120:123], v[84:87], v[64:79]
    v_exp_f32 v24, v24
    v_exp_f32 v25, v25
    v_cvt_pk_bf16_f32 v83, v22, v23
    v_exp_f32_e64 v26, v26
    v_exp_f32 v27, v27
    s_waitcnt lgkmcnt(0)
    v_cvt_pk_bf16_f32 v84, v24, v25
    v_mfma_f32_32x32x16_bf16 v[48:63], v[112:115], v[80:83], v[48:63]
    v_exp_f32 v28, v28
    v_exp_f32 v29, v29
    v_cvt_pk_bf16_f32 v85, v26, v27
    v_exp_f32 v30, v30
    v_exp_f32 v31, v31
    v_cvt_pk_bf16_f32 v86, v28, v29
    v_cvt_pk_bf16_f32 v87, v30, v31
    v_mfma_f32_32x32x16_bf16 v[16:31], v[106:109], v[88:91], 0
    v_exp_f32 v32, v32
    v_exp_f32 v33, v33
    v_exp_f32 v34, v34
    v_exp_f32 v35, v35
    s_add_u32 m0, s54, 14336
    v_cvt_pk_bf16_f32 v80, v32, v33
    buffer_load_dwordx4 v15, s[40:43], s51 offen offset:0 sc1 lds
    v_mfma_f32_32x32x8_bf16 v[16:31], v[110:111], v[92:93], v[16:31]
    v_exp_f32 v36, v36
    v_exp_f32 v37, v37
    v_cvt_pk_bf16_f32 v81, v34, v35
    v_exp_f32 v38, v38
    v_exp_f32 v39, v39
    v_cvt_pk_bf16_f32 v82, v36, v37
    s_add_u32 s26, s55, 81920
    s_sub_u32 s25, s55, 81920
    s_cmp_eq_u32 s24, 0
    s_cselect_b32 s26, s26, s25
    v_add_u32 v5, s26, v14
    v_add_u32 v6, s55, v14
    v_mfma_f32_32x32x16_bf16 v[48:63], v[116:119], v[84:87], v[48:63]
    v_exp_f32 v40, v40
    v_exp_f32 v41, v41
    v_cvt_pk_bf16_f32 v83, v38, v39
    v_exp_f32 v42, v42
    v_exp_f32 v43, v43
    v_cvt_pk_bf16_f32 v84, v40, v41
    v_mfma_f32_32x32x16_bf16 v[64:79], v[112:115], v[80:83], v[64:79]
    s_mov_b64 exec, s[28:29]
    ds_read_b128 v[112:115], v4 offset:39680
    ds_read_b128 v[120:123], v4 offset:40320
    s_mov_b64 exec, -1
    v_exp_f32 v44, v44
    v_exp_f32 v45, v45
    v_cvt_pk_bf16_f32 v85, v42, v43
    v_exp_f32 v46, v46
    v_exp_f32 v47, v47
    v_cvt_pk_bf16_f32 v86, v44, v45
    v_cvt_pk_bf16_f32 v87, v46, v47
    v_mfma_f32_32x32x16_bf16 v[32:47], v[106:109], v[94:97], 0
    v_exp_f32 v16, v16
    v_exp_f32 v17, v17
    v_exp_f32 v18, v18
    v_exp_f32 v19, v19
    v_cvt_pk_bf16_f32 v80, v16, v17
    v_mfma_f32_32x32x8_bf16 v[32:47], v[110:111], v[98:99], v[32:47]
    v_exp_f32 v20, v20
    v_exp_f32 v21, v21
    v_cvt_pk_bf16_f32 v81, v18, v19
    v_exp_f32 v22, v22
    v_exp_f32 v23, v23
    v_cvt_pk_bf16_f32 v82, v20, v21
    s_add_u32 s50, s62, 24
    s_sub_u32 s63, s50, 54
    s_min_u32 s50, s50, s63
    s_lshl_b32 s50, s50, 12
    s_add_u32 s34, s62, 32
    s_sub_u32 s63, s34, 54
    s_min_u32 s34, s34, s63
    s_lshl_b32 s34, s34, 12
    buffer_load_dwordx4 v[96:99], v14, s[36:39], s50 offen offset:0 sc1
    v_mfma_f32_32x32x16_bf16 v[64:79], v[116:119], v[84:87], v[64:79]
    v_exp_f32 v24, v24
    v_exp_f32 v25, v25
    v_cvt_pk_bf16_f32 v83, v22, v23
    v_exp_f32_e64 v26, v26
    v_exp_f32 v27, v27
    s_waitcnt lgkmcnt(0)
    v_cvt_pk_bf16_f32 v84, v24, v25
    buffer_load_dwordx4 v[100:103], v14, s[36:39], s50 offen offset:1024 sc1
    v_mfma_f32_32x32x16_bf16 v[48:63], v[112:115], v[80:83], v[48:63]
    s_barrier
    s_nop 0
    v_exp_f32 v28, v28
    v_exp_f32 v29, v29
    v_cvt_pk_bf16_f32 v85, v26, v27
    v_exp_f32 v30, v30
    v_exp_f32 v31, v31
    v_cvt_pk_bf16_f32 v86, v28, v29
    v_cvt_pk_bf16_f32 v87, v30, v31
    s_nop 0
    v_exp_f32 v32, v32
    v_exp_f32 v33, v33
    v_exp_f32 v34, v34
    v_exp_f32 v35, v35
    v_cvt_pk_bf16_f32 v80, v32, v33
    buffer_load_dwordx4 v[104:107], v14, s[36:39], s50 offen offset:2048 sc1
    buffer_load_dwordx4 v[108:111], v14, s[36:39], s50 offen offset:3072 sc1
    s_nop 0
    v_exp_f32 v36, v36
    v_exp_f32 v37, v37
    v_cvt_pk_bf16_f32 v81, v34, v35
    v_exp_f32 v38, v38
    v_exp_f32 v39, v39
    v_cvt_pk_bf16_f32 v82, v36, v37
    v_mfma_f32_32x32x16_bf16 v[48:63], v[120:123], v[84:87], v[48:63]
    v_exp_f32 v40, v40
    v_exp_f32 v41, v41
    v_cvt_pk_bf16_f32 v83, v38, v39
    v_exp_f32 v42, v42
    v_exp_f32 v43, v43
    v_cvt_pk_bf16_f32 v84, v40, v41
    buffer_load_dwordx4 v[116:119], v14, s[36:39], s34 offen offset:1024 sc1
    v_mfma_f32_32x32x16_bf16 v[64:79], v[112:115], v[80:83], v[64:79]
    v_exp_f32 v44, v44
    v_exp_f32 v45, v45
    v_cvt_pk_bf16_f32 v85, v42, v43
    v_exp_f32 v46, v46
    v_exp_f32 v47, v47
    v_cvt_pk_bf16_f32 v86, v44, v45
    v_cvt_pk_bf16_f32 v87, v46, v47
    s_nop 1
    v_mfma_f32_32x32x16_bf16 v[64:79], v[120:123], v[84:87], v[64:79]
    s_setprio 0
    ds_write_b128 v5, v[48:51] offset:0
    ds_write_b128 v5, v[52:55] offset:1024
    ds_write_b128 v5, v[56:59] offset:2048
    ds_write_b32 v5, v60 offset:3072
    buffer_load_dwordx4 v[112:115], v14, s[36:39], s34 offen offset:0 sc1
    buffer_load_dwordx4 v[120:123], v14, s[36:39], s34 offen offset:2048 sc1
    s_waitcnt lgkmcnt(0)
    s_barrier
    ds_read_b128 v[16:19], v6 offset:0
    ds_read_b128 v[20:23], v6 offset:1024
    ds_read_b128 v[24:27], v6 offset:2048
    ds_read_b32 v28, v6 offset:3072
    s_mov_b32 s25, 0x33800000
    s_mov_b32 s26, 0x5f800000
    s_waitcnt lgkmcnt(0)
    v_add_f32 v64, v64, v16
    v_add_f32 v65, v65, v17
    v_add_f32 v66, v66, v18
    v_add_f32 v67, v67, v19
    v_add_f32 v68, v68, v20
    v_add_f32 v69, v69, v21
    v_add_f32 v70, v70, v22
    v_add_f32 v71, v71, v23
    v_add_f32 v72, v72, v24
    v_add_f32 v73, v73, v25
    v_add_f32 v74, v74, v26
    v_add_f32 v75, v75, v27
    v_add_f32 v76, v76, v28
    v_mul_f32 v11, 0, v64
    v_fma_f32 v11, v65, 0, v11
    v_fma_f32 v11, v66, 0, v11
    v_fma_f32 v11, v67, 0, v11
    v_fma_f32 v11, v68, 0, v11
    v_fma_f32 v11, v69, 0, v11
    v_fma_f32 v11, v70, 0, v11
    v_fma_f32 v11, v71, 0, v11
    v_fma_f32 v11, v72, 0, v11
    v_fma_f32 v11, v73, 0, v11
    v_fma_f32 v11, v74, 0, v11
    v_fma_f32 v11, v75, 0, v11
    v_add_f32 v11, v11, v76
    v_cmp_nle_f32 vcc, s25, v11
    v_cmp_nle_f32 s[32:33], v11, s26
    s_nop 1
    s_or_b64 vcc, vcc, s[32:33]
    s_cbranch_vccnz K_slow
K_fin:
    v_rcp_f32 v11, v76
    s_waitcnt vmcnt(23)
    v_mul_f32 v11, v11, v1
    v_mul_f32 v64, v64, v11
    v_mul_f32 v65, v65, v11
    v_mul_f32 v66, v66, v11
    v_mul_f32 v67, v67, v11
    v_mul_f32 v68, v68, v11
    v_mul_f32 v69, v69, v11
    v_mul_f32 v70, v70, v11
    v_mul_f32 v71, v71, v11
    v_mul_f32 v72, v72, v11
    v_mul_f32 v73, v73, v11
    v_mul_f32 v74, v74, v11
    v_mul_f32 v75, v75, v11
    v_cvt_pk_bf16_f32 v80, v64, v65
    v_cvt_pk_bf16_f32 v81, v66, v67
    v_cvt_pk_bf16_f32 v82, v68, v69
    v_cvt_pk_bf16_f32 v83, v70, v71
    v_cvt_pk_bf16_f32 v84, v72, v73
    v_cvt_pk_bf16_f32 v85, v74, v75
    buffer_store_dwordx4 v[80:83], v8, s[56:59], 0 offen sc1
    buffer_store_dwordx2 v[84:85], v9, s[56:59], 0 offen sc1
    v_add_u32 v12, s54, v14
    v_add_u32 v13, s55, v14
    v_add_f32 v7, 1.0, v7
    v_rcp_f32 v7, v7
    s_cmp_ge_u32 s3, 4
    s_cselect_b64 vcc, -1, 0
    s_setprio 1
    s_waitcnt vmcnt(63)
    v_mfma_f32_16x16x32_bf16 v[16:19], v[128:131], v[144:147], 0
    v_mfma_f32_16x16x32_bf16 v[20:23], v[128:131], v[148:151], 0
    v_mfma_f32_16x16x32_bf16 v[24:27], v[128:131], v[152:155], 0
    v_mfma_f32_16x16x32_bf16 v[28:31], v[128:131], v[156:159], 0
    v_mfma_f32_16x16x32_bf16 v[32:35], v[128:131], v[160:163], 0
    v_mfma_f32_16x16x32_bf16 v[36:39], v[132:135], v[144:147], 0
    v_mfma_f32_16x16x32_bf16 v[40:43], v[132:135], v[148:151], 0
    v_mfma_f32_16x16x32_bf16 v[44:47], v[132:135], v[152:155], 0
    v_mfma_f32_16x16x32_bf16 v[48:51], v[132:135], v[156:159], 0
    v_mfma_f32_16x16x32_bf16 v[52:55], v[132:135], v[160:163], 0
    v_mfma_f32_16x16x32_bf16 v[56:59], v[136:139], v[144:147], 0
    s_add_u32 s51, s62, 32
    s_sub_u32 s63, s51, 54
    s_min_u32 s51, s51, s63
    s_mul_i32 s51, s51, 5120
    s_add_u32 m0, s55, 0
    s_nop 0
    buffer_load_dwordx4 v14, s[40:43], s51 offen offset:0 sc1 lds
    v_mfma_f32_16x16x32_bf16 v[60:63], v[136:139], v[148:151], 0
    v_mfma_f32_16x16x32_bf16 v[64:67], v[136:139], v[152:155], 0
    v_mfma_f32_16x16x32_bf16 v[68:71], v[136:139], v[156:159], 0
    buffer_load_dwordx4 v14, s[40:43], s51 offen offset:1024 sc1 lds
    v_mfma_f32_16x16x32_bf16 v[72:75], v[136:139], v[160:163], 0
    v_mfma_f32_16x16x32_bf16 v[76:79], v[140:143], v[144:147], 0
    v_mfma_f32_16x16x32_bf16 v[80:83], v[140:143], v[148:151], 0
    v_mfma_f32_16x16x32_bf16 v[84:87], v[140:143], v[152:155], 0
    buffer_load_dwordx4 v14, s[40:43], s51 offen offset:2048 sc1 lds
    v_mfma_f32_16x16x32_bf16 v[88:91], v[140:143], v[156:159], 0
    v_mfma_f32_16x16x32_bf16 v[92:95], v[140:143], v[160:163], 0
    s_waitcnt vmcnt(63)
    v_mfma_f32_16x16x32_bf16 v[16:19], v[164:167], v[180:183], v[16:19]
    buffer_load_dwordx4 v14, s[40:43], s51 offen offset:3072 sc1 lds
    v_mfma_f32_16x16x32_bf16 v[20:23], v[164:167], v[184:187], v[20:23]
    v_mfma_f32_16x16x32_bf16 v[24:27], v[164:167], v[188:191], v[24:27]
    v_mfma_f32_16x16x32_bf16 v[28:31], v[164:167], v[192:195], v[28:31]
    v_mfma_f32_16x16x32_bf16 v[32:35], v[164:167], v[196:199], v[32:35]
    s_add_u32 m0, s55, 4096
    s_nop 0
    buffer_load_dwordx4 v15, s[40:43], s51 offen offset:0 sc1 lds
    v_mfma_f32_16x16x32_bf16 v[36:39], v[168:171], v[180:183], v[36:39]
    v_mfma_f32_16x16x32_bf16 v[40:43], v[168:171], v[184:187], v[40:43]
    v_mfma_f32_16x16x32_bf16 v[44:47], v[168:171], v[188:191], v[44:47]
    v_mfma_f32_16x16x32_bf16 v[48:51], v[168:171], v[192:195], v[48:51]
    s_add_u32 s50, s62, 40
    s_sub_u32 s63, s50, 54
    s_min_u32 s50, s50, s63
    s_lshl_b32 s50, s50, 12
    buffer_load_dwordx4 v[128:131], v14, s[36:39], s50 offen offset:0 sc1
    v_mfma_f32_16x16x32_bf16 v[52:55], v[168:171], v[196:199], v[52:55]
    v_mfma_f32_16x16x32_bf16 v[56:59], v[172:175], v[180:183], v[56:59]
    v_mfma_f32_16x16x32_bf16 v[60:63], v[172:175], v[184:187], v[60:63]
    buffer_load_dwordx4 v[132:135], v14, s[36:39], s50 offen offset:1024 sc1
    v_mfma_f32_16x16x32_bf16 v[64:67], v[172:175], v[188:191], v[64:67]
    v_mfma_f32_16x16x32_bf16 v[68:71], v[172:175], v[192:195], v[68:71]
    v_mfma_f32_16x16x32_bf16 v[72:75], v[172:175], v[196:199], v[72:75]
    v_mfma_f32_16x16x32_bf16 v[76:79], v[176:179], v[180:183], v[76:79]
    buffer_load_dwordx4 v[136:139], v14, s[36:39], s50 offen offset:2048 sc1
    v_mfma_f32_16x16x32_bf16 v[80:83], v[176:179], v[184:187], v[80:83]
    v_mfma_f32_16x16x32_bf16 v[84:87], v[176:179], v[188:191], v[84:87]
    v_mfma_f32_16x16x32_bf16 v[88:91], v[176:179], v[192:195], v[88:91]
    buffer_load_dwordx4 v[140:143], v14, s[36:39], s50 offen offset:3072 sc1
    v_mfma_f32_16x16x32_bf16 v[92:95], v[176:179], v[196:199], v[92:95]
    s_cbranch_vccnz L_b6l_59
    s_waitcnt vmcnt(18)
    ds_read_b128 v[180:183], v12 offset:10240
    ds_read_b128 v[184:187], v12 offset:11264
    ds_read_b128 v[188:191], v12 offset:12288
    ds_read_b128 v[192:195], v12 offset:13312
    ds_read_b128 v[196:199], v12 offset:14336
L_b6l_59:
    s_waitcnt vmcnt(63)
    v_mfma_f32_16x16x32_bf16 v[16:19], v[200:203], v[216:219], v[16:19]
    v_mfma_f32_16x16x32_bf16 v[20:23], v[200:203], v[220:223], v[20:23]
    v_mfma_f32_16x16x32_bf16 v[24:27], v[200:203], v[224:227], v[24:27]
    s_add_u32 s51, s62, 40
    s_sub_u32 s63, s51, 54
    s_min_u32 s51, s51, s63
    s_mul_i32 s51, s51, 5120
    buffer_load_dwordx4 v[144:147], v14, s[40:43], s51 offen offset:0 sc1
    v_mfma_f32_16x16x32_bf16 v[28:31], v[200:203], v[228:231], v[28:31]
    v_mfma_f32_16x16x32_bf16 v[32:35], v[200:203], v[232:235], v[32:35]
    v_mfma_f32_16x16x32_bf16 v[36:39], v[204:207], v[216:219], v[36:39]
    v_mfma_f32_16x16x32_bf16 v[40:43], v[204:207], v[220:223], v[40:43]
    buffer_load_dwordx4 v[148:151], v14, s[40:43], s51 offen offset:1024 sc1
    v_mfma_f32_16x16x32_bf16 v[44:47], v[204:207], v[224:227], v[44:47]
    v_mfma_f32_16x16x32_bf16 v[48:51], v[204:207], v[228:231], v[48:51]
    v_mfma_f32_16x16x32_bf16 v[52:55], v[204:207], v[232:235], v[52:55]
    buffer_load_dwordx4 v[152:155], v14, s[40:43], s51 offen offset:2048 sc1
    v_mfma_f32_16x16x32_bf16 v[56:59], v[208:211], v[216:219], v[56:59]
    v_mfma_f32_16x16x32_bf16 v[60:63], v[208:211], v[220:223], v[60:63]
    v_mfma_f32_16x16x32_bf16 v[64:67], v[208:211], v[224:227], v[64:67]
    v_mfma_f32_16x16x32_bf16 v[68:71], v[208:211], v[228:231], v[68:71]
    buffer_load_dwordx4 v[156:159], v14, s[40:43], s51 offen offset:3072 sc1
    v_mfma_f32_16x16x32_bf16 v[72:75], v[208:211], v[232:235], v[72:75]
    v_mfma_f32_16x16x32_bf16 v[76:79], v[212:215], v[216:219], v[76:79]
    v_mfma_f32_16x16x32_bf16 v[80:83], v[212:215], v[220:223], v[80:83]
    buffer_load_dwordx4 v[160:163], v15, s[40:43], s51 offen offset:0 sc1
    v_mfma_f32_16x16x32_bf16 v[84:87], v[212:215], v[224:227], v[84:87]
    v_mfma_f32_16x16x32_bf16 v[88:91], v[212:215], v[228:231], v[88:91]
    v_mfma_f32_16x16x32_bf16 v[92:95], v[212:215], v[232:235], v[92:95]
    s_waitcnt vmcnt(19)
    v_mfma_f32_16x16x32_bf16 v[16:19], v[96:99], v[236:239], v[16:19]
    s_add_u32 s51, s62, 48
    s_sub_u32 s63, s51, 54
    s_min_u32 s51, s51, s63
    s_cmp_lt_u32 s3, 6
    s_cselect_b32 s51, s51, 1024
    s_mul_i32 s51, s51, 5120
    s_cbranch_vccz L_opt_60
    buffer_load_dwordx4 v[180:183], v14, s[40:43], s51 offen offset:0 sc1
L_opt_60:
    v_mfma_f32_16x16x32_bf16 v[20:23], v[96:99], v[240:243], v[20:23]
    v_mfma_f32_16x16x32_bf16 v[24:27], v[96:99], v[244:247], v[24:27]
    v_mfma_f32_16x16x32_bf16 v[28:31], v[96:99], v[248:251], v[28:31]
    v_mfma_f32_16x16x32_bf16 v[32:35], v[96:99], v[252:255], v[32:35]
    s_cbranch_vccz L_opt_61
    buffer_load_dwordx4 v[184:187], v14, s[40:43], s51 offen offset:1024 sc1
L_opt_61:
    v_mfma_f32_16x16x32_bf16 v[36:39], v[100:103], v[236:239], v[36:39]
    v_mfma_f32_16x16x32_bf16 v[40:43], v[100:103], v[240:243], v[40:43]
    v_mfma_f32_16x16x32_bf16 v[44:47], v[100:103], v[244:247], v[44:47]
    s_cbranch_vccz L_opt_62
    buffer_load_dwordx4 v[188:191], v14, s[40:43], s51 offen offset:2048 sc1
L_opt_62:
    v_mfma_f32_16x16x32_bf16 v[48:51], v[100:103], v[248:251], v[48:51]
    v_mfma_f32_16x16x32_bf16 v[52:55], v[100:103], v[252:255], v[52:55]
    v_mfma_f32_16x16x32_bf16 v[56:59], v[104:107], v[236:239], v[56:59]
    v_mfma_f32_16x16x32_bf16 v[60:63], v[104:107], v[240:243], v[60:63]
    s_cbranch_vccz L_opt_63
    buffer_load_dwordx4 v[192:195], v14, s[40:43], s51 offen offset:3072 sc1
L_opt_63:
    v_mfma_f32_16x16x32_bf16 v[64:67], v[104:107], v[244:247], v[64:67]
    v_mfma_f32_16x16x32_bf16 v[68:71], v[104:107], v[248:251], v[68:71]
    v_mfma_f32_16x16x32_bf16 v[72:75], v[104:107], v[252:255], v[72:75]
    s_cbranch_vccz L_opt_64
    buffer_load_dwordx4 v[196:199], v15, s[40:43], s51 offen offset:0 sc1
L_opt_64:
    v_mfma_f32_16x16x32_bf16 v[76:79], v[108:111], v[236:239], v[76:79]
    v_mfma_f32_16x16x32_bf16 v[80:83], v[108:111], v[240:243], v[80:83]
    v_mfma_f32_16x16x32_bf16 v[84:87], v[108:111], v[244:247], v[84:87]
    v_mfma_f32_16x16x32_bf16 v[88:91], v[108:111], v[248:251], v[88:91]
    s_add_u32 s50, s62, 48
    s_sub_u32 s63, s50, 54
    s_min_u32 s50, s50, s63
    s_cmp_lt_u32 s3, 6
    s_cselect_b32 s50, s50, 524032
    s_lshl_b32 s50, s50, 12
    buffer_load_dwordx4 v[164:167], v14, s[36:39], s50 offen offset:0 sc1
    v_mfma_f32_16x16x32_bf16 v[92:95], v[108:111], v[252:255], v[92:95]
    s_waitcnt vmcnt(10)
    ds_read_b128 v[216:219], v13 offset:0
    ds_read_b128 v[220:223], v13 offset:1024
    ds_read_b128 v[224:227], v13 offset:2048
    ds_read_b128 v[228:231], v13 offset:3072
    ds_read_b128 v[232:235], v13 offset:4096
    ds_read_b128 v[236:239], v12 offset:0
    ds_read_b128 v[240:243], v12 offset:1024
    ds_read_b128 v[244:247], v12 offset:2048
    ds_read_b128 v[248:251], v12 offset:3072
    ds_read_b128 v[252:255], v12 offset:4096
    s_waitcnt vmcnt(63) lgkmcnt(5)
    v_mfma_f32_16x16x32_bf16 v[16:19], v[112:115], v[216:219], v[16:19]
    v_mfma_f32_16x16x32_bf16 v[20:23], v[112:115], v[220:223], v[20:23]
    buffer_load_dwordx4 v[168:171], v14, s[36:39], s50 offen offset:1024 sc1
    v_mfma_f32_16x16x32_bf16 v[24:27], v[112:115], v[224:227], v[24:27]
    v_mfma_f32_16x16x32_bf16 v[28:31], v[112:115], v[228:231], v[28:31]
    v_mfma_f32_16x16x32_bf16 v[32:35], v[112:115], v[232:235], v[32:35]
    v_mfma_f32_16x16x32_bf16 v[36:39], v[116:119], v[216:219], v[36:39]
    buffer_load_dwordx4 v[172:175], v14, s[36:39], s50 offen offset:2048 sc1
    v_mfma_f32_16x16x32_bf16 v[40:43], v[116:119], v[220:223], v[40:43]
    v_mfma_f32_16x16x32_bf16 v[44:47], v[116:119], v[224:227], v[44:47]
    v_mfma_f32_16x16x32_bf16 v[48:51], v[116:119], v[228:231], v[48:51]
    v_mfma_f32_16x16x32_bf16 v[52:55], v[116:119], v[232:235], v[52:55]
    buffer_load_dwordx4 v[176:179], v14, s[36:39], s50 offen offset:3072 sc1
    v_mfma_f32_16x16x32_bf16 v[56:59], v[120:123], v[216:219], v[56:59]
    v_mfma_f32_16x16x32_bf16 v[60:63], v[120:123], v[220:223], v[60:63]
    v_mfma_f32_16x16x32_bf16 v[64:67], v[120:123], v[224:227], v[64:67]
    s_add_u32 s50, s3, 54
    s_lshl_b32 s50, s50, 12
    buffer_load_dwordx4 v[200:203], v14, s[36:39], s50 offen offset:0 sc1
    v_mfma_f32_16x16x32_bf16 v[68:71], v[120:123], v[228:231], v[68:71]
    v_mfma_f32_16x16x32_bf16 v[72:75], v[120:123], v[232:235], v[72:75]
    v_mfma_f32_16x16x32_bf16 v[76:79], v[124:127], v[216:219], v[76:79]
    v_mfma_f32_16x16x32_bf16 v[80:83], v[124:127], v[220:223], v[80:83]
    buffer_load_dwordx4 v[204:207], v14, s[36:39], s50 offen offset:1024 sc1
    v_mfma_f32_16x16x32_bf16 v[84:87], v[124:127], v[224:227], v[84:87]
    v_mfma_f32_16x16x32_bf16 v[88:91], v[124:127], v[228:231], v[88:91]
    v_mfma_f32_16x16x32_bf16 v[92:95], v[124:127], v[232:235], v[92:95]
    buffer_load_dwordx4 v[208:211], v14, s[36:39], s50 offen offset:2048 sc1
    ds_read_b128 v[216:219], v12 offset:5120
    ds_read_b128 v[220:223], v12 offset:6144
    ds_read_b128 v[224:227], v12 offset:7168
    ds_read_b128 v[228:231], v12 offset:8192
    ds_read_b128 v[232:235], v12 offset:9216
    s_waitcnt vmcnt(7)
    v_mfma_f32_16x16x32_bf16 v[16:19], v[128:131], v[144:147], v[16:19]
    s_lshr_b32 s20, s3, 1
    v_mfma_f32_16x16x32_bf16 v[20:23], v[128:131], v[148:151], v[20:23]
    s_and_b32 s21, s3, 1
    s_lshl_b32 s21, s21, 1
    v_mfma_f32_16x16x32_bf16 v[24:27], v[128:131], v[152:155], v[24:27]
    s_mul_i32 s22, s20, 5120
    s_mov_b32 s23, 15360
    v_mfma_f32_16x16x32_bf16 v[28:31], v[128:131], v[156:159], v[28:31]
    s_cmp_eq_u32 s20, 3
    s_cselect_b32 s22, 61440, s22
    s_cselect_b32 s23, 5120, s23
    s_lshl_b32 s24, s21, 8
    buffer_load_dwordx4 v[212:215], v14, s[36:39], s50 offen offset:3072 sc1
    v_mfma_f32_16x16x32_bf16 v[32:35], v[128:131], v[160:163], v[32:35]
    s_add_u32 s22, s22, s24
    v_mfma_f32_16x16x32_bf16 v[36:39], v[132:135], v[144:147], v[36:39]
    v_and_b32 v2, 15, v0
    v_lshrrev_b32 v3, 4, v0
    v_mfma_f32_16x16x32_bf16 v[40:43], v[132:135], v[148:151], v[40:43]
    v_lshrrev_b32 v4, 2, v2
    v_mul_u32_u24 v4, 5120, v4
    v_mfma_f32_16x16x32_bf16 v[44:47], v[132:135], v[152:155], v[44:47]
    v_and_b32 v11, 3, v0
    v_lshl_add_u32 v4, v11, 3, v4
    s_add_u32 s50, s3, 62
    s_lshl_b32 s50, s50, 12
    buffer_load_dwordx4 v[96:99], v14, s[36:39], s50 offen offset:0 sc1
    v_mfma_f32_16x16x32_bf16 v[48:51], v[132:135], v[156:159], v[48:51]
    v_lshl_add_u32 v11, v3, 5, v4
    v_mfma_f32_16x16x32_bf16 v[52:55], v[132:135], v[160:163], v[52:55]
    s_lshl_b32 s20, s20, 4
    s_add_u32 s20, s20, s21
    v_mfma_f32_16x16x32_bf16 v[56:59], v[136:139], v[144:147], v[56:59]
    s_mul_i32 s20, s20, 1280
    v_add_u32 v11, s20, v11
    buffer_load_dwordx4 v[100:103], v14, s[36:39], s50 offen offset:1024 sc1
    v_mfma_f32_16x16x32_bf16 v[60:63], v[136:139], v[148:151], v[60:63]
    v_lshlrev_b32 v2, 4, v2
    v_lshl_add_u32 v1, v3, 10, v2
    v_mfma_f32_16x16x32_bf16 v[64:67], v[136:139], v[152:155], v[64:67]
    v_add_u32 v1, s22, v1
    v_mfma_f32_16x16x32_bf16 v[68:71], v[136:139], v[156:159], v[68:71]
    v_add_u32 v2, s23, v1
    v_add_u32 v3, s23, v2
    v_mfma_f32_16x16x32_bf16 v[72:75], v[136:139], v[160:163], v[72:75]
    v_add_u32 v4, s23, v3
    s_mul_i32 s21, s48, 81920
    buffer_load_dwordx4 v[104:107], v14, s[36:39], s50 offen offset:2048 sc1
    v_mfma_f32_16x16x32_bf16 v[76:79], v[140:143], v[144:147], v[76:79]
    s_mul_i32 s20, s49, 160
    s_add_u32 s21, s21, s20
    v_mfma_f32_16x16x32_bf16 v[80:83], v[140:143], v[148:151], v[80:83]
    s_sub_u32 s46, 2621440, s21
    v_mfma_f32_16x16x32_bf16 v[84:87], v[140:143], v[152:155], v[84:87]
    s_mov_b32 s47, 0x00020000
    s_add_u32 s44, s44, s21
    s_addc_u32 s45, s45, 0
    buffer_load_dwordx4 v[108:111], v14, s[36:39], s50 offen offset:3072 sc1
    v_mfma_f32_16x16x32_bf16 v[88:91], v[140:143], v[156:159], v[88:91]
    v_add_u32 v6, 81920, v1
    v_add_u32 v8, 81920, v2
    v_mfma_f32_16x16x32_bf16 v[92:95], v[140:143], v[160:163], v[92:95]
    v_add_u32 v9, 81920, v3
    v_add_u32 v10, 81920, v4
    s_add_u32 s50, s3, 66
    s_cmp_ge_u32 s50, 70
    s_cselect_b32 s50, s50, 524032
    s_lshl_b32 s50, s50, 12
    s_cbranch_vccz L_opt_65
    buffer_load_dwordx4 v[112:115], v14, s[36:39], s50 offen offset:0 sc1
L_opt_65:
    s_cbranch_vccz L_opt_66
    buffer_load_dwordx4 v[116:119], v14, s[36:39], s50 offen offset:1024 sc1
L_opt_66:
    s_cbranch_vccz L_opt_67
    buffer_load_dwordx4 v[120:123], v14, s[36:39], s50 offen offset:2048 sc1
L_opt_67:
    s_cbranch_vccz L_opt_68
    buffer_load_dwordx4 v[124:127], v14, s[36:39], s50 offen offset:3072 sc1
L_opt_68:
    ds_read_b128 v[144:147], v12 offset:10240
    ds_read_b128 v[148:151], v12 offset:11264
    ds_read_b128 v[152:155], v12 offset:12288
    ds_read_b128 v[156:159], v12 offset:13312
    ds_read_b128 v[160:163], v12 offset:14336
    s_waitcnt vmcnt(8)
    s_cmp_lt_u32 s3, 6
    s_cbranch_scc0 L_skip_69
    v_mfma_f32_16x16x32_bf16 v[16:19], v[164:167], v[180:183], v[16:19]
    v_mfma_f32_16x16x32_bf16 v[20:23], v[164:167], v[184:187], v[20:23]
    v_mfma_f32_16x16x32_bf16 v[24:27], v[164:167], v[188:191], v[24:27]
    v_mfma_f32_16x16x32_bf16 v[28:31], v[164:167], v[192:195], v[28:31]
    v_mfma_f32_16x16x32_bf16 v[32:35], v[164:167], v[196:199], v[32:35]
    v_mfma_f32_16x16x32_bf16 v[36:39], v[168:171], v[180:183], v[36:39]
    v_mfma_f32_16x16x32_bf16 v[40:43], v[168:171], v[184:187], v[40:43]
    v_mfma_f32_16x16x32_bf16 v[44:47], v[168:171], v[188:191], v[44:47]
    v_mfma_f32_16x16x32_bf16 v[48:51], v[168:171], v[192:195], v[48:51]
    v_mfma_f32_16x16x32_bf16 v[52:55], v[168:171], v[196:199], v[52:55]
    v_mfma_f32_16x16x32_bf16 v[56:59], v[172:175], v[180:183], v[56:59]
    v_mfma_f32_16x16x32_bf16 v[60:63], v[172:175], v[184:187], v[60:63]
    v_mfma_f32_16x16x32_bf16 v[64:67], v[172:175], v[188:191], v[64:67]
    v_mfma_f32_16x16x32_bf16 v[68:71], v[172:175], v[192:195], v[68:71]
    v_mfma_f32_16x16x32_bf16 v[72:75], v[172:175], v[196:199], v[72:75]
    v_mfma_f32_16x16x32_bf16 v[76:79], v[176:179], v[180:183], v[76:79]
    v_mfma_f32_16x16x32_bf16 v[80:83], v[176:179], v[184:187], v[80:83]
    v_mfma_f32_16x16x32_bf16 v[84:87], v[176:179], v[188:191], v[84:87]
    v_mfma_f32_16x16x32_bf16 v[88:91], v[176:179], v[192:195], v[88:91]
    v_mfma_f32_16x16x32_bf16 v[92:95], v[176:179], v[196:199], v[92:95]
L_skip_69:
    s_waitcnt vmcnt(0) lgkmcnt(0)
    v_max3_u32 v5, v200, v201, v202
    v_max3_u32 v5, v5, v203, v204
    v_max3_u32 v5, v5, v205, v206
    v_max3_u32 v5, v5, v207, v208
    v_max3_u32 v5, v5, v209, v210
    v_max3_u32 v5, v5, v211, v212
    v_max3_u32 v5, v5, v213, v214
    v_max3_u32 v5, v5, v215, v96
    v_max3_u32 v5, v5, v97, v98
    v_max3_u32 v5, v5, v99, v100
    v_max3_u32 v5, v5, v101, v102
    v_max3_u32 v5, v5, v103, v104
    v_max3_u32 v5, v5, v105, v106
    v_max3_u32 v5, v5, v107, v108
    v_max3_u32 v5, v5, v109, v110
    v_max3_u32 v5, v5, v111, v112
    v_max3_u32 v5, v5, v113, v114
    v_max3_u32 v5, v5, v115, v116
    v_max3_u32 v5, v5, v117, v118
    v_max3_u32 v5, v5, v119, v120
    v_max3_u32 v5, v5, v121, v122
    v_max3_u32 v5, v5, v123, v124
    v_max3_u32 v5, v5, v125, v126
    v_max_u32 v5, v5, v127
    v_cmp_eq_u32 vcc, -1, v5
    s_cbranch_vccnz L_ospin_70
L_oback_71:
    s_setprio 0
    s_cmp_ge_u32 s3, 4
    s_cbranch_scc1 L_clsb_72
    s_mov_b32 m0, s54
    v_mfma_f32_16x16x32_bf16 v[16:19], v[200:203], v[236:239], v[16:19]
    v_mfma_f32_16x16x32_bf16 v[20:23], v[200:203], v[240:243], v[20:23]
    v_mfma_f32_16x16x32_bf16 v[16:19], v[96:99], v[216:219], v[16:19]
    v_mfma_f32_16x16x32_bf16 v[20:23], v[96:99], v[220:223], v[20:23]
    v_mfma_f32_16x16x32_bf16 v[24:27], v[200:203], v[244:247], v[24:27]
    v_mfma_f32_16x16x32_bf16 v[28:31], v[200:203], v[248:251], v[28:31]
    v_mfma_f32_16x16x32_bf16 v[24:27], v[96:99], v[224:227], v[24:27]
    v_mfma_f32_16x16x32_bf16 v[28:31], v[96:99], v[228:231], v[28:31]
    v_mfma_f32_16x16x32_bf16 v[32:35], v[200:203], v[252:255], v[32:35]
    s_nop 1
    ds_write_addtid_b32 v16 offset:0
    ds_write_addtid_b32 v17 offset:256
    v_mfma_f32_16x16x32_bf16 v[36:39], v[204:207], v[236:239], v[36:39]
    ds_write_addtid_b32 v18 offset:512
    ds_write_addtid_b32 v19 offset:768
    v_mfma_f32_16x16x32_bf16 v[32:35], v[96:99], v[232:235], v[32:35]
    ds_write_addtid_b32 v20 offset:1024
    ds_write_addtid_b32 v21 offset:1280
    v_mfma_f32_16x16x32_bf16 v[36:39], v[100:103], v[216:219], v[36:39]
    ds_write_addtid_b32 v22 offset:1536
    ds_write_addtid_b32 v23 offset:1792
    v_mfma_f32_16x16x32_bf16 v[40:43], v[204:207], v[240:243], v[40:43]
    ds_write_addtid_b32 v24 offset:2048
    ds_write_addtid_b32 v25 offset:2304
    v_mfma_f32_16x16x32_bf16 v[44:47], v[204:207], v[244:247], v[44:47]
    ds_write_addtid_b32 v26 offset:2560
    ds_write_addtid_b32 v27 offset:2816
    v_mfma_f32_16x16x32_bf16 v[40:43], v[100:103], v[220:223], v[40:43]
    ds_write_addtid_b32 v28 offset:3072
    ds_write_addtid_b32 v29 offset:3328
    v_mfma_f32_16x16x32_bf16 v[44:47], v[100:103], v[224:227], v[44:47]
    ds_write_addtid_b32 v30 offset:3584
    ds_write_addtid_b32 v31 offset:3840
    v_mfma_f32_16x16x32_bf16 v[48:51], v[204:207], v[248:251], v[48:51]
    ds_write_addtid_b32 v32 offset:4096
    ds_write_addtid_b32 v33 offset:4352
    v_mfma_f32_16x16x32_bf16 v[52:55], v[204:207], v[252:255], v[52:55]
    ds_write_addtid_b32 v34 offset:4608
    ds_write_addtid_b32 v35 offset:4864
    v_mfma_f32_16x16x32_bf16 v[48:51], v[100:103], v[228:231], v[48:51]
    ds_write_addtid_b32 v36 offset:5120
    ds_write_addtid_b32 v37 offset:5376
    v_mfma_f32_16x16x32_bf16 v[52:55], v[100:103], v[232:235], v[52:55]
    ds_write_addtid_b32 v38 offset:5632
    ds_write_addtid_b32 v39 offset:5888
    v_mfma_f32_16x16x32_bf16 v[56:59], v[208:211], v[236:239], v[56:59]
    ds_write_addtid_b32 v40 offset:6144
    ds_write_addtid_b32 v41 offset:6400
    v_mfma_f32_16x16x32_bf16 v[60:63], v[208:211], v[240:243], v[60:63]
    ds_write_addtid_b32 v42 offset:6656
    ds_write_addtid_b32 v43 offset:6912
    v_mfma_f32_16x16x32_bf16 v[56:59], v[104:107], v[216:219], v[56:59]
    ds_write_addtid_b32 v44 offset:7168
    ds_write_addtid_b32 v45 offset:7424
    v_mfma_f32_16x16x32_bf16 v[60:63], v[104:107], v[220:223], v[60:63]
    ds_write_addtid_b32 v46 offset:7680
    ds_write_addtid_b32 v47 offset:7936
    v_mfma_f32_16x16x32_bf16 v[64:67], v[208:211], v[244:247], v[64:67]
    ds_write_addtid_b32 v48 offset:8192
    ds_write_addtid_b32 v49 offset:8448
    v_mfma_f32_16x16x32_bf16 v[68:71], v[208:211], v[248:251], v[68:71]
    ds_write_addtid_b32 v50 offset:8704
    ds_write_addtid_b32 v51 offset:8960
    v_mfma_f32_16x16x32_bf16 v[64:67], v[104:107], v[224:227], v[64:67]
    ds_write_addtid_b32 v52 offset:9216
    ds_write_addtid_b32 v53 offset:9472
    v_mfma_f32_16x16x32_bf16 v[68:71], v[104:107], v[228:231], v[68:71]
    ds_write_addtid_b32 v54 offset:9728
    ds_write_addtid_b32 v55 offset:9984
    v_mfma_f32_16x16x32_bf16 v[72:75], v[208:211], v[252:255], v[72:75]
    ds_write_addtid_b32 v56 offset:10240
    ds_write_addtid_b32 v57 offset:10496
    v_mfma_f32_16x16x32_bf16 v[76:79], v[212:215], v[236:239], v[76:79]
    ds_write_addtid_b32 v58 offset:10752
    ds_write_addtid_b32 v59 offset:11008
    v_mfma_f32_16x16x32_bf16 v[72:75], v[104:107], v[232:235], v[72:75]
    ds_write_addtid_b32 v60 offset:11264
    ds_write_addtid_b32 v61 offset:11520
    v_mfma_f32_16x16x32_bf16 v[76:79], v[108:111], v[216:219], v[76:79]
    ds_write_addtid_b32 v62 offset:11776
    ds_write_addtid_b32 v63 offset:12032
    v_mfma_f32_16x16x32_bf16 v[80:83], v[212:215], v[240:243], v[80:83]
    ds_write_addtid_b32 v64 offset:12288
    ds_write_addtid_b32 v65 offset:12544
    v_mfma_f32_16x16x32_bf16 v[84:87], v[212:215], v[244:247], v[84:87]
    ds_write_addtid_b32 v66 offset:12800
    ds_write_addtid_b32 v67 offset:13056
    v_mfma_f32_16x16x32_bf16 v[80:83], v[108:111], v[220:223], v[80:83]
    ds_write_addtid_b32 v68 offset:13312
    ds_write_addtid_b32 v69 offset:13568
    v_mfma_f32_16x16x32_bf16 v[84:87], v[108:111], v[224:227], v[84:87]
    ds_write_addtid_b32 v70 offset:13824
    ds_write_addtid_b32 v71 offset:14080
    v_mfma_f32_16x16x32_bf16 v[88:91], v[212:215], v[248:251], v[88:91]
    ds_write_addtid_b32 v72 offset:14336
    ds_write_addtid_b32 v73 offset:14592
    v_mfma_f32_16x16x32_bf16 v[92:95], v[212:215], v[252:255], v[92:95]
    ds_write_addtid_b32 v74 offset:14848
    ds_write_addtid_b32 v75 offset:15104
    s_sub_u32 m0, s55, 15360
    v_mfma_f32_16x16x32_bf16 v[88:91], v[108:111], v[228:231], v[88:91]
    s_nop 0
    ds_write_addtid_b32 v76 offset:15360
    ds_write_addtid_b32 v77 offset:15616
    v_mfma_f32_16x16x32_bf16 v[92:95], v[108:111], v[232:235], v[92:95]
    ds_write_addtid_b32 v78 offset:15872
    ds_write_addtid_b32 v79 offset:16128
    ds_write_addtid_b32 v80 offset:16384
    ds_write_addtid_b32 v81 offset:16640
    ds_write_addtid_b32 v82 offset:16896
    ds_write_addtid_b32 v83 offset:17152
    ds_write_addtid_b32 v84 offset:17408
    ds_write_addtid_b32 v85 offset:17664
    ds_write_addtid_b32 v86 offset:17920
    ds_write_addtid_b32 v87 offset:18176
    s_nop 3
    ds_write_addtid_b32 v88 offset:18432
    ds_write_addtid_b32 v89 offset:18688
    ds_write_addtid_b32 v90 offset:18944
    ds_write_addtid_b32 v91 offset:19200
    ds_write_addtid_b32 v92 offset:19456
    ds_write_addtid_b32 v93 offset:19712
    ds_write_addtid_b32 v94 offset:19968
    ds_write_addtid_b32 v95 offset:20224
    s_branch L_clsj_73
L_clsb_72:
    v_lshlrev_b32 v13, 2, v0
    v_add_u32 v12, s54, v13
    v_add_u32 v13, s55, v13
    v_mfma_f32_16x16x32_bf16 v[16:19], v[200:203], v[236:239], v[16:19]
    v_mfma_f32_16x16x32_bf16 v[20:23], v[200:203], v[240:243], v[20:23]
    v_mfma_f32_16x16x32_bf16 v[16:19], v[96:99], v[216:219], v[16:19]
    v_mfma_f32_16x16x32_bf16 v[20:23], v[96:99], v[220:223], v[20:23]
    v_mfma_f32_16x16x32_bf16 v[16:19], v[112:115], v[144:147], v[16:19]
    v_mfma_f32_16x16x32_bf16 v[20:23], v[112:115], v[148:151], v[20:23]
    v_mfma_f32_16x16x32_bf16 v[24:27], v[200:203], v[244:247], v[24:27]
    v_mfma_f32_16x16x32_bf16 v[28:31], v[200:203], v[248:251], v[28:31]
    v_mfma_f32_16x16x32_bf16 v[24:27], v[96:99], v[224:227], v[24:27]
    v_mfma_f32_16x16x32_bf16 v[28:31], v[96:99], v[228:231], v[28:31]
    v_mfma_f32_16x16x32_bf16 v[24:27], v[112:115], v[152:155], v[24:27]
    v_mfma_f32_16x16x32_bf16 v[28:31], v[112:115], v[156:159], v[28:31]
    v_mfma_f32_16x16x32_bf16 v[32:35], v[200:203], v[252:255], v[32:35]
    v_mfma_f32_16x16x32_bf16 v[36:39], v[204:207], v[236:239], v[36:39]
    ds_write2st64_b32 v12, v16, v17 offset0:0 offset1:1
    v_mfma_f32_16x16x32_bf16 v[32:35], v[96:99], v[232:235], v[32:35]
    ds_write2st64_b32 v12, v18, v19 offset0:2 offset1:3
    v_mfma_f32_16x16x32_bf16 v[36:39], v[100:103], v[216:219], v[36:39]
    v_mfma_f32_16x16x32_bf16 v[32:35], v[112:115], v[160:163], v[32:35]
    ds_write2st64_b32 v12, v20, v21 offset0:4 offset1:5
    v_mfma_f32_16x16x32_bf16 v[36:39], v[116:119], v[144:147], v[36:39]
    ds_write2st64_b32 v12, v22, v23 offset0:6 offset1:7
    v_mfma_f32_16x16x32_bf16 v[40:43], v[204:207], v[240:243], v[40:43]
    v_mfma_f32_16x16x32_bf16 v[44:47], v[204:207], v[244:247], v[44:47]
    ds_write2st64_b32 v12, v24, v25 offset0:8 offset1:9
    v_mfma_f32_16x16x32_bf16 v[40:43], v[100:103], v[220:223], v[40:43]
    ds_write2st64_b32 v12, v26, v27 offset0:10 offset1:11
    v_mfma_f32_16x16x32_bf16 v[44:47], v[100:103], v[224:227], v[44:47]
    v_mfma_f32_16x16x32_bf16 v[40:43], v[116:119], v[148:151], v[40:43]
    ds_write2st64_b32 v12, v28, v29 offset0:12 offset1:13
    v_mfma_f32_16x16x32_bf16 v[44:47], v[116:119], v[152:155], v[44:47]
    ds_write2st64_b32 v12, v30, v31 offset0:14 offset1:15
    v_mfma_f32_16x16x32_bf16 v[48:51], v[204:207], v[248:251], v[48:51]
    v_mfma_f32_16x16x32_bf16 v[52:55], v[204:207], v[252:255], v[52:55]
    ds_write2st64_b32 v12, v32, v33 offset0:16 offset1:17
    v_mfma_f32_16x16x32_bf16 v[48:51], v[100:103], v[228:231], v[48:51]
    ds_write2st64_b32 v12, v34, v35 offset0:18 offset1:19
    v_mfma_f32_16x16x32_bf16 v[52:55], v[100:103], v[232:235], v[52:55]
    v_mfma_f32_16x16x32_bf16 v[48:51], v[116:119], v[156:159], v[48:51]
    ds_write2st64_b32 v12, v36, v37 offset0:20 offset1:21
    v_mfma_f32_16x16x32_bf16 v[52:55], v[116:119], v[160:163], v[52:55]
    ds_write2st64_b32 v12, v38, v39 offset0:22 offset1:23
    v_mfma_f32_16x16x32_bf16 v[56:59], v[208:211], v[236:239], v[56:59]
    v_mfma_f32_16x16x32_bf16 v[60:63], v[208:211], v[240:243], v[60:63]
    ds_write2st64_b32 v12, v40, v41 offset0:24 offset1:25
    v_mfma_f32_16x16x32_bf16 v[56:59], v[104:107], v[216:219], v[56:59]
    ds_write2st64_b32 v12, v42, v43 offset0:26 offset1:27
    v_mfma_f32_16x16x32_bf16 v[60:63], v[104:107], v[220:223], v[60:63]
    v_mfma_f32_16x16x32_bf16 v[56:59], v[120:123], v[144:147], v[56:59]
    ds_write2st64_b32 v12, v44, v45 offset0:28 offset1:29
    v_mfma_f32_16x16x32_bf16 v[60:63], v[120:123], v[148:151], v[60:63]
    ds_write2st64_b32 v12, v46, v47 offset0:30 offset1:31
    v_mfma_f32_16x16x32_bf16 v[64:67], v[208:211], v[244:247], v[64:67]
    v_mfma_f32_16x16x32_bf16 v[68:71], v[208:211], v[248:251], v[68:71]
    ds_write2st64_b32 v12, v48, v49 offset0:32 offset1:33
    v_mfma_f32_16x16x32_bf16 v[64:67], v[104:107], v[224:227], v[64:67]
    ds_write2st64_b32 v12, v50, v51 offset0:34 offset1:35
    v_mfma_f32_16x16x32_bf16 v[68:71], v[104:107], v[228:231], v[68:71]
    v_mfma_f32_16x16x32_bf16 v[64:67], v[120:123], v[152:155], v[64:67]
    ds_write2st64_b32 v12, v52, v53 offset0:36 offset1:37
    v_mfma_f32_16x16x32_bf16 v[68:71], v[120:123], v[156:159], v[68:71]
    ds_write2st64_b32 v12, v54, v55 offset0:38 offset1:39
    v_mfma_f32_16x16x32_bf16 v[72:75], v[208:211], v[252:255], v[72:75]
    v_mfma_f32_16x16x32_bf16 v[76:79], v[212:215], v[236:239], v[76:79]
    ds_write2st64_b32 v12, v56, v57 offset0:40 offset1:41
    v_mfma_f32_16x16x32_bf16 v[72:75], v[104:107], v[232:235], v[72:75]
    ds_write2st64_b32 v12, v58, v59 offset0:42 offset1:43
    v_mfma_f32_16x16x32_bf16 v[76:79], v[108:111], v[216:219], v[76:79]
    v_mfma_f32_16x16x32_bf16 v[72:75], v[120:123], v[160:163], v[72:75]
    ds_write2st64_b32 v12, v60, v61 offset0:44 offset1:45
    v_mfma_f32_16x16x32_bf16 v[76:79], v[124:127], v[144:147], v[76:79]
    ds_write2st64_b32 v12, v62, v63 offset0:46 offset1:47
    v_mfma_f32_16x16x32_bf16 v[80:83], v[212:215], v[240:243], v[80:83]
    v_mfma_f32_16x16x32_bf16 v[84:87], v[212:215], v[244:247], v[84:87]
    ds_write2st64_b32 v12, v64, v65 offset0:48 offset1:49
    v_mfma_f32_16x16x32_bf16 v[80:83], v[108:111], v[220:223], v[80:83]
    ds_write2st64_b32 v12, v66, v67 offset0:50 offset1:51
    v_mfma_f32_16x16x32_bf16 v[84:87], v[108:111], v[224:227], v[84:87]
    v_mfma_f32_16x16x32_bf16 v[80:83], v[124:127], v[148:151], v[80:83]
    ds_write2st64_b32 v12, v68, v69 offset0:52 offset1:53
    v_mfma_f32_16x16x32_bf16 v[84:87], v[124:127], v[152:155], v[84:87]
    ds_write2st64_b32 v12, v70, v71 offset0:54 offset1:55
    v_mfma_f32_16x16x32_bf16 v[88:91], v[212:215], v[248:251], v[88:91]
    v_mfma_f32_16x16x32_bf16 v[92:95], v[212:215], v[252:255], v[92:95]
    ds_write2st64_b32 v12, v72, v73 offset0:56 offset1:57
    v_mfma_f32_16x16x32_bf16 v[88:91], v[108:111], v[228:231], v[88:91]
    ds_write2st64_b32 v12, v74, v75 offset0:58 offset1:59
    v_mfma_f32_16x16x32_bf16 v[92:95], v[108:111], v[232:235], v[92:95]
    v_mfma_f32_16x16x32_bf16 v[88:91], v[124:127], v[156:159], v[88:91]
    ds_write2st64_b32 v13, v76, v77 offset0:0 offset1:1
    v_mfma_f32_16x16x32_bf16 v[92:95], v[124:127], v[160:163], v[92:95]
    ds_write2st64_b32 v13, v78, v79 offset0:2 offset1:3
    ds_write2st64_b32 v13, v80, v81 offset0:4 offset1:5
    ds_write2st64_b32 v13, v82, v83 offset0:6 offset1:7
    ds_write2st64_b32 v13, v84, v85 offset0:8 offset1:9
    ds_write2st64_b32 v13, v86, v87 offset0:10 offset1:11
    s_nop 3
    ds_write2st64_b32 v13, v88, v89 offset0:12 offset1:13
    ds_write2st64_b32 v13, v90, v91 offset0:14 offset1:15
    ds_write2st64_b32 v13, v92, v93 offset0:16 offset1:17
    ds_write2st64_b32 v13, v94, v95 offset0:18 offset1:19
L_clsj_73:
    s_cmp_ge_u32 s3, 4
    s_cbranch_scc1 L_nop_76
    s_mul_i32 s50, s3, 5120
    s_mov_b32 s51, 15360
    s_cmp_eq_u32 s3, 3
    s_cselect_b32 s50, 61440, s50
    s_cselect_b32 s51, 5120, s51
    v_and_b32 v116, 15, v0
    v_lshrrev_b32 v117, 4, v0
    v_lshlrev_b32 v118, 4, v116
    v_lshl_add_u32 v118, v117, 8, v118
    v_add_u32 v108, s50, v118
    v_add_u32 v109, s51, v108
    v_add_u32 v110, s51, v109
    v_add_u32 v111, s51, v110
    v_lshrrev_b32 v116, 2, v116
    v_mul_u32_u24 v116, 5120, v116
    v_and_b32 v118, 3, v0
    v_lshl_add_u32 v116, v118, 3, v116
    s_mul_i32 s55, s3, 20480
    v_mul_u32_u24 v5, 1280, v117
    v_add3_u32 v5, v5, v116, s55
    v_add_u32 v112, 81920, v108
    v_add_u32 v113, 81920, v109
    v_add_u32 v114, 81920, v110
    v_add_u32 v115, 81920, v111
L_nop_76:
    s_waitcnt lgkmcnt(0)
    s_barrier
    ds_read_b128 v[16:19], v1 offset:0
    ds_read_b128 v[20:23], v2 offset:0
    ds_read_b128 v[24:27], v3 offset:0
    ds_read_b128 v[28:31], v4 offset:0
    ds_read_b128 v[32:35], v6 offset:0
    ds_read_b128 v[36:39], v8 offset:0
    ds_read_b128 v[40:43], v9 offset:0
    ds_read_b128 v[44:47], v10 offset:0
    ds_read_b128 v[48:51], v1 offset:256
    ds_read_b128 v[52:55], v2 offset:256
    ds_read_b128 v[56:59], v3 offset:256
    ds_read_b128 v[60:63], v4 offset:256
    ds_read_b128 v[64:67], v6 offset:256
    ds_read_b128 v[68:71], v8 offset:256
    ds_read_b128 v[72:75], v9 offset:256
    ds_read_b128 v[76:79], v10 offset:256
    s_cmp_ge_u32 s3, 4
    s_cbranch_scc1 L_nob_74
    s_waitcnt lgkmcnt(14)
    v_pk_add_f32 v[16:17], v[16:17], v[20:21]
    v_pk_add_f32 v[18:19], v[18:19], v[22:23]
    s_waitcnt lgkmcnt(13)
    v_pk_add_f32 v[16:17], v[16:17], v[24:25]
    v_pk_add_f32 v[18:19], v[18:19], v[26:27]
    s_waitcnt lgkmcnt(12)
    v_pk_add_f32 v[16:17], v[16:17], v[28:29]
    v_pk_add_f32 v[18:19], v[18:19], v[30:31]
    s_waitcnt lgkmcnt(11)
    v_pk_add_f32 v[16:17], v[16:17], v[32:33]
    v_pk_add_f32 v[18:19], v[18:19], v[34:35]
    s_waitcnt lgkmcnt(10)
    v_pk_add_f32 v[16:17], v[16:17], v[36:37]
    v_pk_add_f32 v[18:19], v[18:19], v[38:39]
    s_waitcnt lgkmcnt(9)
    v_pk_add_f32 v[16:17], v[16:17], v[40:41]
    v_pk_add_f32 v[18:19], v[18:19], v[42:43]
    s_waitcnt lgkmcnt(8)
    v_pk_add_f32 v[16:17], v[16:17], v[44:45]
    v_pk_add_f32 v[18:19], v[18:19], v[46:47]
    ds_read_b128 v[128:131], v108 offset:4096
    ds_read_b128 v[132:135], v109 offset:4096
    ds_read_b128 v[136:139], v110 offset:4096
    ds_read_b128 v[140:143], v111 offset:4096
    ds_read_b128 v[144:147], v112 offset:4096
    ds_read_b128 v[148:151], v113 offset:4096
    ds_read_b128 v[152:155], v114 offset:4096
    ds_read_b128 v[156:159], v115 offset:4096
    s_nop 0
    v_mul_f32_dpp v16, v7, v16 quad_perm:[0,0,0,0] row_mask:0xf bank_mask:0xf
    v_mul_f32_dpp v17, v7, v17 quad_perm:[0,0,0,0] row_mask:0xf bank_mask:0xf
    v_mul_f32_dpp v18, v7, v18 quad_perm:[0,0,0,0] row_mask:0xf bank_mask:0xf
    v_mul_f32_dpp v19, v7, v19 quad_perm:[0,0,0,0] row_mask:0xf bank_mask:0xf
    v_cvt_pk_bf16_f32 v16, v16, v17
    v_cvt_pk_bf16_f32 v17, v18, v19
    buffer_store_dwordx2 v[16:17], v11, s[44:47], 0 offen offset:0 nt
    s_waitcnt lgkmcnt(14)
    v_pk_add_f32 v[48:49], v[48:49], v[52:53]
    v_pk_add_f32 v[50:51], v[50:51], v[54:55]
    s_waitcnt lgkmcnt(13)
    v_pk_add_f32 v[48:49], v[48:49], v[56:57]
    v_pk_add_f32 v[50:51], v[50:51], v[58:59]
    s_waitcnt lgkmcnt(12)
    v_pk_add_f32 v[48:49], v[48:49], v[60:61]
    v_pk_add_f32 v[50:51], v[50:51], v[62:63]
    s_waitcnt lgkmcnt(11)
    v_pk_add_f32 v[48:49], v[48:49], v[64:65]
    v_pk_add_f32 v[50:51], v[50:51], v[66:67]
    s_waitcnt lgkmcnt(10)
    v_pk_add_f32 v[48:49], v[48:49], v[68:69]
    v_pk_add_f32 v[50:51], v[50:51], v[70:71]
    s_waitcnt lgkmcnt(9)
    v_pk_add_f32 v[48:49], v[48:49], v[72:73]
    v_pk_add_f32 v[50:51], v[50:51], v[74:75]
    s_waitcnt lgkmcnt(8)
    v_pk_add_f32 v[48:49], v[48:49], v[76:77]
    v_pk_add_f32 v[50:51], v[50:51], v[78:79]
    s_nop 0
    v_mul_f32_dpp v48, v7, v48 quad_perm:[1,1,1,1] row_mask:0xf bank_mask:0xf
    v_mul_f32_dpp v49, v7, v49 quad_perm:[1,1,1,1] row_mask:0xf bank_mask:0xf
    v_mul_f32_dpp v50, v7, v50 quad_perm:[1,1,1,1] row_mask:0xf bank_mask:0xf
    v_mul_f32_dpp v51, v7, v51 quad_perm:[1,1,1,1] row_mask:0xf bank_mask:0xf
    v_cvt_pk_bf16_f32 v48, v48, v49
    v_cvt_pk_bf16_f32 v49, v50, v51
    buffer_store_dwordx2 v[48:49], v11, s[44:47], 0 offen offset:1280 nt
    s_waitcnt lgkmcnt(6)
    v_pk_add_f32 v[128:129], v[128:129], v[132:133]
    v_pk_add_f32 v[130:131], v[130:131], v[134:135]
    s_waitcnt lgkmcnt(5)
    v_pk_add_f32 v[128:129], v[128:129], v[136:137]
    v_pk_add_f32 v[130:131], v[130:131], v[138:139]
    s_waitcnt lgkmcnt(4)
    v_pk_add_f32 v[128:129], v[128:129], v[140:141]
    v_pk_add_f32 v[130:131], v[130:131], v[142:143]
    s_waitcnt lgkmcnt(3)
    v_pk_add_f32 v[128:129], v[128:129], v[144:145]
    v_pk_add_f32 v[130:131], v[130:131], v[146:147]
    s_waitcnt lgkmcnt(2)
    v_pk_add_f32 v[128:129], v[128:129], v[148:149]
    v_pk_add_f32 v[130:131], v[130:131], v[150:151]
    s_waitcnt lgkmcnt(1)
    v_pk_add_f32 v[128:129], v[128:129], v[152:153]
    v_pk_add_f32 v[130:131], v[130:131], v[154:155]
    s_waitcnt lgkmcnt(0)
    v_pk_add_f32 v[128:129], v[128:129], v[156:157]
    v_pk_add_f32 v[130:131], v[130:131], v[158:159]
    s_nop 0
    v_mul_f32_dpp v128, v7, v128 quad_perm:[2,2,2,2] row_mask:0xf bank_mask:0xf
    v_mul_f32_dpp v129, v7, v129 quad_perm:[2,2,2,2] row_mask:0xf bank_mask:0xf
    v_mul_f32_dpp v130, v7, v130 quad_perm:[2,2,2,2] row_mask:0xf bank_mask:0xf
    v_mul_f32_dpp v131, v7, v131 quad_perm:[2,2,2,2] row_mask:0xf bank_mask:0xf
    v_cvt_pk_bf16_f32 v128, v128, v129
    v_cvt_pk_bf16_f32 v129, v130, v131
    buffer_store_dwordx2 v[128:129], v5, s[44:47], 0 offen offset:128 nt
    s_branch L_rend_75
L_nob_74:
    s_waitcnt lgkmcnt(14)
    v_pk_add_f32 v[16:17], v[16:17], v[20:21]
    v_pk_add_f32 v[18:19], v[18:19], v[22:23]
    s_waitcnt lgkmcnt(13)
    v_pk_add_f32 v[16:17], v[16:17], v[24:25]
    v_pk_add_f32 v[18:19], v[18:19], v[26:27]
    s_waitcnt lgkmcnt(12)
    v_pk_add_f32 v[16:17], v[16:17], v[28:29]
    v_pk_add_f32 v[18:19], v[18:19], v[30:31]
    s_waitcnt lgkmcnt(11)
    v_pk_add_f32 v[16:17], v[16:17], v[32:33]
    v_pk_add_f32 v[18:19], v[18:19], v[34:35]
    s_waitcnt lgkmcnt(10)
    v_pk_add_f32 v[16:17], v[16:17], v[36:37]
    v_pk_add_f32 v[18:19], v[18:19], v[38:39]
    s_waitcnt lgkmcnt(9)
    v_pk_add_f32 v[16:17], v[16:17], v[40:41]
    v_pk_add_f32 v[18:19], v[18:19], v[42:43]
    s_waitcnt lgkmcnt(8)
    v_pk_add_f32 v[16:17], v[16:17], v[44:45]
    v_pk_add_f32 v[18:19], v[18:19], v[46:47]
    s_nop 0
    v_mul_f32_dpp v16, v7, v16 quad_perm:[0,0,0,0] row_mask:0xf bank_mask:0xf
    v_mul_f32_dpp v17, v7, v17 quad_perm:[0,0,0,0] row_mask:0xf bank_mask:0xf
    v_mul_f32_dpp v18, v7, v18 quad_perm:[0,0,0,0] row_mask:0xf bank_mask:0xf
    v_mul_f32_dpp v19, v7, v19 quad_perm:[0,0,0,0] row_mask:0xf bank_mask:0xf
    v_cvt_pk_bf16_f32 v16, v16, v17
    v_cvt_pk_bf16_f32 v17, v18, v19
    buffer_store_dwordx2 v[16:17], v11, s[44:47], 0 offen offset:0 nt
    s_waitcnt lgkmcnt(6)
    v_pk_add_f32 v[48:49], v[48:49], v[52:53]
    v_pk_add_f32 v[50:51], v[50:51], v[54:55]
    s_waitcnt lgkmcnt(5)
    v_pk_add_f32 v[48:49], v[48:49], v[56:57]
    v_pk_add_f32 v[50:51], v[50:51], v[58:59]
    s_waitcnt lgkmcnt(4)
    v_pk_add_f32 v[48:49], v[48:49], v[60:61]
    v_pk_add_f32 v[50:51], v[50:51], v[62:63]
    s_waitcnt lgkmcnt(3)
    v_pk_add_f32 v[48:49], v[48:49], v[64:65]
    v_pk_add_f32 v[50:51], v[50:51], v[66:67]
    s_waitcnt lgkmcnt(2)
    v_pk_add_f32 v[48:49], v[48:49], v[68:69]
    v_pk_add_f32 v[50:51], v[50:51], v[70:71]
    s_waitcnt lgkmcnt(1)
    v_pk_add_f32 v[48:49], v[48:49], v[72:73]
    v_pk_add_f32 v[50:51], v[50:51], v[74:75]
    s_waitcnt lgkmcnt(0)
    v_pk_add_f32 v[48:49], v[48:49], v[76:77]
    v_pk_add_f32 v[50:51], v[50:51], v[78:79]
    s_nop 0
    v_mul_f32_dpp v48, v7, v48 quad_perm:[1,1,1,1] row_mask:0xf bank_mask:0xf
    v_mul_f32_dpp v49, v7, v49 quad_perm:[1,1,1,1] row_mask:0xf bank_mask:0xf
    v_mul_f32_dpp v50, v7, v50 quad_perm:[1,1,1,1] row_mask:0xf bank_mask:0xf
    v_mul_f32_dpp v51, v7, v51 quad_perm:[1,1,1,1] row_mask:0xf bank_mask:0xf
    v_cvt_pk_bf16_f32 v48, v48, v49
    v_cvt_pk_bf16_f32 v49, v50, v51
    buffer_store_dwordx2 v[48:49], v11, s[44:47], 0 offen offset:1280 nt
L_rend_75:
K_end:
    s_endpgm
K_last:
L_ispin_6:
    s_mov_b32 s34, 65536
L_ispin_6_l:
    v_mov_b32 v255, 0
    global_load_dword v255, v255, s[6:7] sc1
    s_waitcnt vmcnt(0)
    v_cmp_ne_u32 vcc, 1, v255
    s_sub_u32 s34, s34, 1
    s_cbranch_scc1 L_iback_7
    s_cbranch_vccnz L_ispin_6_l
    s_branch L_iback_7
L_ispin_49:
    s_mov_b32 s34, 65536
L_ispin_49_l:
    v_mov_b32 v255, 0
    global_load_dword v255, v255, s[6:7] sc1
    s_waitcnt vmcnt(0)
    v_cmp_ne_u32 vcc, 1, v255
    s_sub_u32 s34, s34, 1
    s_cbranch_scc1 L_iback_50
    s_cbranch_vccnz L_ispin_49_l
    s_branch L_iback_50
L_pspin_55:
    s_mov_b32 s34, 65536
L_pspin_55_l:
    s_sleep 4
    global_load_dword v6, v5, s[100:101] sc1
    s_waitcnt vmcnt(0)
    v_cmp_ne_u32 vcc, 1, v6
    s_sub_u32 s34, s34, 1
    s_cbranch_scc1 L_pback_56
    s_cbranch_vccnz L_pspin_55_l
    s_branch L_pback_56
L_sspin_57:
    s_mov_b32 s34, 65536
L_sspin_57_l:
    s_sleep 4
    global_load_dword v6, v5, s[100:101] sc1
    s_waitcnt vmcnt(0)
    v_cmp_ne_u32 vcc, 1, v6
    s_sub_u32 s34, s34, 1
    s_cbranch_scc1 L_sback_58
    s_cbranch_vccnz L_sspin_57_l
    s_branch L_sback_58
K_slow:
    v_and_b32 v5, 31, v0
    v_lshlrev_b32 v3, 3, v5
    v_lshrrev_b32 v6, 5, v0
    v_mul_u32_u24 v4, 320, v6
    v_lshl_add_u32 v4, v5, 4, v4
    v_mov_b32 v12, 0xff800000
    s_mov_b32 s27, 0
    s_lshl_b32 s26, s21, 5
    s_add_u32 s26, s26, s30
    s_lshl_b32 s26, s26, 1
    s_add_u32 s26, s26, s24
    s_mul_i32 s26, s26, 1280
    s_add_u32 s26, s26, 5242880
    s_add_u32 s12, s4, s26
    s_addc_u32 s13, s5, 0
    s_mov_b32 s14, 1280
    v_lshl_add_u32 v13, v6, 20, v3
    s_waitcnt vmcnt(0)
    buffer_load_dwordx4 v[88:91], v14, s[12:15], 0 offen sc1
    buffer_load_dwordx2 v[92:93], v13, s[12:15], 0 offen offset:1024 sc1
    s_mov_b32 s28, 0x000fffff
    s_mov_b32 s29, 0x000fffff
    v_and_b32 v10, 27, v0
    v_cmp_eq_u32 vcc, 24, v10
    v_mov_b32 v10, 0x3f803f80
    s_nop 0
    v_cndmask_b32 v112, 0, v10, vcc
    v_cndmask_b32 v113, 0, v10, vcc
    v_cndmask_b32 v114, 0, v10, vcc
    v_cndmask_b32 v115, 0, v10, vcc
    v_cndmask_b32 v116, 0, v10, vcc
    v_cndmask_b32 v117, 0, v10, vcc
    v_cndmask_b32 v118, 0, v10, vcc
    v_cndmask_b32 v119, 0, v10, vcc
    v_cndmask_b32 v120, 0, v10, vcc
    v_cndmask_b32 v121, 0, v10, vcc
    v_cndmask_b32 v122, 0, v10, vcc
    v_cndmask_b32 v123, 0, v10, vcc
K_slow1:
    buffer_load_dwordx4 v[100:103], v14, s[8:11], s27 offen sc1
    buffer_load_dwordx2 v[104:105], v3, s[8:11], s27 offen offset:1024 sc1
    s_waitcnt vmcnt(0)
    v_mfma_f32_32x32x16_bf16 v[16:31], v[100:103], v[88:91], 0
    v_mfma_f32_32x32x8_bf16 v[16:31], v[104:105], v[92:93], v[16:31]
    s_nop 15
    v_max3_f32 v12, v16, v17, v12
    v_max3_f32 v12, v18, v19, v12
    v_max3_f32 v12, v20, v21, v12
    v_max3_f32 v12, v22, v23, v12
    v_max3_f32 v12, v24, v25, v12
    v_max3_f32 v12, v26, v27, v12
    v_max3_f32 v12, v28, v29, v12
    v_max3_f32 v12, v30, v31, v12
    s_add_u32 s27, s27, 2560
    s_cmp_lt_u32 s27, 163840
    s_cbranch_scc1 K_slow1
    v_mov_b32 v13, v12
    s_nop 1
    v_permlane32_swap_b32 v12, v13
    v_max_f32 v12, v12, v13
    s_mov_b32 s27, 0
    v_mov_b32 v64, 0
    v_mov_b32 v65, 0
    v_mov_b32 v66, 0
    v_mov_b32 v67, 0
    v_mov_b32 v68, 0
    v_mov_b32 v69, 0
    v_mov_b32 v70, 0
    v_mov_b32 v71, 0
    v_mov_b32 v72, 0
    v_mov_b32 v73, 0
    v_mov_b32 v74, 0
    v_mov_b32 v75, 0
    v_mov_b32 v76, 0
    v_mov_b32 v77, 0
    v_mov_b32 v78, 0
    v_mov_b32 v79, 0
K_slow2:
    buffer_load_dwordx4 v[100:103], v14, s[8:11], s27 offen sc1
    buffer_load_dwordx2 v[104:105], v3, s[8:11], s27 offen offset:1024 sc1
    s_mov_b64 exec, s[28:29]
    buffer_load_dwordx4 v[112:115], v4, s[8:11], s27 offen offset:1280 sc1
    buffer_load_dwordx4 v[116:119], v4, s[8:11], s27 offen offset:1920 sc1
    s_mov_b64 exec, -1
    s_waitcnt vmcnt(0)
    v_mfma_f32_32x32x16_bf16 v[16:31], v[100:103], v[88:91], 0
    v_mfma_f32_32x32x8_bf16 v[16:31], v[104:105], v[92:93], v[16:31]
    s_nop 15
    v_sub_f32 v16, v16, v12
    v_sub_f32 v17, v17, v12
    v_sub_f32 v18, v18, v12
    v_sub_f32 v19, v19, v12
    v_sub_f32 v20, v20, v12
    v_sub_f32 v21, v21, v12
    v_sub_f32 v22, v22, v12
    v_sub_f32 v23, v23, v12
    v_sub_f32 v24, v24, v12
    v_sub_f32 v25, v25, v12
    v_sub_f32 v26, v26, v12
    v_sub_f32 v27, v27, v12
    v_sub_f32 v28, v28, v12
    v_sub_f32 v29, v29, v12
    v_sub_f32 v30, v30, v12
    v_sub_f32 v31, v31, v12
    v_exp_f32 v16, v16
    v_exp_f32 v17, v17
    v_exp_f32 v18, v18
    v_exp_f32 v19, v19
    v_exp_f32 v20, v20
    v_exp_f32 v21, v21
    v_exp_f32 v22, v22
    v_exp_f32 v23, v23
    v_exp_f32 v24, v24
    v_exp_f32 v25, v25
    v_exp_f32 v26, v26
    v_exp_f32 v27, v27
    v_exp_f32 v28, v28
    v_exp_f32 v29, v29
    v_exp_f32 v30, v30
    v_exp_f32 v31, v31
    s_nop 0
    v_cvt_pk_bf16_f32 v80, v16, v17
    v_cvt_pk_bf16_f32 v81, v18, v19
    v_cvt_pk_bf16_f32 v82, v20, v21
    v_cvt_pk_bf16_f32 v83, v22, v23
    v_cvt_pk_bf16_f32 v84, v24, v25
    v_cvt_pk_bf16_f32 v85, v26, v27
    v_cvt_pk_bf16_f32 v86, v28, v29
    v_cvt_pk_bf16_f32 v87, v30, v31
    s_nop 1
    v_mfma_f32_32x32x16_bf16 v[64:79], v[112:115], v[80:83], v[64:79]
    v_mfma_f32_32x32x16_bf16 v[64:79], v[116:119], v[84:87], v[64:79]
    s_add_u32 s27, s27, 2560
    s_cmp_lt_u32 s27, 163840
    s_cbranch_scc1 K_slow2
    s_nop 15
    s_add_u32 s50, s62, 24
    s_sub_u32 s63, s50, 54
    s_min_u32 s50, s50, s63
    s_lshl_b32 s50, s50, 12
    buffer_load_dwordx4 v[96:99], v14, s[36:39], s50 offen offset:0 sc1
    buffer_load_dwordx4 v[100:103], v14, s[36:39], s50 offen offset:1024 sc1
    buffer_load_dwordx4 v[104:107], v14, s[36:39], s50 offen offset:2048 sc1
    buffer_load_dwordx4 v[108:111], v14, s[36:39], s50 offen offset:3072 sc1
    s_add_u32 s50, s62, 32
    s_sub_u32 s63, s50, 54
    s_min_u32 s50, s50, s63
    s_lshl_b32 s50, s50, 12
    buffer_load_dwordx4 v[112:115], v14, s[36:39], s50 offen offset:0 sc1
    buffer_load_dwordx4 v[116:119], v14, s[36:39], s50 offen offset:1024 sc1
    buffer_load_dwordx4 v[120:123], v14, s[36:39], s50 offen offset:2048 sc1
    buffer_load_dwordx4 v[124:127], v14, s[36:39], s50 offen offset:3072 sc1
    s_waitcnt vmcnt(0)
    s_branch K_fin
L_ospin_70:
    s_mov_b32 s34, 65536
L_ospin_70_l:
    s_add_u32 s50, s3, 54
    s_lshl_b32 s50, s50, 12
    buffer_load_dwordx4 v[200:203], v14, s[36:39], s50 offen offset:0 sc1
    buffer_load_dwordx4 v[204:207], v14, s[36:39], s50 offen offset:1024 sc1
    buffer_load_dwordx4 v[208:211], v14, s[36:39], s50 offen offset:2048 sc1
    buffer_load_dwordx4 v[212:215], v14, s[36:39], s50 offen offset:3072 sc1
    s_add_u32 s50, s3, 62
    s_lshl_b32 s50, s50, 12
    buffer_load_dwordx4 v[96:99], v14, s[36:39], s50 offen offset:0 sc1
    buffer_load_dwordx4 v[100:103], v14, s[36:39], s50 offen offset:1024 sc1
    buffer_load_dwordx4 v[104:107], v14, s[36:39], s50 offen offset:2048 sc1
    buffer_load_dwordx4 v[108:111], v14, s[36:39], s50 offen offset:3072 sc1
    s_add_u32 s50, s3, 66
    s_cmp_ge_u32 s50, 70
    s_cselect_b32 s50, s50, 524032
    s_lshl_b32 s50, s50, 12
    buffer_load_dwordx4 v[112:115], v14, s[36:39], s50 offen offset:0 sc1
    buffer_load_dwordx4 v[116:119], v14, s[36:39], s50 offen offset:1024 sc1
    buffer_load_dwordx4 v[120:123], v14, s[36:39], s50 offen offset:2048 sc1
    buffer_load_dwordx4 v[124:127], v14, s[36:39], s50 offen offset:3072 sc1
    s_waitcnt vmcnt(0)
    v_max3_u32 v5, v200, v201, v202
    v_max3_u32 v5, v5, v203, v204
    v_max3_u32 v5, v5, v205, v206
    v_max3_u32 v5, v5, v207, v208
    v_max3_u32 v5, v5, v209, v210
    v_max3_u32 v5, v5, v211, v212
    v_max3_u32 v5, v5, v213, v214
    v_max3_u32 v5, v5, v215, v96
    v_max3_u32 v5, v5, v97, v98
    v_max3_u32 v5, v5, v99, v100
    v_max3_u32 v5, v5, v101, v102
    v_max3_u32 v5, v5, v103, v104
    v_max3_u32 v5, v5, v105, v106
    v_max3_u32 v5, v5, v107, v108
    v_max3_u32 v5, v5, v109, v110
    v_max3_u32 v5, v5, v111, v112
    v_max3_u32 v5, v5, v113, v114
    v_max3_u32 v5, v5, v115, v116
    v_max3_u32 v5, v5, v117, v118
    v_max3_u32 v5, v5, v119, v120
    v_max3_u32 v5, v5, v121, v122
    v_max3_u32 v5, v5, v123, v124
    v_max3_u32 v5, v5, v125, v126
    v_max_u32 v5, v5, v127
    v_cmp_eq_u32 vcc, -1, v5
    s_sub_u32 s34, s34, 1
    s_cbranch_scc1 L_oback_71
    s_cbranch_vccnz L_ospin_70_l
    s_branch L_oback_71
.section .rodata,"a"
.p2align 6
.amdhsa_kernel gated_mix__softmax_full_mha__geglu_ffn__prompt_kernel
  .amdhsa_next_free_vgpr 256
  .amdhsa_next_free_sgpr 102
  .amdhsa_accum_offset 256
  .amdhsa_group_segment_fixed_size 0
  .amdhsa_kernarg_size 88
  .amdhsa_user_sgpr_count 2
  .amdhsa_user_sgpr_kernarg_segment_ptr 1
  .amdhsa_system_sgpr_workgroup_id_x 1
.end_amdhsa_kernel
```
